```python
import torch

def _softmax(x, axis=-1):
    return torch.softmax(x, dim=axis)

def _gelu(x):
    return torch.nn.functional.gelu(x, approximate='tanh')

def _silu(x):
    return torch.nn.functional.silu(x)

def _sigmoid(x):
    return torch.sigmoid(x)

def _layernorm(x, axis=-1, eps=1e-05):
    m = x.mean(dim=axis, keepdim=True)
    v = x.var(dim=axis, keepdim=True, unbiased=False)
    return (x - m) / torch.sqrt(v + eps)

def _scatter_add(tgt, idx, src, axis=0):
    return tgt.clone().index_add_(axis, idx, src)

def _segment_sum(src, seg, n):
    out = torch.zeros((n,) + src.shape[1:], dtype=src.dtype)
    return out.index_add_(0, seg, src)

def _pad(x, pw):
    flat = tuple((v for pair in reversed(pw) for v in pair))
    return torch.nn.functional.pad(x, flat)
kernel_name = 'adaLN_cond__gqa_block_cached__swiglu_ffn__prompt'

def setup_inputs():

    _w = lambda a: (lambda t: t.to(torch.bfloat16) if t.is_floating_point() else t)(torch.as_tensor(a))

    def _A_setup():
        B, Sq, D = (1, 2048, 448)
        Hq, Hkv, Sk, Dh = (16, 8, 2048, 256)
        assert Hq % Hkv == 0, (Hq, Hkv)
        return {'x': _w((lambda *s: torch.randn(*s, dtype=torch.bfloat16) * 0.05)(B, Sq, D)), 'k_cache': _w((lambda *s: torch.randn(*s, dtype=torch.bfloat16) * 3.2)(B, Hkv, Sk, Dh)), 'v_cache': _w((lambda *s: torch.randn(*s, dtype=torch.bfloat16) * 0.4)(B, Hkv, Sk, Dh)), 'wq': _w((lambda *s: torch.randn(*s, dtype=torch.bfloat16) * 3.2)(D, Hq * Dh) * D ** (-0.5)), 'wo': _w((lambda *s: torch.randn(*s, dtype=torch.bfloat16) * 0.4)(Hq * Dh, D) * (Hq * Dh) ** (-0.5))}
    _A_in = _A_setup()

    def _B_setup():
        B, S, D, F = (1, 2048, 448, 1792)
        return {'x': _w((lambda *s: torch.randn(*s, dtype=torch.bfloat16) * 0.05)(B, S, D)), 'w_gate': _w((lambda *s: torch.randn(*s, dtype=torch.bfloat16) * 0.05)(D, F)), 'w_up': _w((lambda *s: torch.randn(*s, dtype=torch.bfloat16) * 0.05)(D, F)), 'w_down': _w((lambda *s: torch.randn(*s, dtype=torch.bfloat16) * 0.05)(F, D))}
    _B_in = _B_setup()
    return {'A_x': _A_in['x'], 'A_k_cache': _A_in['k_cache'], 'A_v_cache': _A_in['v_cache'], 'A_wq': _A_in['wq'], 'A_wo': _A_in['wo'], 'B_x': _B_in['x'], 'B_w_gate': _B_in['w_gate'], 'B_w_up': _B_in['w_up'], 'B_w_down': _B_in['w_down'], 'c': _w((lambda *s: torch.randn(*s, dtype=torch.bfloat16) * 0.2)(1, 448) * 8.0), 'w_mod': _w((lambda *s: torch.randn(*s, dtype=torch.bfloat16) * 0.2)(448, 6 * 448) * 448 ** (-0.5) * 8.0)}

def reference(A_x, A_k_cache, A_v_cache, A_wq, A_wo, B_x, B_w_gate, B_w_up, B_w_down, c, w_mod):

    def _A_ref(x, k_cache, v_cache, wq, wo):
        B, Sq, D = x.shape
        Hq, Dh = (16, 256)
        Hkv = k_cache.shape[1]
        rep = Hq // Hkv
        q = (lambda x, *d: x.permute(*d))((x @ wq).reshape(B, Sq, Hq, Dh), 0, 2, 1, 3)
        k = (lambda x, n, axis: torch.repeat_interleave(x, n, dim=axis))(k_cache, rep, axis=1)
        v = (lambda x, n, axis: torch.repeat_interleave(x, n, dim=axis))(v_cache, rep, axis=1)
        scores = torch.einsum('bhqd,bhkd->bhqk', q, k) * Dh ** (-0.5)
        p = _softmax(scores, axis=-1)
        o = torch.einsum('bhqk,bhkd->bhqd', p, v)
        return (lambda x, *d: x.permute(*d))(o, 0, 2, 1, 3).reshape(B, Sq, Hq * Dh) @ wo

    def _B_ref(x, w_gate, w_up, w_down):
        g = _silu(x @ w_gate)
        u = x @ w_up
        return g * u @ w_down
    x = A_x
    mod = (_silu(c) @ w_mod).reshape(c.shape[0], 6, 1, -1)
    sa, ca, ga, sb, cb, gb = (mod[:, 0].clone(), mod[:, 1].clone(), mod[:, 2].clone(), mod[:, 3].clone(), mod[:, 4].clone(), mod[:, 5].clone())
    h = _layernorm(x, axis=-1) * (1 + ca) + sa
    x = x + ga * _A_ref(h, A_k_cache, A_v_cache, A_wq, A_wo)
    h = _layernorm(x, axis=-1) * (1 + cb) + sb
    x = x + gb * _B_ref(h, B_w_gate, B_w_up, B_w_down)
    return x
```

```asm
; @launch kernel=attn_kernel grid=(256,1,1) block=(256,1,1) lds=163840
.amdgcn_target "amdgcn-amd-amdhsa--gfx950"
.text
.globl attn_kernel
.p2align 8
.type attn_kernel,@function
attn_kernel:
    s_cmp_ge_u32 s2, 256
    s_cbranch_scc1 Lat_end_1
    s_load_dwordx4 s[88:91], s[0:1], 72
    s_load_dwordx2 s[86:87], s[0:1], 0
    s_load_dwordx4 s[44:47], s[0:1], 8
    s_load_dwordx4 s[48:51], s[0:1], 24
    s_load_dwordx4 s[52:55], s[0:1], 96
    s_load_dwordx4 s[80:83], s[0:1], 48
    s_load_dwordx2 s[84:85], s[0:1], 64
    v_lshrrev_b32 v2, 6, v0
    s_nop 0
    v_readfirstlane_b32 s28, v2
    s_and_b32 s29, s2, 7
    s_lshr_b32 s30, s2, 3
    v_and_b32 v1, 63, v0
    v_lshrrev_b32 v120, 5, v1
    v_bfe_u32 v121, v1, 2, 2
    v_and_b32 v122, 3, v1
    v_bfe_u32 v123, v1, 4, 1
    v_and_b32 v124, 31, v1
    s_lshr_b32 s31, s28, 1
    s_and_b32 s32, s28, 1
    s_lshl_b32 s38, s28, 12
    s_mul_i32 s40, s28, 112
    v_lshrrev_b32 v104, 1, v1
    v_add_u32 v104, s40, v104
    v_lshlrev_b32 v105, 1, v104
    v_mul_u32_u24 v106, 5376, v104
    v_and_b32 v107, 1, v1
    v_lshl_add_u32 v106, v107, 4, v106
    s_lshl_b32 s40, s30, 6
    s_lshl_b32 s41, s32, 5
    s_add_u32 s40, s40, s41
    v_add_u32 v110, s40, v124
    v_mul_u32_u24 v110, 896, v110
    v_lshl_add_u32 v110, v120, 4, v110
    s_mul_i32 s42, s31, 448
    s_lshl_b32 s40, s2, 5
    s_waitcnt lgkmcnt(0)
    s_mov_b32 s4, s88
    s_mov_b32 s5, s89
    s_mov_b32 s6, 896
    s_mov_b32 s7, 0x00020000
    s_mov_b32 s8, s44
    s_mov_b32 s9, s45
    s_mov_b32 s10, 8388608
    s_mov_b32 s11, 0x00020000
    s_mov_b32 s12, s46
    s_mov_b32 s13, s47
    s_mov_b32 s14, 8388608
    s_mov_b32 s15, 0x00020000
    s_mov_b32 s44, s90
    s_mov_b32 s45, s91
    s_mov_b32 s46, 2408448
    s_mov_b32 s47, 0x00020000
    s_mov_b32 s76, s86
    s_mov_b32 s77, s87
    s_mov_b32 s78, 1835008
    s_mov_b32 s79, 0x00020000
    s_cmp_gt_u32 s2, 32
    s_cbranch_scc1 Lnz_4
    s_cmp_lg_u32 s28, 1
    s_cbranch_scc1 Lnz_4
    s_mov_b32 s24, s54
    s_mov_b32 s25, s55
    s_mov_b32 s26, 134217728
    s_mov_b32 s27, 0x00020000
    v_mov_b64 v[96:97], 0
    v_mov_b64 v[98:99], 0
    v_lshlrev_b32 v100, 4, v1
    s_lshl_b32 s41, s2, 10
    s_add_u32 s41, s41, 524288
    buffer_store_dwordx4 v[96:99], v100, s[24:27], s41 offen sc1
Lnz_4:
    s_cmp_ge_u32 s2, 168
    s_cbranch_scc1 Lnm_2
    buffer_load_ushort v20, v105, s[4:7], 0 offen offset:0
    buffer_load_ushort v21, v105, s[4:7], 0 offen offset:56
    buffer_load_ushort v22, v105, s[4:7], 0 offen offset:112
    buffer_load_ushort v23, v105, s[4:7], 0 offen offset:168
    s_add_u32 s41, s40, 0
    buffer_load_dwordx4 v[24:27], v106, s[44:47], s41 offen
    s_add_u32 s41, s40, 150528
    buffer_load_dwordx4 v[28:31], v106, s[44:47], s41 offen
    s_add_u32 s41, s40, 301056
    buffer_load_dwordx4 v[32:35], v106, s[44:47], s41 offen
    s_add_u32 s41, s40, 451584
    buffer_load_dwordx4 v[36:39], v106, s[44:47], s41 offen
Lnm_2:
    buffer_load_dwordx4 v[40:43], v110, s[76:79], s42 offen offset:0
    buffer_load_dwordx4 v[44:47], v110, s[76:79], s42 offen offset:32
    buffer_load_dwordx4 v[48:51], v110, s[76:79], s42 offen offset:64
    buffer_load_dwordx4 v[52:55], v110, s[76:79], s42 offen offset:96
    buffer_load_dwordx4 v[56:59], v110, s[76:79], s42 offen offset:128
    buffer_load_dwordx4 v[60:63], v110, s[76:79], s42 offen offset:160
    buffer_load_dwordx4 v[64:67], v110, s[76:79], s42 offen offset:192
    buffer_load_dwordx4 v[68:71], v110, s[76:79], s42 offen offset:224
    buffer_load_dwordx4 v[72:75], v110, s[76:79], s42 offen offset:256
    buffer_load_dwordx4 v[76:79], v110, s[76:79], s42 offen offset:288
    buffer_load_dwordx4 v[80:83], v110, s[76:79], s42 offen offset:320
    buffer_load_dwordx4 v[84:87], v110, s[76:79], s42 offen offset:352
    buffer_load_dwordx4 v[88:91], v110, s[76:79], s42 offen offset:384
    buffer_load_dwordx4 v[92:95], v110, s[76:79], s42 offen offset:416
    s_mov_b32 s16, s48
    s_mov_b32 s17, s49
    s_mov_b32 s18, 3670016
    s_mov_b32 s19, 0x00020000
    s_mov_b32 s20, s50
    s_mov_b32 s21, s51
    s_mov_b32 s22, 3670016
    s_mov_b32 s23, 0x00020000
    s_mov_b32 s24, s54
    s_mov_b32 s25, s55
    s_mov_b32 s26, 134217728
    s_mov_b32 s27, 0x00020000
    s_mov_b32 s48, s52
    s_mov_b32 s49, s53
    s_mov_b32 s50, 256
    s_mov_b32 s51, 0x00020000
    s_mov_b32 s64, s80
    s_mov_b32 s65, s81
    s_mov_b32 s66, 1605632
    s_mov_b32 s67, 0x00020000
    s_mov_b32 s68, s82
    s_mov_b32 s69, s83
    s_mov_b32 s70, 1605632
    s_mov_b32 s71, 0x00020000
    s_mov_b32 s72, s84
    s_mov_b32 s73, s85
    s_mov_b32 s74, 1605632
    s_mov_b32 s75, 0x00020000
    s_mov_b32 s36, 0x3db8aa3b
    s_mov_b32 s37, 0x5f800000
    s_mov_b32 s90, 0x00003f80
    s_mov_b32 s91, 0x3f800000
    s_mov_b32 s92, 0x3f803f80
    v_xor_b32 v126, 0, v1
    v_lshlrev_b32 v126, 4, v126
    v_add_u32 v112, 0, v126
    v_xor_b32 v126, 4, v1
    v_lshlrev_b32 v126, 4, v126
    v_add_u32 v113, 7168, v126
    v_xor_b32 v126, 8, v1
    v_lshlrev_b32 v126, 4, v126
    v_add_u32 v114, 14336, v126
    v_xor_b32 v126, 12, v1
    v_lshlrev_b32 v126, 4, v126
    v_add_u32 v115, 21504, v126
    v_lshl_add_u32 v126, v120, 3, v121
    v_lshlrev_b32 v126, 10, v126
    v_lshl_add_u32 v126, v123, 5, v126
    v_and_b32 v125, 1, v122
    v_lshl_add_u32 v126, v125, 4, v126
    v_lshrrev_b32 v125, 1, v122
    v_lshl_add_u32 v126, v125, 3, v126
    s_lshl_b32 s40, s31, 9
    v_add_u32 v126, s40, v126
    v_xor_b32 v125, 0, v121
    v_lshl_add_u32 v116, v125, 6, v126
    v_xor_b32 v125, 1, v121
    v_lshl_add_u32 v117, v125, 6, v126
    v_xor_b32 v125, 2, v121
    v_lshl_add_u32 v118, v125, 6, v126
    v_xor_b32 v125, 3, v121
    v_lshl_add_u32 v119, v125, 6, v126
    v_and_b32 v125, 15, v124
    v_lshlrev_b32 v127, 9, v124
    s_lshl_b32 s40, s31, 14
    v_add_u32 v127, s40, v127
    v_add_u32 v126, 0, v120
    v_xor_b32 v126, v126, v125
    v_lshl_add_u32 v2, v126, 4, v127
    v_add_u32 v126, 2, v120
    v_xor_b32 v126, v126, v125
    v_lshl_add_u32 v3, v126, 4, v127
    v_add_u32 v126, 4, v120
    v_xor_b32 v126, v126, v125
    v_lshl_add_u32 v4, v126, 4, v127
    v_add_u32 v126, 6, v120
    v_xor_b32 v126, v126, v125
    v_lshl_add_u32 v5, v126, 4, v127
    v_add_u32 v126, 8, v120
    v_xor_b32 v126, v126, v125
    v_lshl_add_u32 v6, v126, 4, v127
    v_add_u32 v126, 10, v120
    v_xor_b32 v126, v126, v125
    v_lshl_add_u32 v7, v126, 4, v127
    v_add_u32 v126, 12, v120
    v_xor_b32 v126, v126, v125
    v_lshl_add_u32 v8, v126, 4, v127
    v_add_u32 v126, 14, v120
    v_xor_b32 v126, v126, v125
    v_lshl_add_u32 v9, v126, 4, v127
    s_lshl_b32 s40, s28, 3
    v_add_u32 v125, s40, v120
    v_lshlrev_b32 v127, 9, v125
    v_add_u32 v126, 0, v125
    v_and_b32 v126, 15, v126
    v_xor_b32 v126, v126, v124
    v_lshl_add_u32 v14, v126, 4, v127
    v_add_u32 v126, 2, v125
    v_and_b32 v126, 15, v126
    v_xor_b32 v126, v126, v124
    v_lshl_add_u32 v15, v126, 4, v127
    v_add_u32 v126, 4, v125
    v_and_b32 v126, 15, v126
    v_xor_b32 v126, v126, v124
    v_lshl_add_u32 v16, v126, 4, v127
    v_add_u32 v126, 6, v125
    v_and_b32 v126, 15, v126
    v_xor_b32 v126, v126, v124
    v_lshl_add_u32 v17, v126, 4, v127
    v_add_u32 v126, 0, v120
    v_and_b32 v126, 3, v126
    v_lshlrev_b32 v126, 2, v126
    v_xor_b32 v126, v126, v124
    v_lshl_add_u32 v18, v126, 4, v127
    v_add_u32 v126, 2, v120
    v_and_b32 v126, 3, v126
    v_lshlrev_b32 v126, 2, v126
    v_xor_b32 v126, v126, v124
    v_lshl_add_u32 v19, v126, 4, v127
    v_mul_u32_u24 v126, 4, v120
    v_add_u32 v126, v126, v121
    v_mul_u32_u24 v126, 512, v126
    v_xor_b32 v127, 0, v121
    v_lshlrev_b32 v127, 6, v127
    v_add_u32 v126, v126, v127
    v_lshlrev_b32 v127, 5, v123
    v_add_u32 v126, v126, v127
    v_lshlrev_b32 v127, 3, v122
    v_add_u32 v126, v126, v127
    v_add_u32 v10, 65536, v126
    s_lshl_b32 s40, s31, 14
    v_add_u32 v10, s40, v10
    v_mul_u32_u24 v126, 4, v120
    v_add_u32 v126, v126, v121
    v_mul_u32_u24 v126, 512, v126
    v_xor_b32 v127, 1, v121
    v_lshlrev_b32 v127, 6, v127
    v_add_u32 v126, v126, v127
    v_lshlrev_b32 v127, 5, v123
    v_add_u32 v126, v126, v127
    v_lshlrev_b32 v127, 3, v122
    v_add_u32 v126, v126, v127
    v_add_u32 v11, 65536, v126
    s_lshl_b32 s40, s31, 14
    v_add_u32 v11, s40, v11
    v_mul_u32_u24 v126, 4, v120
    v_add_u32 v126, v126, v121
    v_mul_u32_u24 v126, 512, v126
    v_xor_b32 v127, 2, v121
    v_lshlrev_b32 v127, 6, v127
    v_add_u32 v126, v126, v127
    v_lshlrev_b32 v127, 5, v123
    v_add_u32 v126, v126, v127
    v_lshlrev_b32 v127, 3, v122
    v_add_u32 v126, v126, v127
    v_add_u32 v12, 65536, v126
    s_lshl_b32 s40, s31, 14
    v_add_u32 v12, s40, v12
    v_mul_u32_u24 v126, 4, v120
    v_add_u32 v126, v126, v121
    v_mul_u32_u24 v126, 512, v126
    v_xor_b32 v127, 3, v121
    v_lshlrev_b32 v127, 6, v127
    v_add_u32 v126, v126, v127
    v_lshlrev_b32 v127, 5, v123
    v_add_u32 v126, v126, v127
    v_lshlrev_b32 v127, 3, v122
    v_add_u32 v126, v126, v127
    v_add_u32 v13, 65536, v126
    s_lshl_b32 s40, s31, 14
    v_add_u32 v13, s40, v13
    v_mov_b64 v[100:101], 0
    v_mov_b64 v[102:103], 0
    s_nop 1
    v_mfma_f32_32x32x16_bf16 v[128:143], v[100:103], v[100:103], 0
    v_mfma_f32_32x32x16_bf16 a[128:143], v[100:103], v[100:103], 0
    v_mfma_f32_32x32x16_bf16 v[144:159], v[100:103], v[100:103], 0
    v_mfma_f32_32x32x16_bf16 a[144:159], v[100:103], v[100:103], 0
    v_mfma_f32_32x32x16_bf16 v[160:175], v[100:103], v[100:103], 0
    v_mfma_f32_32x32x16_bf16 a[160:175], v[100:103], v[100:103], 0
    v_mfma_f32_32x32x16_bf16 v[176:191], v[100:103], v[100:103], 0
    v_mfma_f32_32x32x16_bf16 a[176:191], v[100:103], v[100:103], 0
    v_mfma_f32_32x32x16_bf16 v[192:207], v[100:103], v[100:103], 0
    v_mfma_f32_32x32x16_bf16 a[192:207], v[100:103], v[100:103], 0
    v_mfma_f32_32x32x16_bf16 v[208:223], v[100:103], v[100:103], 0
    v_mfma_f32_32x32x16_bf16 a[208:223], v[100:103], v[100:103], 0
    v_mfma_f32_32x32x16_bf16 v[224:239], v[100:103], v[100:103], 0
    v_mfma_f32_32x32x16_bf16 a[224:239], v[100:103], v[100:103], 0
    v_mfma_f32_32x32x16_bf16 v[240:255], v[100:103], v[100:103], 0
    v_mfma_f32_32x32x16_bf16 a[240:255], v[100:103], v[100:103], 0
    s_cmp_ge_u32 s2, 168
    s_cbranch_scc1 Ldma_3
    v_cmp_gt_u32 vcc, 56, v1
    s_waitcnt vmcnt(18)
    v_lshlrev_b32 v20, 16, v20
    v_mul_f32 v104, 0xbfb8aa3b, v20
    v_lshlrev_b32 v21, 16, v21
    v_mul_f32 v105, 0xbfb8aa3b, v21
    v_lshlrev_b32 v22, 16, v22
    v_mul_f32 v106, 0xbfb8aa3b, v22
    v_lshlrev_b32 v23, 16, v23
    v_mul_f32 v107, 0xbfb8aa3b, v23
    v_exp_f32 v104, v104
    v_exp_f32 v105, v105
    v_exp_f32 v106, v106
    v_exp_f32 v107, v107
    s_nop 0
    v_add_f32 v104, 1.0, v104
    v_add_f32 v105, 1.0, v105
    v_add_f32 v106, 1.0, v106
    v_add_f32 v107, 1.0, v107
    v_rcp_f32 v104, v104
    v_rcp_f32 v105, v105
    v_rcp_f32 v106, v106
    v_rcp_f32 v107, v107
    s_nop 0
    v_mul_f32 v20, v20, v104
    v_mul_f32 v21, v21, v105
    v_mul_f32 v22, v22, v106
    v_mul_f32 v23, v23, v107
    v_cvt_pk_bf16_f32 v20, 0, v20
    v_cvt_pk_bf16_f32 v21, 0, v21
    v_cvt_pk_bf16_f32 v22, 0, v22
    v_cvt_pk_bf16_f32 v23, 0, v23
    v_cndmask_b32 v20, 0, v20, vcc
    v_cndmask_b32 v21, 0, v21, vcc
    v_cndmask_b32 v22, 0, v22, vcc
    v_cndmask_b32 v23, 0, v23, vcc
    s_waitcnt vmcnt(17)
    v_lshlrev_b32 v104, 16, v24
    v_and_b32 v105, 0xffff0000, v24
    v_mul_f32 v96, v104, v20
    v_mul_f32 v97, v105, v20
    v_lshlrev_b32 v104, 16, v25
    v_and_b32 v105, 0xffff0000, v25
    v_mul_f32 v98, v104, v20
    v_mul_f32 v99, v105, v20
    v_lshlrev_b32 v104, 16, v26
    v_and_b32 v105, 0xffff0000, v26
    v_mul_f32 v100, v104, v20
    v_mul_f32 v101, v105, v20
    v_lshlrev_b32 v104, 16, v27
    v_and_b32 v105, 0xffff0000, v27
    v_mul_f32 v102, v104, v20
    v_mul_f32 v103, v105, v20
    s_waitcnt vmcnt(16)
    v_lshlrev_b32 v104, 16, v28
    v_and_b32 v105, 0xffff0000, v28
    v_fmac_f32 v96, v104, v21
    v_fmac_f32 v97, v105, v21
    v_lshlrev_b32 v104, 16, v29
    v_and_b32 v105, 0xffff0000, v29
    v_fmac_f32 v98, v104, v21
    v_fmac_f32 v99, v105, v21
    v_lshlrev_b32 v104, 16, v30
    v_and_b32 v105, 0xffff0000, v30
    v_fmac_f32 v100, v104, v21
    v_fmac_f32 v101, v105, v21
    v_lshlrev_b32 v104, 16, v31
    v_and_b32 v105, 0xffff0000, v31
    v_fmac_f32 v102, v104, v21
    v_fmac_f32 v103, v105, v21
    s_waitcnt vmcnt(15)
    v_lshlrev_b32 v104, 16, v32
    v_and_b32 v105, 0xffff0000, v32
    v_fmac_f32 v96, v104, v22
    v_fmac_f32 v97, v105, v22
    v_lshlrev_b32 v104, 16, v33
    v_and_b32 v105, 0xffff0000, v33
    v_fmac_f32 v98, v104, v22
    v_fmac_f32 v99, v105, v22
    v_lshlrev_b32 v104, 16, v34
    v_and_b32 v105, 0xffff0000, v34
    v_fmac_f32 v100, v104, v22
    v_fmac_f32 v101, v105, v22
    v_lshlrev_b32 v104, 16, v35
    v_and_b32 v105, 0xffff0000, v35
    v_fmac_f32 v102, v104, v22
    v_fmac_f32 v103, v105, v22
    s_waitcnt vmcnt(14)
    v_lshlrev_b32 v104, 16, v36
    v_and_b32 v105, 0xffff0000, v36
    v_fmac_f32 v96, v104, v23
    v_fmac_f32 v97, v105, v23
    v_lshlrev_b32 v104, 16, v37
    v_and_b32 v105, 0xffff0000, v37
    v_fmac_f32 v98, v104, v23
    v_fmac_f32 v99, v105, v23
    v_lshlrev_b32 v104, 16, v38
    v_and_b32 v105, 0xffff0000, v38
    v_fmac_f32 v100, v104, v23
    v_fmac_f32 v101, v105, v23
    v_lshlrev_b32 v104, 16, v39
    v_and_b32 v105, 0xffff0000, v39
    v_fmac_f32 v102, v104, v23
    v_fmac_f32 v103, v105, v23
    v_lshlrev_b32 v104, 5, v0
    v_add_u32 v104, 98304, v104
    ds_write_b128 v104, v[96:99]
    ds_write_b128 v104, v[100:103] offset:16
    s_waitcnt lgkmcnt(0)
    s_barrier
    s_cmp_lg_u32 s28, 0
    s_cbranch_scc1 Ldma_3
    v_lshrrev_b32 v104, 4, v1
    v_lshlrev_b32 v104, 11, v104
    v_bfe_u32 v105, v1, 3, 1
    v_lshl_add_u32 v104, v105, 5, v104
    v_and_b32 v105, 7, v1
    v_lshl_add_u32 v104, v105, 2, v104
    v_add_u32 v104, 98304, v104
    ds_read_b32 v20, v104 offset:0
    ds_read_b32 v21, v104 offset:64
    ds_read_b32 v22, v104 offset:128
    ds_read_b32 v23, v104 offset:192
    ds_read_b32 v24, v104 offset:256
    ds_read_b32 v25, v104 offset:320
    ds_read_b32 v26, v104 offset:384
    ds_read_b32 v27, v104 offset:448
    ds_read_b32 v28, v104 offset:512
    ds_read_b32 v29, v104 offset:576
    ds_read_b32 v30, v104 offset:640
    ds_read_b32 v31, v104 offset:704
    ds_read_b32 v32, v104 offset:768
    ds_read_b32 v33, v104 offset:832
    s_waitcnt lgkmcnt(0)
    ds_read_b32 v34, v104 offset:896
    ds_read_b32 v35, v104 offset:960
    ds_read_b32 v36, v104 offset:1024
    ds_read_b32 v37, v104 offset:1088
    ds_read_b32 v38, v104 offset:1152
    ds_read_b32 v39, v104 offset:1216
    ds_read_b32 v96, v104 offset:1280
    ds_read_b32 v97, v104 offset:1344
    ds_read_b32 v98, v104 offset:1408
    ds_read_b32 v99, v104 offset:1472
    ds_read_b32 v100, v104 offset:1536
    ds_read_b32 v101, v104 offset:1600
    ds_read_b32 v102, v104 offset:1664
    ds_read_b32 v103, v104 offset:1728
    s_waitcnt lgkmcnt(0)
    v_add_f32 v20, v20, v24
    v_add_f32 v21, v21, v25
    v_add_f32 v22, v22, v26
    v_add_f32 v23, v23, v27
    v_add_f32 v20, v20, v28
    v_add_f32 v21, v21, v29
    v_add_f32 v22, v22, v30
    v_add_f32 v23, v23, v31
    v_add_f32 v20, v20, v32
    v_add_f32 v21, v21, v33
    v_add_f32 v22, v22, v34
    v_add_f32 v23, v23, v35
    v_add_f32 v20, v20, v36
    v_add_f32 v21, v21, v37
    v_add_f32 v22, v22, v38
    v_add_f32 v23, v23, v39
    v_add_f32 v20, v20, v96
    v_add_f32 v21, v21, v97
    v_add_f32 v22, v22, v98
    v_add_f32 v23, v23, v99
    v_add_f32 v20, v20, v100
    v_add_f32 v21, v21, v101
    v_add_f32 v22, v22, v102
    v_add_f32 v23, v23, v103
    v_add_f32 v20, v20, v21
    v_add_f32 v22, v22, v23
    v_add_f32 v20, v20, v22
    ds_swizzle_b32 v21, v20 offset:0x401F
    s_waitcnt lgkmcnt(0)
    v_add_f32 v20, v20, v21
    v_mov_b32 v21, v20
    s_nop 1
    v_permlane32_swap_b32 v20, v21
    s_nop 1
    v_add_f32 v20, v20, v21
    v_cvt_pk_bf16_f32 v20, v20, v20
    v_lshlrev_b32 v21, 1, v1
    s_lshl_b32 s40, s2, 5
    s_add_u32 s40, s40, 0
    s_mov_b64 exec, 0xffff
    buffer_store_short v20, v21, s[24:27], s40 offen sc1
    s_mov_b64 exec, -1
    s_cmp_ge_u32 s2, 56
    s_cbranch_scc1 Ldma_3
    s_waitcnt vmcnt(0)
    s_lshl_b32 s40, s2, 2
    v_mov_b32 v20, 1
    v_mov_b32 v21, 0
    s_mov_b64 exec, 1
    buffer_store_dword v20, v21, s[48:51], s40 offen sc1
    s_mov_b64 exec, -1
Ldma_3:
    s_lshl_b32 s42, s28, 15
    s_lshl_b32 s43, s29, 10
    s_add_u32 s42, s42, s43
    s_mov_b32 s80, s16
    s_mov_b32 s81, s17
    s_mov_b32 s82, s18
    s_mov_b32 s83, s19
    s_mov_b32 s84, 131072
    s_add_u32 m0, s38, 0
    s_nop 0
    buffer_load_dwordx4 v112, s[80:83], s42 offen offset:0 lds
    buffer_load_dwordx4 v113, s[80:83], s42 offen offset:1024 lds
    buffer_load_dwordx4 v114, s[80:83], s42 offen offset:2048 lds
    buffer_load_dwordx4 v115, s[80:83], s42 offen offset:3072 lds
    s_add_u32 s42, s42, s84
    s_add_u32 m0, s38, 16384
    s_nop 0
    buffer_load_dwordx4 v112, s[80:83], s42 offen offset:0 lds
    buffer_load_dwordx4 v113, s[80:83], s42 offen offset:1024 lds
    buffer_load_dwordx4 v114, s[80:83], s42 offen offset:2048 lds
    buffer_load_dwordx4 v115, s[80:83], s42 offen offset:3072 lds
    s_add_u32 s42, s42, s84
    s_add_u32 m0, s38, 32768
    s_nop 0
    buffer_load_dwordx4 v112, s[80:83], s42 offen offset:0 lds
    buffer_load_dwordx4 v113, s[80:83], s42 offen offset:1024 lds
    buffer_load_dwordx4 v114, s[80:83], s42 offen offset:2048 lds
    buffer_load_dwordx4 v115, s[80:83], s42 offen offset:3072 lds
    s_add_u32 s42, s42, s84
    s_add_u32 m0, s38, 49152
    s_nop 0
    buffer_load_dwordx4 v112, s[80:83], s42 offen offset:0 lds
    buffer_load_dwordx4 v113, s[80:83], s42 offen offset:1024 lds
    buffer_load_dwordx4 v114, s[80:83], s42 offen offset:2048 lds
    buffer_load_dwordx4 v115, s[80:83], s42 offen offset:3072 lds
    s_add_u32 s42, s42, s84
    s_add_u32 m0, s38, 65536
    s_nop 0
    buffer_load_dwordx4 v112, s[80:83], s42 offen offset:0 lds
    buffer_load_dwordx4 v113, s[80:83], s42 offen offset:1024 lds
    buffer_load_dwordx4 v114, s[80:83], s42 offen offset:2048 lds
    buffer_load_dwordx4 v115, s[80:83], s42 offen offset:3072 lds
    s_add_u32 s42, s42, s84
    s_mul_i32 s40, s30, 14
    s_lshl_b32 s41, s28, 2
    s_add_u32 s40, s40, s41
    s_lshl_b32 s40, s40, 13
    s_lshl_b32 s41, s29, 10
    s_add_u32 s40, s40, s41
    v_lshlrev_b32 v126, 4, v1
    buffer_load_dwordx4 a[0:3], v126, s[16:19], s40 offen
    s_add_u32 s40, s40, 8192
    buffer_load_dwordx4 a[4:7], v126, s[16:19], s40 offen
    s_add_u32 s40, s40, 8192
    buffer_load_dwordx4 a[8:11], v126, s[16:19], s40 offen
    s_add_u32 s40, s40, 8192
    buffer_load_dwordx4 a[12:15], v126, s[16:19], s40 offen
    s_add_u32 s40, s40, 8192
    s_lshl_b32 s40, s2, 2
    s_add_u32 s40, s40, s28
    s_lshl_b32 s40, s40, 11
    v_lshlrev_b32 v126, 4, v1
    buffer_load_dwordx4 a[32:35], v126, s[64:67], s40 offen offset:0
    buffer_load_dwordx4 a[36:39], v126, s[64:67], s40 offen offset:1024
    buffer_load_dwordx4 a[40:43], v126, s[68:71], s40 offen offset:0
    buffer_load_dwordx4 a[44:47], v126, s[68:71], s40 offen offset:1024
    buffer_load_dwordx4 a[48:51], v126, s[72:75], s40 offen offset:0
    buffer_load_dwordx4 a[52:55], v126, s[72:75], s40 offen offset:1024
    s_add_u32 s54, s38, 81920
    s_mov_b32 s55, s38
    s_add_u32 s87, s38, 16384
    s_mov_b32 s56, 0
    s_mov_b32 s57, 32768
    s_mov_b32 s86, 65536
    s_waitcnt vmcnt(30)
    v_dot2_f32_bf16 v100, v40, s92, 0
    v_dot2_f32_bf16 v104, v40, v40, 0
    v_dot2_f32_bf16 v101, v41, s92, 0
    v_dot2_f32_bf16 v105, v41, v41, 0
    v_dot2_f32_bf16 v102, v42, s92, 0
    v_dot2_f32_bf16 v106, v42, v42, 0
    v_dot2_f32_bf16 v103, v43, s92, 0
    v_dot2_f32_bf16 v107, v43, v43, 0
    v_dot2_f32_bf16 v100, v44, s92, v100
    v_dot2_f32_bf16 v104, v44, v44, v104
    v_dot2_f32_bf16 v101, v45, s92, v101
    v_dot2_f32_bf16 v105, v45, v45, v105
    v_dot2_f32_bf16 v102, v46, s92, v102
    v_dot2_f32_bf16 v106, v46, v46, v106
    v_dot2_f32_bf16 v103, v47, s92, v103
    v_dot2_f32_bf16 v107, v47, v47, v107
    v_dot2_f32_bf16 v100, v48, s92, v100
    v_dot2_f32_bf16 v104, v48, v48, v104
    v_dot2_f32_bf16 v101, v49, s92, v101
    v_dot2_f32_bf16 v105, v49, v49, v105
    v_dot2_f32_bf16 v102, v50, s92, v102
    v_dot2_f32_bf16 v106, v50, v50, v106
    v_dot2_f32_bf16 v103, v51, s92, v103
    v_dot2_f32_bf16 v107, v51, v51, v107
    v_dot2_f32_bf16 v100, v52, s92, v100
    v_dot2_f32_bf16 v104, v52, v52, v104
    v_dot2_f32_bf16 v101, v53, s92, v101
    v_dot2_f32_bf16 v105, v53, v53, v105
    v_dot2_f32_bf16 v102, v54, s92, v102
    v_dot2_f32_bf16 v106, v54, v54, v106
    v_dot2_f32_bf16 v103, v55, s92, v103
    v_dot2_f32_bf16 v107, v55, v55, v107
    v_dot2_f32_bf16 v100, v56, s92, v100
    v_dot2_f32_bf16 v104, v56, v56, v104
    v_dot2_f32_bf16 v101, v57, s92, v101
    v_dot2_f32_bf16 v105, v57, v57, v105
    v_dot2_f32_bf16 v102, v58, s92, v102
    v_dot2_f32_bf16 v106, v58, v58, v106
    v_dot2_f32_bf16 v103, v59, s92, v103
    v_dot2_f32_bf16 v107, v59, v59, v107
    v_dot2_f32_bf16 v100, v60, s92, v100
    v_dot2_f32_bf16 v104, v60, v60, v104
    v_dot2_f32_bf16 v101, v61, s92, v101
    v_dot2_f32_bf16 v105, v61, v61, v105
    v_dot2_f32_bf16 v102, v62, s92, v102
    v_dot2_f32_bf16 v106, v62, v62, v106
    v_dot2_f32_bf16 v103, v63, s92, v103
    v_dot2_f32_bf16 v107, v63, v63, v107
    v_dot2_f32_bf16 v100, v64, s92, v100
    v_dot2_f32_bf16 v104, v64, v64, v104
    v_dot2_f32_bf16 v101, v65, s92, v101
    v_dot2_f32_bf16 v105, v65, v65, v105
    v_dot2_f32_bf16 v102, v66, s92, v102
    v_dot2_f32_bf16 v106, v66, v66, v106
    v_dot2_f32_bf16 v103, v67, s92, v103
    v_dot2_f32_bf16 v107, v67, v67, v107
    v_dot2_f32_bf16 v100, v68, s92, v100
    v_dot2_f32_bf16 v104, v68, v68, v104
    v_dot2_f32_bf16 v101, v69, s92, v101
    v_dot2_f32_bf16 v105, v69, v69, v105
    v_dot2_f32_bf16 v102, v70, s92, v102
    v_dot2_f32_bf16 v106, v70, v70, v106
    v_dot2_f32_bf16 v103, v71, s92, v103
    v_dot2_f32_bf16 v107, v71, v71, v107
    v_dot2_f32_bf16 v100, v72, s92, v100
    v_dot2_f32_bf16 v104, v72, v72, v104
    v_dot2_f32_bf16 v101, v73, s92, v101
    v_dot2_f32_bf16 v105, v73, v73, v105
    v_dot2_f32_bf16 v102, v74, s92, v102
    v_dot2_f32_bf16 v106, v74, v74, v106
    v_dot2_f32_bf16 v103, v75, s92, v103
    v_dot2_f32_bf16 v107, v75, v75, v107
    v_dot2_f32_bf16 v100, v76, s92, v100
    v_dot2_f32_bf16 v104, v76, v76, v104
    v_dot2_f32_bf16 v101, v77, s92, v101
    v_dot2_f32_bf16 v105, v77, v77, v105
    v_dot2_f32_bf16 v102, v78, s92, v102
    v_dot2_f32_bf16 v106, v78, v78, v106
    v_dot2_f32_bf16 v103, v79, s92, v103
    v_dot2_f32_bf16 v107, v79, v79, v107
    v_dot2_f32_bf16 v100, v80, s92, v100
    v_dot2_f32_bf16 v104, v80, v80, v104
    v_dot2_f32_bf16 v101, v81, s92, v101
    v_dot2_f32_bf16 v105, v81, v81, v105
    v_dot2_f32_bf16 v102, v82, s92, v102
    v_dot2_f32_bf16 v106, v82, v82, v106
    v_dot2_f32_bf16 v103, v83, s92, v103
    v_dot2_f32_bf16 v107, v83, v83, v107
    v_dot2_f32_bf16 v100, v84, s92, v100
    v_dot2_f32_bf16 v104, v84, v84, v104
    v_dot2_f32_bf16 v101, v85, s92, v101
    v_dot2_f32_bf16 v105, v85, v85, v105
    v_dot2_f32_bf16 v102, v86, s92, v102
    v_dot2_f32_bf16 v106, v86, v86, v106
    v_dot2_f32_bf16 v103, v87, s92, v103
    v_dot2_f32_bf16 v107, v87, v87, v107
    v_dot2_f32_bf16 v100, v88, s92, v100
    v_dot2_f32_bf16 v104, v88, v88, v104
    v_dot2_f32_bf16 v101, v89, s92, v101
    v_dot2_f32_bf16 v105, v89, v89, v105
    v_dot2_f32_bf16 v102, v90, s92, v102
    v_dot2_f32_bf16 v106, v90, v90, v106
    v_dot2_f32_bf16 v103, v91, s92, v103
    v_dot2_f32_bf16 v107, v91, v91, v107
    v_dot2_f32_bf16 v100, v92, s92, v100
    v_dot2_f32_bf16 v104, v92, v92, v104
    v_dot2_f32_bf16 v101, v93, s92, v101
    v_dot2_f32_bf16 v105, v93, v93, v105
    v_dot2_f32_bf16 v102, v94, s92, v102
    v_dot2_f32_bf16 v106, v94, v94, v106
    v_dot2_f32_bf16 v103, v95, s92, v103
    v_dot2_f32_bf16 v107, v95, v95, v107
    s_lshl_b32 s40, s28, 8
    s_add_u32 s40, s40, 159744
    v_lshlrev_b32 v110, 3, v124
    v_add_u32 v111, s40, v110
    v_xor_b32 v110, 512, v111
    v_add_f32 v100, v100, v101
    v_add_f32 v102, v102, v103
    v_add_f32 v104, v104, v105
    v_add_f32 v106, v106, v107
    v_add_f32 v100, v100, v102
    v_add_f32 v101, v104, v106
    v_mov_b32 v102, v100
    v_mov_b32 v103, v101
    s_nop 1
    v_permlane32_swap_b32 v100, v102
    v_permlane32_swap_b32 v101, v103
    s_nop 1
    v_add_f32 v100, v100, v102
    v_add_f32 v101, v101, v103
    ds_write_b64 v111, v[100:101]
    s_waitcnt lgkmcnt(0)
    s_barrier
    ds_read_b64 v[102:103], v110
    s_mul_i32 s40, s32, 28672
    s_add_u32 s40, s40, 98304
    v_lshlrev_b32 v108, 4, v1
    v_add_u32 v108, s40, v108
    s_mul_i32 s40, s31, 14336
    v_add_u32 v110, s40, v108
    v_lshlrev_b32 v109, 5, v120
    v_add_u32 v109, 155648, v109
    s_waitcnt lgkmcnt(0)
    v_add_f32 v100, v100, v102
    v_add_f32 v101, v101, v103
    v_mul_f32 v100, 0x3b124925, v100
    v_mul_f32 v101, 0x3b124925, v101
    v_fma_f32 v101, -v100, v100, v101
    v_max_f32 v101, 0, v101
    v_cvt_pk_bf16_f32 v100, 0, v100
    v_cvt_pk_bf16_f32 v101, 0, v101
    v_add_f32 v101, 0x3727c5ac, v101
    v_cvt_pk_bf16_f32 v101, 0, v101
    v_sqrt_f32 v101, v101
    s_nop 0
    v_cvt_pk_bf16_f32 v101, 0, v101
    v_rcp_f32 v102, v101
    s_nop 0
    v_mov_b32 v103, v102
    v_dot2_f32_bf16 v24, v40, s90, v100 neg_lo:[0,0,1]
    v_dot2_f32_bf16 v25, v40, s91, v100 neg_lo:[0,0,1]
    v_dot2_f32_bf16 v26, v41, s90, v100 neg_lo:[0,0,1]
    v_dot2_f32_bf16 v27, v41, s91, v100 neg_lo:[0,0,1]
    v_dot2_f32_bf16 v28, v42, s90, v100 neg_lo:[0,0,1]
    v_dot2_f32_bf16 v29, v42, s91, v100 neg_lo:[0,0,1]
    v_dot2_f32_bf16 v30, v43, s90, v100 neg_lo:[0,0,1]
    v_dot2_f32_bf16 v31, v43, s91, v100 neg_lo:[0,0,1]
    v_cvt_pk_bf16_f32 v24, 0, v24
    v_cvt_pk_bf16_f32 v25, 0, v25
    v_cvt_pk_bf16_f32 v26, 0, v26
    v_cvt_pk_bf16_f32 v27, 0, v27
    v_cvt_pk_bf16_f32 v28, 0, v28
    v_cvt_pk_bf16_f32 v29, 0, v29
    v_cvt_pk_bf16_f32 v30, 0, v30
    v_cvt_pk_bf16_f32 v31, 0, v31
    v_pk_mul_f32 v[24:25], v[24:25], v[102:103]
    v_pk_mul_f32 v[26:27], v[26:27], v[102:103]
    v_pk_mul_f32 v[28:29], v[28:29], v[102:103]
    v_pk_mul_f32 v[30:31], v[30:31], v[102:103]
    v_cvt_pk_bf16_f32 v40, v24, v25
    v_cvt_pk_bf16_f32 v41, v26, v27
    v_cvt_pk_bf16_f32 v42, v28, v29
    v_cvt_pk_bf16_f32 v43, v30, v31
    ds_write_b128 v110, v[40:43] offset:0
    v_dot2_f32_bf16 v32, v44, s90, v100 neg_lo:[0,0,1]
    v_dot2_f32_bf16 v33, v44, s91, v100 neg_lo:[0,0,1]
    v_dot2_f32_bf16 v34, v45, s90, v100 neg_lo:[0,0,1]
    v_dot2_f32_bf16 v35, v45, s91, v100 neg_lo:[0,0,1]
    v_dot2_f32_bf16 v36, v46, s90, v100 neg_lo:[0,0,1]
    v_dot2_f32_bf16 v37, v46, s91, v100 neg_lo:[0,0,1]
    v_dot2_f32_bf16 v38, v47, s90, v100 neg_lo:[0,0,1]
    v_dot2_f32_bf16 v39, v47, s91, v100 neg_lo:[0,0,1]
    v_cvt_pk_bf16_f32 v32, 0, v32
    v_cvt_pk_bf16_f32 v33, 0, v33
    v_cvt_pk_bf16_f32 v34, 0, v34
    v_cvt_pk_bf16_f32 v35, 0, v35
    v_cvt_pk_bf16_f32 v36, 0, v36
    v_cvt_pk_bf16_f32 v37, 0, v37
    v_cvt_pk_bf16_f32 v38, 0, v38
    v_cvt_pk_bf16_f32 v39, 0, v39
    v_pk_mul_f32 v[32:33], v[32:33], v[102:103]
    v_pk_mul_f32 v[34:35], v[34:35], v[102:103]
    v_pk_mul_f32 v[36:37], v[36:37], v[102:103]
    v_pk_mul_f32 v[38:39], v[38:39], v[102:103]
    v_cvt_pk_bf16_f32 v44, v32, v33
    v_cvt_pk_bf16_f32 v45, v34, v35
    v_cvt_pk_bf16_f32 v46, v36, v37
    v_cvt_pk_bf16_f32 v47, v38, v39
    ds_write_b128 v110, v[44:47] offset:1024
    v_dot2_f32_bf16 v24, v48, s90, v100 neg_lo:[0,0,1]
    v_dot2_f32_bf16 v25, v48, s91, v100 neg_lo:[0,0,1]
    v_dot2_f32_bf16 v26, v49, s90, v100 neg_lo:[0,0,1]
    v_dot2_f32_bf16 v27, v49, s91, v100 neg_lo:[0,0,1]
    v_dot2_f32_bf16 v28, v50, s90, v100 neg_lo:[0,0,1]
    v_dot2_f32_bf16 v29, v50, s91, v100 neg_lo:[0,0,1]
    v_dot2_f32_bf16 v30, v51, s90, v100 neg_lo:[0,0,1]
    v_dot2_f32_bf16 v31, v51, s91, v100 neg_lo:[0,0,1]
    v_cvt_pk_bf16_f32 v24, 0, v24
    v_cvt_pk_bf16_f32 v25, 0, v25
    v_cvt_pk_bf16_f32 v26, 0, v26
    v_cvt_pk_bf16_f32 v27, 0, v27
    v_cvt_pk_bf16_f32 v28, 0, v28
    v_cvt_pk_bf16_f32 v29, 0, v29
    v_cvt_pk_bf16_f32 v30, 0, v30
    v_cvt_pk_bf16_f32 v31, 0, v31
    v_pk_mul_f32 v[24:25], v[24:25], v[102:103]
    v_pk_mul_f32 v[26:27], v[26:27], v[102:103]
    v_pk_mul_f32 v[28:29], v[28:29], v[102:103]
    v_pk_mul_f32 v[30:31], v[30:31], v[102:103]
    v_cvt_pk_bf16_f32 v48, v24, v25
    v_cvt_pk_bf16_f32 v49, v26, v27
    v_cvt_pk_bf16_f32 v50, v28, v29
    v_cvt_pk_bf16_f32 v51, v30, v31
    ds_write_b128 v110, v[48:51] offset:2048
    v_dot2_f32_bf16 v32, v52, s90, v100 neg_lo:[0,0,1]
    v_dot2_f32_bf16 v33, v52, s91, v100 neg_lo:[0,0,1]
    v_dot2_f32_bf16 v34, v53, s90, v100 neg_lo:[0,0,1]
    v_dot2_f32_bf16 v35, v53, s91, v100 neg_lo:[0,0,1]
    v_dot2_f32_bf16 v36, v54, s90, v100 neg_lo:[0,0,1]
    v_dot2_f32_bf16 v37, v54, s91, v100 neg_lo:[0,0,1]
    v_dot2_f32_bf16 v38, v55, s90, v100 neg_lo:[0,0,1]
    v_dot2_f32_bf16 v39, v55, s91, v100 neg_lo:[0,0,1]
    v_cvt_pk_bf16_f32 v32, 0, v32
    v_cvt_pk_bf16_f32 v33, 0, v33
    v_cvt_pk_bf16_f32 v34, 0, v34
    v_cvt_pk_bf16_f32 v35, 0, v35
    v_cvt_pk_bf16_f32 v36, 0, v36
    v_cvt_pk_bf16_f32 v37, 0, v37
    v_cvt_pk_bf16_f32 v38, 0, v38
    v_cvt_pk_bf16_f32 v39, 0, v39
    v_pk_mul_f32 v[32:33], v[32:33], v[102:103]
    v_pk_mul_f32 v[34:35], v[34:35], v[102:103]
    v_pk_mul_f32 v[36:37], v[36:37], v[102:103]
    v_pk_mul_f32 v[38:39], v[38:39], v[102:103]
    v_cvt_pk_bf16_f32 v52, v32, v33
    v_cvt_pk_bf16_f32 v53, v34, v35
    v_cvt_pk_bf16_f32 v54, v36, v37
    v_cvt_pk_bf16_f32 v55, v38, v39
    ds_write_b128 v110, v[52:55] offset:3072
    v_dot2_f32_bf16 v24, v56, s90, v100 neg_lo:[0,0,1]
    v_dot2_f32_bf16 v25, v56, s91, v100 neg_lo:[0,0,1]
    v_dot2_f32_bf16 v26, v57, s90, v100 neg_lo:[0,0,1]
    v_dot2_f32_bf16 v27, v57, s91, v100 neg_lo:[0,0,1]
    v_dot2_f32_bf16 v28, v58, s90, v100 neg_lo:[0,0,1]
    v_dot2_f32_bf16 v29, v58, s91, v100 neg_lo:[0,0,1]
    v_dot2_f32_bf16 v30, v59, s90, v100 neg_lo:[0,0,1]
    v_dot2_f32_bf16 v31, v59, s91, v100 neg_lo:[0,0,1]
    v_cvt_pk_bf16_f32 v24, 0, v24
    v_cvt_pk_bf16_f32 v25, 0, v25
    v_cvt_pk_bf16_f32 v26, 0, v26
    v_cvt_pk_bf16_f32 v27, 0, v27
    v_cvt_pk_bf16_f32 v28, 0, v28
    v_cvt_pk_bf16_f32 v29, 0, v29
    v_cvt_pk_bf16_f32 v30, 0, v30
    v_cvt_pk_bf16_f32 v31, 0, v31
    v_pk_mul_f32 v[24:25], v[24:25], v[102:103]
    v_pk_mul_f32 v[26:27], v[26:27], v[102:103]
    v_pk_mul_f32 v[28:29], v[28:29], v[102:103]
    v_pk_mul_f32 v[30:31], v[30:31], v[102:103]
    v_cvt_pk_bf16_f32 v56, v24, v25
    v_cvt_pk_bf16_f32 v57, v26, v27
    v_cvt_pk_bf16_f32 v58, v28, v29
    v_cvt_pk_bf16_f32 v59, v30, v31
    ds_write_b128 v110, v[56:59] offset:4096
    v_dot2_f32_bf16 v32, v60, s90, v100 neg_lo:[0,0,1]
    v_dot2_f32_bf16 v33, v60, s91, v100 neg_lo:[0,0,1]
    v_dot2_f32_bf16 v34, v61, s90, v100 neg_lo:[0,0,1]
    v_dot2_f32_bf16 v35, v61, s91, v100 neg_lo:[0,0,1]
    v_dot2_f32_bf16 v36, v62, s90, v100 neg_lo:[0,0,1]
    v_dot2_f32_bf16 v37, v62, s91, v100 neg_lo:[0,0,1]
    v_dot2_f32_bf16 v38, v63, s90, v100 neg_lo:[0,0,1]
    v_dot2_f32_bf16 v39, v63, s91, v100 neg_lo:[0,0,1]
    v_cvt_pk_bf16_f32 v32, 0, v32
    v_cvt_pk_bf16_f32 v33, 0, v33
    v_cvt_pk_bf16_f32 v34, 0, v34
    v_cvt_pk_bf16_f32 v35, 0, v35
    v_cvt_pk_bf16_f32 v36, 0, v36
    v_cvt_pk_bf16_f32 v37, 0, v37
    v_cvt_pk_bf16_f32 v38, 0, v38
    v_cvt_pk_bf16_f32 v39, 0, v39
    v_pk_mul_f32 v[32:33], v[32:33], v[102:103]
    v_pk_mul_f32 v[34:35], v[34:35], v[102:103]
    v_pk_mul_f32 v[36:37], v[36:37], v[102:103]
    v_pk_mul_f32 v[38:39], v[38:39], v[102:103]
    v_cvt_pk_bf16_f32 v60, v32, v33
    v_cvt_pk_bf16_f32 v61, v34, v35
    v_cvt_pk_bf16_f32 v62, v36, v37
    v_cvt_pk_bf16_f32 v63, v38, v39
    ds_write_b128 v110, v[60:63] offset:5120
    v_dot2_f32_bf16 v24, v64, s90, v100 neg_lo:[0,0,1]
    v_dot2_f32_bf16 v25, v64, s91, v100 neg_lo:[0,0,1]
    v_dot2_f32_bf16 v26, v65, s90, v100 neg_lo:[0,0,1]
    v_dot2_f32_bf16 v27, v65, s91, v100 neg_lo:[0,0,1]
    v_dot2_f32_bf16 v28, v66, s90, v100 neg_lo:[0,0,1]
    v_dot2_f32_bf16 v29, v66, s91, v100 neg_lo:[0,0,1]
    v_dot2_f32_bf16 v30, v67, s90, v100 neg_lo:[0,0,1]
    v_dot2_f32_bf16 v31, v67, s91, v100 neg_lo:[0,0,1]
    v_cvt_pk_bf16_f32 v24, 0, v24
    v_cvt_pk_bf16_f32 v25, 0, v25
    v_cvt_pk_bf16_f32 v26, 0, v26
    v_cvt_pk_bf16_f32 v27, 0, v27
    v_cvt_pk_bf16_f32 v28, 0, v28
    v_cvt_pk_bf16_f32 v29, 0, v29
    v_cvt_pk_bf16_f32 v30, 0, v30
    v_cvt_pk_bf16_f32 v31, 0, v31
    v_pk_mul_f32 v[24:25], v[24:25], v[102:103]
    v_pk_mul_f32 v[26:27], v[26:27], v[102:103]
    v_pk_mul_f32 v[28:29], v[28:29], v[102:103]
    v_pk_mul_f32 v[30:31], v[30:31], v[102:103]
    v_cvt_pk_bf16_f32 v64, v24, v25
    v_cvt_pk_bf16_f32 v65, v26, v27
    v_cvt_pk_bf16_f32 v66, v28, v29
    v_cvt_pk_bf16_f32 v67, v30, v31
    ds_write_b128 v110, v[64:67] offset:6144
    v_dot2_f32_bf16 v32, v68, s90, v100 neg_lo:[0,0,1]
    v_dot2_f32_bf16 v33, v68, s91, v100 neg_lo:[0,0,1]
    v_dot2_f32_bf16 v34, v69, s90, v100 neg_lo:[0,0,1]
    v_dot2_f32_bf16 v35, v69, s91, v100 neg_lo:[0,0,1]
    v_dot2_f32_bf16 v36, v70, s90, v100 neg_lo:[0,0,1]
    v_dot2_f32_bf16 v37, v70, s91, v100 neg_lo:[0,0,1]
    v_dot2_f32_bf16 v38, v71, s90, v100 neg_lo:[0,0,1]
    v_dot2_f32_bf16 v39, v71, s91, v100 neg_lo:[0,0,1]
    v_cvt_pk_bf16_f32 v32, 0, v32
    v_cvt_pk_bf16_f32 v33, 0, v33
    v_cvt_pk_bf16_f32 v34, 0, v34
    v_cvt_pk_bf16_f32 v35, 0, v35
    v_cvt_pk_bf16_f32 v36, 0, v36
    v_cvt_pk_bf16_f32 v37, 0, v37
    v_cvt_pk_bf16_f32 v38, 0, v38
    v_cvt_pk_bf16_f32 v39, 0, v39
    v_pk_mul_f32 v[32:33], v[32:33], v[102:103]
    v_pk_mul_f32 v[34:35], v[34:35], v[102:103]
    v_pk_mul_f32 v[36:37], v[36:37], v[102:103]
    v_pk_mul_f32 v[38:39], v[38:39], v[102:103]
    v_cvt_pk_bf16_f32 v68, v32, v33
    v_cvt_pk_bf16_f32 v69, v34, v35
    v_cvt_pk_bf16_f32 v70, v36, v37
    v_cvt_pk_bf16_f32 v71, v38, v39
    ds_write_b128 v110, v[68:71] offset:7168
    v_dot2_f32_bf16 v24, v72, s90, v100 neg_lo:[0,0,1]
    v_dot2_f32_bf16 v25, v72, s91, v100 neg_lo:[0,0,1]
    v_dot2_f32_bf16 v26, v73, s90, v100 neg_lo:[0,0,1]
    v_dot2_f32_bf16 v27, v73, s91, v100 neg_lo:[0,0,1]
    v_dot2_f32_bf16 v28, v74, s90, v100 neg_lo:[0,0,1]
    v_dot2_f32_bf16 v29, v74, s91, v100 neg_lo:[0,0,1]
    v_dot2_f32_bf16 v30, v75, s90, v100 neg_lo:[0,0,1]
    v_dot2_f32_bf16 v31, v75, s91, v100 neg_lo:[0,0,1]
    v_cvt_pk_bf16_f32 v24, 0, v24
    v_cvt_pk_bf16_f32 v25, 0, v25
    v_cvt_pk_bf16_f32 v26, 0, v26
    v_cvt_pk_bf16_f32 v27, 0, v27
    v_cvt_pk_bf16_f32 v28, 0, v28
    v_cvt_pk_bf16_f32 v29, 0, v29
    v_cvt_pk_bf16_f32 v30, 0, v30
    v_cvt_pk_bf16_f32 v31, 0, v31
    v_pk_mul_f32 v[24:25], v[24:25], v[102:103]
    v_pk_mul_f32 v[26:27], v[26:27], v[102:103]
    v_pk_mul_f32 v[28:29], v[28:29], v[102:103]
    v_pk_mul_f32 v[30:31], v[30:31], v[102:103]
    v_cvt_pk_bf16_f32 v72, v24, v25
    v_cvt_pk_bf16_f32 v73, v26, v27
    v_cvt_pk_bf16_f32 v74, v28, v29
    v_cvt_pk_bf16_f32 v75, v30, v31
    ds_write_b128 v110, v[72:75] offset:8192
    v_dot2_f32_bf16 v32, v76, s90, v100 neg_lo:[0,0,1]
    v_dot2_f32_bf16 v33, v76, s91, v100 neg_lo:[0,0,1]
    v_dot2_f32_bf16 v34, v77, s90, v100 neg_lo:[0,0,1]
    v_dot2_f32_bf16 v35, v77, s91, v100 neg_lo:[0,0,1]
    v_dot2_f32_bf16 v36, v78, s90, v100 neg_lo:[0,0,1]
    v_dot2_f32_bf16 v37, v78, s91, v100 neg_lo:[0,0,1]
    v_dot2_f32_bf16 v38, v79, s90, v100 neg_lo:[0,0,1]
    v_dot2_f32_bf16 v39, v79, s91, v100 neg_lo:[0,0,1]
    v_cvt_pk_bf16_f32 v32, 0, v32
    v_cvt_pk_bf16_f32 v33, 0, v33
    v_cvt_pk_bf16_f32 v34, 0, v34
    v_cvt_pk_bf16_f32 v35, 0, v35
    v_cvt_pk_bf16_f32 v36, 0, v36
    v_cvt_pk_bf16_f32 v37, 0, v37
    v_cvt_pk_bf16_f32 v38, 0, v38
    v_cvt_pk_bf16_f32 v39, 0, v39
    v_pk_mul_f32 v[32:33], v[32:33], v[102:103]
    v_pk_mul_f32 v[34:35], v[34:35], v[102:103]
    v_pk_mul_f32 v[36:37], v[36:37], v[102:103]
    v_pk_mul_f32 v[38:39], v[38:39], v[102:103]
    v_cvt_pk_bf16_f32 v76, v32, v33
    v_cvt_pk_bf16_f32 v77, v34, v35
    v_cvt_pk_bf16_f32 v78, v36, v37
    v_cvt_pk_bf16_f32 v79, v38, v39
    ds_write_b128 v110, v[76:79] offset:9216
    v_dot2_f32_bf16 v24, v80, s90, v100 neg_lo:[0,0,1]
    v_dot2_f32_bf16 v25, v80, s91, v100 neg_lo:[0,0,1]
    v_dot2_f32_bf16 v26, v81, s90, v100 neg_lo:[0,0,1]
    v_dot2_f32_bf16 v27, v81, s91, v100 neg_lo:[0,0,1]
    v_dot2_f32_bf16 v28, v82, s90, v100 neg_lo:[0,0,1]
    v_dot2_f32_bf16 v29, v82, s91, v100 neg_lo:[0,0,1]
    v_dot2_f32_bf16 v30, v83, s90, v100 neg_lo:[0,0,1]
    v_dot2_f32_bf16 v31, v83, s91, v100 neg_lo:[0,0,1]
    v_cvt_pk_bf16_f32 v24, 0, v24
    v_cvt_pk_bf16_f32 v25, 0, v25
    v_cvt_pk_bf16_f32 v26, 0, v26
    v_cvt_pk_bf16_f32 v27, 0, v27
    v_cvt_pk_bf16_f32 v28, 0, v28
    v_cvt_pk_bf16_f32 v29, 0, v29
    v_cvt_pk_bf16_f32 v30, 0, v30
    v_cvt_pk_bf16_f32 v31, 0, v31
    v_pk_mul_f32 v[24:25], v[24:25], v[102:103]
    v_pk_mul_f32 v[26:27], v[26:27], v[102:103]
    v_pk_mul_f32 v[28:29], v[28:29], v[102:103]
    v_pk_mul_f32 v[30:31], v[30:31], v[102:103]
    v_cvt_pk_bf16_f32 v80, v24, v25
    v_cvt_pk_bf16_f32 v81, v26, v27
    v_cvt_pk_bf16_f32 v82, v28, v29
    v_cvt_pk_bf16_f32 v83, v30, v31
    ds_write_b128 v110, v[80:83] offset:10240
    v_dot2_f32_bf16 v32, v84, s90, v100 neg_lo:[0,0,1]
    v_dot2_f32_bf16 v33, v84, s91, v100 neg_lo:[0,0,1]
    v_dot2_f32_bf16 v34, v85, s90, v100 neg_lo:[0,0,1]
    v_dot2_f32_bf16 v35, v85, s91, v100 neg_lo:[0,0,1]
    v_dot2_f32_bf16 v36, v86, s90, v100 neg_lo:[0,0,1]
    v_dot2_f32_bf16 v37, v86, s91, v100 neg_lo:[0,0,1]
    v_dot2_f32_bf16 v38, v87, s90, v100 neg_lo:[0,0,1]
    v_dot2_f32_bf16 v39, v87, s91, v100 neg_lo:[0,0,1]
    v_cvt_pk_bf16_f32 v32, 0, v32
    v_cvt_pk_bf16_f32 v33, 0, v33
    v_cvt_pk_bf16_f32 v34, 0, v34
    v_cvt_pk_bf16_f32 v35, 0, v35
    v_cvt_pk_bf16_f32 v36, 0, v36
    v_cvt_pk_bf16_f32 v37, 0, v37
    v_cvt_pk_bf16_f32 v38, 0, v38
    v_cvt_pk_bf16_f32 v39, 0, v39
    v_pk_mul_f32 v[32:33], v[32:33], v[102:103]
    v_pk_mul_f32 v[34:35], v[34:35], v[102:103]
    v_pk_mul_f32 v[36:37], v[36:37], v[102:103]
    v_pk_mul_f32 v[38:39], v[38:39], v[102:103]
    v_cvt_pk_bf16_f32 v84, v32, v33
    v_cvt_pk_bf16_f32 v85, v34, v35
    v_cvt_pk_bf16_f32 v86, v36, v37
    v_cvt_pk_bf16_f32 v87, v38, v39
    ds_write_b128 v110, v[84:87] offset:11264
    v_dot2_f32_bf16 v24, v88, s90, v100 neg_lo:[0,0,1]
    v_dot2_f32_bf16 v25, v88, s91, v100 neg_lo:[0,0,1]
    v_dot2_f32_bf16 v26, v89, s90, v100 neg_lo:[0,0,1]
    v_dot2_f32_bf16 v27, v89, s91, v100 neg_lo:[0,0,1]
    v_dot2_f32_bf16 v28, v90, s90, v100 neg_lo:[0,0,1]
    v_dot2_f32_bf16 v29, v90, s91, v100 neg_lo:[0,0,1]
    v_dot2_f32_bf16 v30, v91, s90, v100 neg_lo:[0,0,1]
    v_dot2_f32_bf16 v31, v91, s91, v100 neg_lo:[0,0,1]
    v_cvt_pk_bf16_f32 v24, 0, v24
    v_cvt_pk_bf16_f32 v25, 0, v25
    v_cvt_pk_bf16_f32 v26, 0, v26
    v_cvt_pk_bf16_f32 v27, 0, v27
    v_cvt_pk_bf16_f32 v28, 0, v28
    v_cvt_pk_bf16_f32 v29, 0, v29
    v_cvt_pk_bf16_f32 v30, 0, v30
    v_cvt_pk_bf16_f32 v31, 0, v31
    v_pk_mul_f32 v[24:25], v[24:25], v[102:103]
    v_pk_mul_f32 v[26:27], v[26:27], v[102:103]
    v_pk_mul_f32 v[28:29], v[28:29], v[102:103]
    v_pk_mul_f32 v[30:31], v[30:31], v[102:103]
    v_cvt_pk_bf16_f32 v88, v24, v25
    v_cvt_pk_bf16_f32 v89, v26, v27
    v_cvt_pk_bf16_f32 v90, v28, v29
    v_cvt_pk_bf16_f32 v91, v30, v31
    ds_write_b128 v110, v[88:91] offset:12288
    v_dot2_f32_bf16 v32, v92, s90, v100 neg_lo:[0,0,1]
    v_dot2_f32_bf16 v33, v92, s91, v100 neg_lo:[0,0,1]
    v_dot2_f32_bf16 v34, v93, s90, v100 neg_lo:[0,0,1]
    v_dot2_f32_bf16 v35, v93, s91, v100 neg_lo:[0,0,1]
    v_dot2_f32_bf16 v36, v94, s90, v100 neg_lo:[0,0,1]
    v_dot2_f32_bf16 v37, v94, s91, v100 neg_lo:[0,0,1]
    v_dot2_f32_bf16 v38, v95, s90, v100 neg_lo:[0,0,1]
    v_dot2_f32_bf16 v39, v95, s91, v100 neg_lo:[0,0,1]
    v_cvt_pk_bf16_f32 v32, 0, v32
    v_cvt_pk_bf16_f32 v33, 0, v33
    v_cvt_pk_bf16_f32 v34, 0, v34
    v_cvt_pk_bf16_f32 v35, 0, v35
    v_cvt_pk_bf16_f32 v36, 0, v36
    v_cvt_pk_bf16_f32 v37, 0, v37
    v_cvt_pk_bf16_f32 v38, 0, v38
    v_cvt_pk_bf16_f32 v39, 0, v39
    v_pk_mul_f32 v[32:33], v[32:33], v[102:103]
    v_pk_mul_f32 v[34:35], v[34:35], v[102:103]
    v_pk_mul_f32 v[36:37], v[36:37], v[102:103]
    v_pk_mul_f32 v[38:39], v[38:39], v[102:103]
    v_cvt_pk_bf16_f32 v92, v32, v33
    v_cvt_pk_bf16_f32 v93, v34, v35
    v_cvt_pk_bf16_f32 v94, v36, v37
    v_cvt_pk_bf16_f32 v95, v38, v39
    ds_write_b128 v110, v[92:95] offset:13312
    v_mov_b32 v104, v116
    v_mov_b32 v105, v117
    v_mov_b32 v106, v118
    v_mov_b32 v107, v119
    s_waitcnt lgkmcnt(0)
    s_cmp_lg_u32 s28, 0
    s_cbranch_scc1 Lnp_8
    v_lshlrev_b32 v110, 2, v1
    s_mov_b32 s58, -1
    s_mov_b32 s59, 0x00ffffff
    s_mov_b32 s40, 0
Lp_9:
    buffer_load_dword v111, v110, s[48:51], 0 offen sc1
    s_waitcnt vmcnt(0)
    v_cmp_eq_u32 vcc, 0, v111
    s_nop 1
    s_and_b64 vcc, vcc, s[58:59]
    s_cbranch_scc0 Lnp2_10
    s_sleep 4
    s_add_u32 s40, s40, 1
    s_cmp_lt_u32 s40, 2097152
    s_cbranch_scc1 Lp_9
Lnp2_10:
    s_sub_u32 s40, s2, 56
    s_cmp_ge_u32 s40, 112
    s_cbranch_scc1 Lnp_8
    v_mov_b32 v110, 1
    v_mov_b32 v111, 0
    s_mov_b64 exec, 1
    s_lshl_b32 s40, s40, 2
    s_add_u32 s40, s40, 557056
    buffer_store_dword v110, v111, s[24:27], s40 offen sc1
    s_mov_b64 exec, -1
Lnp_8:
    s_barrier
    v_lshlrev_b32 v110, 4, v1
    v_lshlrev_b32 v111, 5, v1
    v_add_u32 v111, 155648, v111
    v_cmp_gt_u32 vcc, 56, v1
    s_and_saveexec_b64 s[58:59], vcc
    buffer_load_dwordx4 v[24:27], v110, s[24:27], 0 offen offset:896 sc1
    buffer_load_dwordx4 v[28:31], v110, s[24:27], 0 offen offset:0 sc1
    s_waitcnt vmcnt(0)
    v_lshlrev_b32 v84, 16, v24
    v_and_b32 v85, 0xffff0000, v24
    v_add_f32 v84, 1.0, v84
    v_add_f32 v85, 1.0, v85
    v_cvt_pk_bf16_f32 v84, v84, 0
    v_cvt_pk_bf16_f32 v85, 0, v85
    v_lshlrev_b32 v92, 16, v28
    v_and_b32 v93, 0xffff0000, v28
    v_lshlrev_b32 v86, 16, v25
    v_and_b32 v87, 0xffff0000, v25
    v_add_f32 v86, 1.0, v86
    v_add_f32 v87, 1.0, v87
    v_cvt_pk_bf16_f32 v86, v86, 0
    v_cvt_pk_bf16_f32 v87, 0, v87
    v_lshlrev_b32 v94, 16, v29
    v_and_b32 v95, 0xffff0000, v29
    v_lshlrev_b32 v88, 16, v26
    v_and_b32 v89, 0xffff0000, v26
    v_add_f32 v88, 1.0, v88
    v_add_f32 v89, 1.0, v89
    v_cvt_pk_bf16_f32 v88, v88, 0
    v_cvt_pk_bf16_f32 v89, 0, v89
    v_lshlrev_b32 v96, 16, v30
    v_and_b32 v97, 0xffff0000, v30
    v_lshlrev_b32 v90, 16, v27
    v_and_b32 v91, 0xffff0000, v27
    v_add_f32 v90, 1.0, v90
    v_add_f32 v91, 1.0, v91
    v_cvt_pk_bf16_f32 v90, v90, 0
    v_cvt_pk_bf16_f32 v91, 0, v91
    v_lshlrev_b32 v98, 16, v31
    v_and_b32 v99, 0xffff0000, v31
    ds_write_b128 v111, v[84:87]
    ds_write_b128 v111, v[88:91] offset:16
    ds_write_b128 v111, v[92:95] offset:1792
    ds_write_b128 v111, v[96:99] offset:1808
    s_mov_b64 exec, s[58:59]
    s_waitcnt lgkmcnt(0)
    s_mul_i32 s40, s31, 14336
    v_add_u32 v110, s40, v108
    s_mul_i32 s40, s31, 896
    v_add_u32 v109, s40, v109
    ds_read_b128 v[80:83], v110 offset:0
    ds_read_b128 v[84:87], v109 offset:0
    ds_read_b128 v[88:91], v109 offset:16
    ds_read_b128 v[92:95], v109 offset:1792
    ds_read_b128 v[96:99], v109 offset:1808
    ds_read_b128 v[72:75], v110
    ds_read_b128 v[40:43], v110 offset:1024
    ds_read_b128 v[44:47], v109 offset:64
    ds_read_b128 v[48:51], v109 offset:80
    ds_read_b128 v[52:55], v109 offset:1856
    ds_read_b128 v[56:59], v109 offset:1872
    s_mov_b32 s35, 0
.p2align 3
Lmd_11:
    s_waitcnt lgkmcnt(6)
    v_dot2_f32_bf16 v100, v80, v84, 0
    v_dot2_f32_bf16 v101, v80, v85, 0
    v_dot2_f32_bf16 v102, v81, v86, 0
    v_dot2_f32_bf16 v103, v81, v87, 0
    v_dot2_f32_bf16 v24, v82, v88, 0
    v_dot2_f32_bf16 v25, v82, v89, 0
    v_dot2_f32_bf16 v26, v83, v90, 0
    v_dot2_f32_bf16 v27, v83, v91, 0
    v_cvt_pk_bf16_f32 v28, v100, v101
    v_cvt_pk_bf16_f32 v29, v102, v103
    v_cvt_pk_bf16_f32 v30, v24, v25
    v_cvt_pk_bf16_f32 v31, v26, v27
    v_dot2_f32_bf16 v100, v28, s90, v92
    v_dot2_f32_bf16 v101, v28, s91, v93
    v_dot2_f32_bf16 v102, v29, s90, v94
    v_dot2_f32_bf16 v103, v29, s91, v95
    v_dot2_f32_bf16 v24, v30, s90, v96
    v_dot2_f32_bf16 v25, v30, s91, v97
    v_dot2_f32_bf16 v26, v31, s90, v98
    v_dot2_f32_bf16 v27, v31, s91, v99
    v_cvt_pk_bf16_f32 v28, v100, v101
    v_cvt_pk_bf16_f32 v29, v102, v103
    v_cvt_pk_bf16_f32 v30, v24, v25
    v_cvt_pk_bf16_f32 v31, v26, v27
    ds_write_b128 v110, v[28:31] offset:0
    ds_read_b128 v[80:83], v110 offset:2048
    ds_read_b128 v[84:87], v109 offset:128
    ds_read_b128 v[88:91], v109 offset:144
    ds_read_b128 v[92:95], v109 offset:1920
    ds_read_b128 v[96:99], v109 offset:1936
    s_waitcnt lgkmcnt(6)
    v_dot2_f32_bf16 v100, v40, v44, 0
    v_dot2_f32_bf16 v101, v40, v45, 0
    v_dot2_f32_bf16 v102, v41, v46, 0
    v_dot2_f32_bf16 v103, v41, v47, 0
    v_dot2_f32_bf16 v24, v42, v48, 0
    v_dot2_f32_bf16 v25, v42, v49, 0
    v_dot2_f32_bf16 v26, v43, v50, 0
    v_dot2_f32_bf16 v27, v43, v51, 0
    v_cvt_pk_bf16_f32 v32, v100, v101
    v_cvt_pk_bf16_f32 v33, v102, v103
    v_cvt_pk_bf16_f32 v34, v24, v25
    v_cvt_pk_bf16_f32 v35, v26, v27
    v_dot2_f32_bf16 v100, v32, s90, v52
    v_dot2_f32_bf16 v101, v32, s91, v53
    v_dot2_f32_bf16 v102, v33, s90, v54
    v_dot2_f32_bf16 v103, v33, s91, v55
    v_dot2_f32_bf16 v24, v34, s90, v56
    v_dot2_f32_bf16 v25, v34, s91, v57
    v_dot2_f32_bf16 v26, v35, s90, v58
    v_dot2_f32_bf16 v27, v35, s91, v59
    v_cvt_pk_bf16_f32 v32, v100, v101
    v_cvt_pk_bf16_f32 v33, v102, v103
    v_cvt_pk_bf16_f32 v34, v24, v25
    v_cvt_pk_bf16_f32 v35, v26, v27
    ds_write_b128 v110, v[32:35] offset:1024
    ds_read_b128 v[40:43], v110 offset:3072
    ds_read_b128 v[44:47], v109 offset:192
    ds_read_b128 v[48:51], v109 offset:208
    ds_read_b128 v[52:55], v109 offset:1984
    ds_read_b128 v[56:59], v109 offset:2000
    v_add_u32 v110, 2048, v110
    v_add_u32 v109, 128, v109
    s_add_u32 s35, s35, 1
    s_cmp_lt_u32 s35, 7
    s_cbranch_scc1 Lmd_11
    s_waitcnt lgkmcnt(0)
    s_barrier
    ds_read_b128 v[72:75], v108
    s_waitcnt vmcnt(0)
    s_barrier
    ds_read_b64_tr_b16 v[40:41], v104 offset:0
    ds_read_b64_tr_b16 v[42:43], v104 offset:4096
    ds_read_b64_tr_b16 v[44:45], v105 offset:0
    ds_read_b64_tr_b16 v[46:47], v105 offset:4096
    ds_read_b64_tr_b16 v[48:49], v106 offset:0
    ds_read_b64_tr_b16 v[50:51], v106 offset:4096
    ds_read_b64_tr_b16 v[52:53], v107 offset:0
    ds_read_b64_tr_b16 v[54:55], v107 offset:4096
    s_mov_b32 s35, 0
.p2align 3
Lqp_12:
    s_waitcnt vmcnt(12)
    s_barrier
    ds_read_b128 v[76:79], v108 offset:1024
    s_waitcnt lgkmcnt(5)
    v_mfma_f32_32x32x16_bf16 v[128:143], v[40:43], v[72:75], v[128:143]
    ds_read_b64_tr_b16 v[56:57], v104 offset:256
    ds_read_b64_tr_b16 v[58:59], v104 offset:4352
    s_add_u32 m0, s54, 0
    s_nop 0
    buffer_load_dwordx4 v112, s[80:83], s42 offen offset:0 lds
    v_mfma_f32_32x32x16_bf16 v[144:159], v[44:47], v[72:75], v[144:159]
    ds_read_b64_tr_b16 v[60:61], v105 offset:256
    ds_read_b64_tr_b16 v[62:63], v105 offset:4352
    s_waitcnt lgkmcnt(5)
    v_mfma_f32_32x32x16_bf16 v[160:175], v[48:51], v[72:75], v[160:175]
    ds_read_b64_tr_b16 v[64:65], v106 offset:256
    ds_read_b64_tr_b16 v[66:67], v106 offset:4352
    buffer_load_dwordx4 v113, s[80:83], s42 offen offset:1024 lds
    v_mfma_f32_32x32x16_bf16 v[176:191], v[52:55], v[72:75], v[176:191]
    ds_read_b64_tr_b16 v[68:69], v107 offset:256
    ds_read_b64_tr_b16 v[70:71], v107 offset:4352
    s_waitcnt lgkmcnt(4)
    v_mfma_f32_32x32x16_bf16 v[192:207], v[56:59], v[72:75], v[192:207]
    ds_read_b64_tr_b16 v[40:41], v104 offset:16384
    ds_read_b64_tr_b16 v[42:43], v104 offset:20480
    buffer_load_dwordx4 v114, s[80:83], s42 offen offset:2048 lds
    v_mfma_f32_32x32x16_bf16 v[208:223], v[60:63], v[72:75], v[208:223]
    ds_read_b64_tr_b16 v[44:45], v105 offset:16384
    ds_read_b64_tr_b16 v[46:47], v105 offset:20480
    s_waitcnt lgkmcnt(4)
    v_mfma_f32_32x32x16_bf16 v[224:239], v[64:67], v[72:75], v[224:239]
    ds_read_b64_tr_b16 v[48:49], v106 offset:16384
    ds_read_b64_tr_b16 v[50:51], v106 offset:20480
    buffer_load_dwordx4 v115, s[80:83], s42 offen offset:3072 lds
    v_mfma_f32_32x32x16_bf16 v[240:255], v[68:71], v[72:75], v[240:255]
    ds_read_b64_tr_b16 v[52:53], v107 offset:16384
    ds_read_b64_tr_b16 v[54:55], v107 offset:20480
    s_add_u32 s42, s42, s84
    s_waitcnt vmcnt(12)
    s_barrier
    ds_read_b128 v[72:75], v108 offset:2048
    s_waitcnt lgkmcnt(5)
    v_mfma_f32_32x32x16_bf16 v[128:143], v[40:43], v[76:79], v[128:143]
    ds_read_b64_tr_b16 v[56:57], v104 offset:16640
    ds_read_b64_tr_b16 v[58:59], v104 offset:20736
    s_cmp_eq_u32 s35, 11
    s_cbranch_scc1 LswV_5
    s_cmp_eq_u32 s35, 12
    s_cbranch_scc1 LswK_6
    Lback_7:
    s_add_u32 m0, s55, 0
    s_nop 0
    buffer_load_dwordx4 v112, s[80:83], s42 offen offset:0 lds
    v_mfma_f32_32x32x16_bf16 v[144:159], v[44:47], v[76:79], v[144:159]
    ds_read_b64_tr_b16 v[60:61], v105 offset:16640
    ds_read_b64_tr_b16 v[62:63], v105 offset:20736
    s_waitcnt lgkmcnt(5)
    v_mfma_f32_32x32x16_bf16 v[160:175], v[48:51], v[76:79], v[160:175]
    ds_read_b64_tr_b16 v[64:65], v106 offset:16640
    ds_read_b64_tr_b16 v[66:67], v106 offset:20736
    buffer_load_dwordx4 v113, s[80:83], s42 offen offset:1024 lds
    v_mfma_f32_32x32x16_bf16 v[176:191], v[52:55], v[76:79], v[176:191]
    ds_read_b64_tr_b16 v[68:69], v107 offset:16640
    ds_read_b64_tr_b16 v[70:71], v107 offset:20736
    s_waitcnt lgkmcnt(4)
    v_mfma_f32_32x32x16_bf16 v[192:207], v[56:59], v[76:79], v[192:207]
    v_add_u32 v104, s57, v116
    v_add_u32 v105, s57, v117
    v_add_u32 v106, s57, v118
    v_add_u32 v107, s57, v119
    ds_read_b64_tr_b16 v[40:41], v104 offset:0
    ds_read_b64_tr_b16 v[42:43], v104 offset:4096
    buffer_load_dwordx4 v114, s[80:83], s42 offen offset:2048 lds
    v_mfma_f32_32x32x16_bf16 v[208:223], v[60:63], v[76:79], v[208:223]
    ds_read_b64_tr_b16 v[44:45], v105 offset:0
    ds_read_b64_tr_b16 v[46:47], v105 offset:4096
    s_waitcnt lgkmcnt(4)
    v_mfma_f32_32x32x16_bf16 v[224:239], v[64:67], v[76:79], v[224:239]
    ds_read_b64_tr_b16 v[48:49], v106 offset:0
    ds_read_b64_tr_b16 v[50:51], v106 offset:4096
    buffer_load_dwordx4 v115, s[80:83], s42 offen offset:3072 lds
    v_mfma_f32_32x32x16_bf16 v[240:255], v[68:71], v[76:79], v[240:255]
    ds_read_b64_tr_b16 v[52:53], v107 offset:0
    ds_read_b64_tr_b16 v[54:55], v107 offset:4096
    s_add_u32 s42, s42, s84
    s_add_u32 s54, s87, s56
    s_add_u32 s55, s38, s57
    s_mov_b32 s88, s56
    s_mov_b32 s56, s57
    s_mov_b32 s57, s86
    s_mov_b32 s86, s88
    v_add_u32 v108, 2048, v108
    s_add_u32 s35, s35, 1
    s_cmp_lt_u32 s35, 14
    s_cbranch_scc1 Lqp_12
    s_waitcnt lgkmcnt(0)
    s_barrier
    s_lshl_b32 s33, s29, 20
    s_mul_i32 s40, s29, 458752
    s_mul_i32 s41, s30, 14336
    s_add_u32 s40, s40, s41
    s_lshl_b32 s41, s28, 12
    s_add_u32 s40, s40, s41
    v_lshlrev_b32 v33, 6, v1
    buffer_load_dword v32, v33, s[20:23], s40 offen
    s_add_u32 s34, s33, 32768
    s_add_u32 s85, s33, 49152
    s_add_u32 s84, s33, 81920
    s_add_u32 s33, s33, 65536
    s_lshl_b32 s40, s28, 14
    s_add_u32 s40, s40, 98304
    v_lshlrev_b32 v34, 4, v1
    v_add_u32 v34, s40, v34
    s_xor_b32 s40, s28, 2
    s_lshl_b32 s40, s40, 14
    s_add_u32 s40, s40, 98304
    v_lshlrev_b32 v35, 4, v1
    v_add_u32 v35, s40, v35
    v_cvt_pk_bf16_f32 v40, v128, v129
    v_cvt_pk_bf16_f32 v41, v130, v131
    v_cvt_pk_bf16_f32 v42, v132, v133
    v_cvt_pk_bf16_f32 v43, v134, v135
    ds_write_b128 v34, v[40:43] offset:0
    v_accvgpr_write_b32 a0, v40
    v_accvgpr_write_b32 a1, v41
    v_accvgpr_write_b32 a2, v42
    v_accvgpr_write_b32 a3, v43
    v_cvt_pk_bf16_f32 v44, v136, v137
    v_cvt_pk_bf16_f32 v45, v138, v139
    v_cvt_pk_bf16_f32 v46, v140, v141
    v_cvt_pk_bf16_f32 v47, v142, v143
    ds_write_b128 v34, v[44:47] offset:1024
    v_accvgpr_write_b32 a4, v44
    v_accvgpr_write_b32 a5, v45
    v_accvgpr_write_b32 a6, v46
    v_accvgpr_write_b32 a7, v47
    v_cvt_pk_bf16_f32 v48, v144, v145
    v_cvt_pk_bf16_f32 v49, v146, v147
    v_cvt_pk_bf16_f32 v50, v148, v149
    v_cvt_pk_bf16_f32 v51, v150, v151
    ds_write_b128 v34, v[48:51] offset:2048
    v_accvgpr_write_b32 a8, v48
    v_accvgpr_write_b32 a9, v49
    v_accvgpr_write_b32 a10, v50
    v_accvgpr_write_b32 a11, v51
    v_cvt_pk_bf16_f32 v52, v152, v153
    v_cvt_pk_bf16_f32 v53, v154, v155
    v_cvt_pk_bf16_f32 v54, v156, v157
    v_cvt_pk_bf16_f32 v55, v158, v159
    ds_write_b128 v34, v[52:55] offset:3072
    v_accvgpr_write_b32 a12, v52
    v_accvgpr_write_b32 a13, v53
    v_accvgpr_write_b32 a14, v54
    v_accvgpr_write_b32 a15, v55
    v_cvt_pk_bf16_f32 v56, v160, v161
    v_cvt_pk_bf16_f32 v57, v162, v163
    v_cvt_pk_bf16_f32 v58, v164, v165
    v_cvt_pk_bf16_f32 v59, v166, v167
    ds_write_b128 v34, v[56:59] offset:4096
    v_accvgpr_write_b32 a16, v56
    v_accvgpr_write_b32 a17, v57
    v_accvgpr_write_b32 a18, v58
    v_accvgpr_write_b32 a19, v59
    v_cvt_pk_bf16_f32 v60, v168, v169
    v_cvt_pk_bf16_f32 v61, v170, v171
    v_cvt_pk_bf16_f32 v62, v172, v173
    v_cvt_pk_bf16_f32 v63, v174, v175
    ds_write_b128 v34, v[60:63] offset:5120
    v_accvgpr_write_b32 a20, v60
    v_accvgpr_write_b32 a21, v61
    v_accvgpr_write_b32 a22, v62
    v_accvgpr_write_b32 a23, v63
    v_cvt_pk_bf16_f32 v64, v176, v177
    v_cvt_pk_bf16_f32 v65, v178, v179
    v_cvt_pk_bf16_f32 v66, v180, v181
    v_cvt_pk_bf16_f32 v67, v182, v183
    ds_write_b128 v34, v[64:67] offset:6144
    v_accvgpr_write_b32 a24, v64
    v_accvgpr_write_b32 a25, v65
    v_accvgpr_write_b32 a26, v66
    v_accvgpr_write_b32 a27, v67
    v_cvt_pk_bf16_f32 v68, v184, v185
    v_cvt_pk_bf16_f32 v69, v186, v187
    v_cvt_pk_bf16_f32 v70, v188, v189
    v_cvt_pk_bf16_f32 v71, v190, v191
    ds_write_b128 v34, v[68:71] offset:7168
    v_accvgpr_write_b32 a28, v68
    v_accvgpr_write_b32 a29, v69
    v_accvgpr_write_b32 a30, v70
    v_accvgpr_write_b32 a31, v71
    v_cvt_pk_bf16_f32 v40, v192, v193
    v_cvt_pk_bf16_f32 v41, v194, v195
    v_cvt_pk_bf16_f32 v42, v196, v197
    v_cvt_pk_bf16_f32 v43, v198, v199
    ds_write_b128 v34, v[40:43] offset:8192
    v_accvgpr_write_b32 a32, v40
    v_accvgpr_write_b32 a33, v41
    v_accvgpr_write_b32 a34, v42
    v_accvgpr_write_b32 a35, v43
    v_cvt_pk_bf16_f32 v44, v200, v201
    v_cvt_pk_bf16_f32 v45, v202, v203
    v_cvt_pk_bf16_f32 v46, v204, v205
    v_cvt_pk_bf16_f32 v47, v206, v207
    ds_write_b128 v34, v[44:47] offset:9216
    v_accvgpr_write_b32 a36, v44
    v_accvgpr_write_b32 a37, v45
    v_accvgpr_write_b32 a38, v46
    v_accvgpr_write_b32 a39, v47
    v_cvt_pk_bf16_f32 v48, v208, v209
    v_cvt_pk_bf16_f32 v49, v210, v211
    v_cvt_pk_bf16_f32 v50, v212, v213
    v_cvt_pk_bf16_f32 v51, v214, v215
    ds_write_b128 v34, v[48:51] offset:10240
    v_accvgpr_write_b32 a40, v48
    v_accvgpr_write_b32 a41, v49
    v_accvgpr_write_b32 a42, v50
    v_accvgpr_write_b32 a43, v51
    v_cvt_pk_bf16_f32 v52, v216, v217
    v_cvt_pk_bf16_f32 v53, v218, v219
    v_cvt_pk_bf16_f32 v54, v220, v221
    v_cvt_pk_bf16_f32 v55, v222, v223
    ds_write_b128 v34, v[52:55] offset:11264
    v_accvgpr_write_b32 a44, v52
    v_accvgpr_write_b32 a45, v53
    v_accvgpr_write_b32 a46, v54
    v_accvgpr_write_b32 a47, v55
    v_cvt_pk_bf16_f32 v56, v224, v225
    v_cvt_pk_bf16_f32 v57, v226, v227
    v_cvt_pk_bf16_f32 v58, v228, v229
    v_cvt_pk_bf16_f32 v59, v230, v231
    ds_write_b128 v34, v[56:59] offset:12288
    v_accvgpr_write_b32 a48, v56
    v_accvgpr_write_b32 a49, v57
    v_accvgpr_write_b32 a50, v58
    v_accvgpr_write_b32 a51, v59
    v_cvt_pk_bf16_f32 v60, v232, v233
    v_cvt_pk_bf16_f32 v61, v234, v235
    v_cvt_pk_bf16_f32 v62, v236, v237
    v_cvt_pk_bf16_f32 v63, v238, v239
    ds_write_b128 v34, v[60:63] offset:13312
    v_accvgpr_write_b32 a52, v60
    v_accvgpr_write_b32 a53, v61
    v_accvgpr_write_b32 a54, v62
    v_accvgpr_write_b32 a55, v63
    v_cvt_pk_bf16_f32 v64, v240, v241
    v_cvt_pk_bf16_f32 v65, v242, v243
    v_cvt_pk_bf16_f32 v66, v244, v245
    v_cvt_pk_bf16_f32 v67, v246, v247
    ds_write_b128 v34, v[64:67] offset:14336
    v_accvgpr_write_b32 a56, v64
    v_accvgpr_write_b32 a57, v65
    v_accvgpr_write_b32 a58, v66
    v_accvgpr_write_b32 a59, v67
    v_cvt_pk_bf16_f32 v68, v248, v249
    v_cvt_pk_bf16_f32 v69, v250, v251
    v_cvt_pk_bf16_f32 v70, v252, v253
    v_cvt_pk_bf16_f32 v71, v254, v255
    ds_write_b128 v34, v[68:71] offset:15360
    v_accvgpr_write_b32 a60, v68
    v_accvgpr_write_b32 a61, v69
    v_accvgpr_write_b32 a62, v70
    v_accvgpr_write_b32 a63, v71
    v_mov_b32 v22, 0
    v_mov_b32 v23, 0
    s_waitcnt vmcnt(5)
    s_barrier
    ds_read_b128 v[96:99], v2 offset:0
    ds_read_b128 v[100:103], v3 offset:0
    ds_read_b128 v[104:107], v4 offset:0
    ds_read_b128 v[108:111], v5 offset:0
    ds_read_b128 v[112:115], v6 offset:0
    ds_read_b128 v[116:119], v7 offset:0
    s_waitcnt lgkmcnt(5)
    v_mfma_f32_32x32x16_bf16 v[40:55], v[96:99], a[0:3], 0
    ds_read_b128 v[120:123], v8 offset:0
    v_mov_b64 v[128:129], 0
    v_mov_b64 v[130:131], 0
    v_mov_b64 v[132:133], 0
    v_mov_b64 v[134:135], 0
    v_mov_b64 v[136:137], 0
    s_waitcnt lgkmcnt(5)
    v_mfma_f32_32x32x16_bf16 v[40:55], v[100:103], a[4:7], v[40:55]
    ds_read_b128 v[124:127], v9 offset:0
    s_barrier
    s_add_u32 m0, s38, 49152
    v_mov_b64 v[138:139], 0
    buffer_load_dwordx4 v14, s[8:11], s85 offen offset:0 lds
    v_mov_b64 v[140:141], 0
    v_mov_b64 v[142:143], 0
    v_mov_b64 v[144:145], 0
    s_waitcnt lgkmcnt(5)
    v_mfma_f32_32x32x16_bf16 v[40:55], v[104:107], a[8:11], v[40:55]
    ds_read_b128 v[96:99], v2 offset:256
    ds_read_b128 a[64:67], v35 offset:0
    ds_read_b128 a[68:71], v35 offset:1024
    v_mov_b64 v[146:147], 0
    v_mov_b64 v[148:149], 0
    v_mov_b64 v[150:151], 0
    v_mov_b64 v[152:153], 0
    s_waitcnt lgkmcnt(7)
    v_mfma_f32_32x32x16_bf16 v[40:55], v[108:111], a[12:15], v[40:55]
    ds_read_b128 v[100:103], v3 offset:256
    ds_read_b128 a[72:75], v35 offset:2048
    ds_read_b128 a[76:79], v35 offset:3072
    buffer_load_dwordx4 v15, s[8:11], s85 offen offset:1024 lds
    v_mov_b64 v[154:155], 0
    v_mov_b64 v[156:157], 0
    v_mov_b64 v[158:159], 0
    s_waitcnt lgkmcnt(9)
    v_mfma_f32_32x32x16_bf16 v[40:55], v[112:115], a[16:19], v[40:55]
    ds_read_b128 v[104:107], v4 offset:256
    ds_read_b128 a[80:83], v35 offset:4096
    ds_read_b128 a[84:87], v35 offset:5120
    v_mov_b64 v[160:161], 0
    v_mov_b64 v[162:163], 0
    v_mov_b64 v[164:165], 0
    v_mov_b64 v[166:167], 0
    s_waitcnt lgkmcnt(11)
    v_mfma_f32_32x32x16_bf16 v[40:55], v[116:119], a[20:23], v[40:55]
    ds_read_b128 v[108:111], v5 offset:256
    ds_read_b128 a[88:91], v35 offset:6144
    ds_read_b128 a[92:95], v35 offset:7168
    v_mov_b64 v[168:169], 0
    v_mov_b64 v[170:171], 0
    v_mov_b64 v[172:173], 0
    v_mov_b64 v[174:175], 0
    s_waitcnt lgkmcnt(13)
    v_mfma_f32_32x32x16_bf16 v[40:55], v[120:123], a[24:27], v[40:55]
    ds_read_b128 v[112:115], v6 offset:256
    ds_read_b128 a[96:99], v35 offset:8192
    ds_read_b128 a[100:103], v35 offset:9216
    buffer_load_dwordx4 v16, s[8:11], s85 offen offset:2048 lds
    v_mov_b64 v[176:177], 0
    v_mov_b64 v[178:179], 0
    v_mov_b64 v[180:181], 0
    s_waitcnt lgkmcnt(15)
    v_mfma_f32_32x32x16_bf16 v[40:55], v[124:127], a[28:31], v[40:55]
    ds_read_b128 v[116:119], v7 offset:256
    ds_read_b128 a[104:107], v35 offset:10240
    ds_read_b128 a[108:111], v35 offset:11264
    v_mov_b64 v[182:183], 0
    v_mov_b64 v[184:185], 0
    v_mov_b64 v[186:187], 0
    v_mov_b64 v[188:189], 0
    s_waitcnt lgkmcnt(15)
    v_mfma_f32_32x32x16_bf16 v[40:55], v[96:99], a[32:35], v[40:55]
    ds_read_b128 v[120:123], v8 offset:256
    ds_read_b128 a[112:115], v35 offset:12288
    ds_read_b128 a[116:119], v35 offset:13312
    v_mov_b64 v[190:191], 0
    v_mov_b64 v[192:193], 0
    v_mov_b64 v[194:195], 0
    v_mov_b64 v[196:197], 0
    v_mov_b64 v[198:199], 0
    s_waitcnt lgkmcnt(15)
    v_mfma_f32_32x32x16_bf16 v[40:55], v[100:103], a[36:39], v[40:55]
    ds_read_b128 v[124:127], v9 offset:256
    ds_read_b128 a[120:123], v35 offset:14336
    ds_read_b128 a[124:127], v35 offset:15360
    buffer_load_dwordx4 v17, s[8:11], s85 offen offset:3072 lds
    v_mov_b64 v[200:201], 0
    v_mov_b64 v[202:203], 0
    v_mov_b64 v[204:205], 0
    v_mov_b64 v[206:207], 0
    s_waitcnt lgkmcnt(15)
    v_mfma_f32_32x32x16_bf16 v[40:55], v[104:107], a[40:43], v[40:55]
    ds_read_b128 v[96:99], v2 offset:0
    v_mov_b64 v[208:209], 0
    v_mov_b64 v[210:211], 0
    v_mov_b64 v[212:213], 0
    v_mov_b64 v[214:215], 0
    v_mov_b64 v[216:217], 0
    v_mov_b64 v[218:219], 0
    s_waitcnt lgkmcnt(15)
    v_mfma_f32_32x32x16_bf16 v[40:55], v[108:111], a[44:47], v[40:55]
    ds_read_b128 v[100:103], v3 offset:0
    v_mov_b64 v[220:221], 0
    v_mov_b64 v[222:223], 0
    v_mov_b64 v[224:225], 0
    v_mov_b64 v[226:227], 0
    v_mov_b64 v[228:229], 0
    v_mov_b64 v[230:231], 0
    s_waitcnt lgkmcnt(13)
    v_mfma_f32_32x32x16_bf16 v[40:55], v[112:115], a[48:51], v[40:55]
    ds_read_b128 v[104:107], v4 offset:0
    v_mov_b64 v[232:233], 0
    v_mov_b64 v[234:235], 0
    v_mov_b64 v[236:237], 0
    v_mov_b64 v[238:239], 0
    v_mov_b64 v[240:241], 0
    v_mov_b64 v[242:243], 0
    s_waitcnt lgkmcnt(11)
    v_mfma_f32_32x32x16_bf16 v[40:55], v[116:119], a[52:55], v[40:55]
    ds_read_b128 v[108:111], v5 offset:0
    v_mov_b64 v[244:245], 0
    v_mov_b64 v[246:247], 0
    v_mov_b64 v[248:249], 0
    v_mov_b64 v[250:251], 0
    v_mov_b64 v[252:253], 0
    v_mov_b64 v[254:255], 0
    s_waitcnt lgkmcnt(9)
    v_mfma_f32_32x32x16_bf16 v[40:55], v[120:123], a[56:59], v[40:55]
    ds_read_b128 v[112:115], v6 offset:0
    s_waitcnt lgkmcnt(7)
    v_mfma_f32_32x32x16_bf16 v[40:55], v[124:127], a[60:63], v[40:55]
    ds_read_b128 v[116:119], v7 offset:0
    s_waitcnt lgkmcnt(5)
    v_mfma_f32_32x32x16_bf16 v[56:71], v[96:99], a[64:67], 0
    ds_read_b128 v[120:123], v8 offset:0
    s_waitcnt lgkmcnt(5)
    v_mfma_f32_32x32x16_bf16 v[56:71], v[100:103], a[68:71], v[56:71]
    ds_read_b128 v[124:127], v9 offset:0
    s_waitcnt lgkmcnt(5)
    v_mfma_f32_32x32x16_bf16 v[56:71], v[104:107], a[72:75], v[56:71]
    ds_read_b128 v[96:99], v2 offset:256
    v_max3_f32 v26, v40, v41, v42
    v_max3_f32 v26, v26, v43, v44
    v_max3_f32 v26, v26, v45, v46
    v_max3_f32 v26, v26, v47, v48
    v_max3_f32 v26, v26, v49, v50
    v_max3_f32 v26, v26, v51, v52
    s_waitcnt lgkmcnt(5)
    v_mfma_f32_32x32x16_bf16 v[56:71], v[108:111], a[76:79], v[56:71]
    ds_read_b128 v[100:103], v3 offset:256
    v_max3_f32 v26, v26, v53, v54
    v_max_f32 v26, v26, v55
    v_mov_b32 v27, v26
    s_nop 1
    v_permlane32_swap_b32 v26, v27
    s_nop 1
    s_waitcnt lgkmcnt(5)
    v_mfma_f32_32x32x16_bf16 v[56:71], v[112:115], a[80:83], v[56:71]
    ds_read_b128 v[104:107], v4 offset:256
    v_max_f32 v26, v26, v27
    v_cvt_pk_bf16_f32 v26, 0, v26
    v_mov_b32 v28, 0x42400000
    v_fma_f32 v20, v26, s36, v28
    v_cvt_pk_bf16_f32 v26, 0, v40
    v_cvt_pk_bf16_f32 v27, 0, v41
    v_fma_f32 v26, v26, s36, -v20
    v_fma_f32 v27, v27, s36, -v20
    v_exp_f32 v26, v26
    s_waitcnt lgkmcnt(5)
    v_mfma_f32_32x32x16_bf16 v[56:71], v[116:119], a[84:87], v[56:71]
    ds_read_b128 v[108:111], v5 offset:256
    v_exp_f32 v27, v27
    v_cvt_pk_bf16_f32 v28, 0, v42
    v_add_f32 v24, v26, v27
    v_cvt_pk_bf16_f32 v88, v26, v27
    v_cvt_pk_bf16_f32 v29, 0, v43
    v_fma_f32 v28, v28, s36, -v20
    s_waitcnt lgkmcnt(5)
    v_mfma_f32_32x32x16_bf16 v[56:71], v[120:123], a[88:91], v[56:71]
    ds_read_b128 v[112:115], v6 offset:256
    v_fma_f32 v29, v29, s36, -v20
    v_exp_f32 v28, v28
    v_exp_f32 v29, v29
    v_cvt_pk_bf16_f32 v30, 0, v44
    v_add_f32 v25, v28, v29
    v_cvt_pk_bf16_f32 v89, v28, v29
    v_cvt_pk_bf16_f32 v31, 0, v45
    s_waitcnt lgkmcnt(5)
    v_mfma_f32_32x32x16_bf16 v[56:71], v[124:127], a[92:95], v[56:71]
    ds_read_b128 v[116:119], v7 offset:256
    v_fma_f32 v30, v30, s36, -v20
    v_fma_f32 v31, v31, s36, -v20
    v_exp_f32 v30, v30
    v_exp_f32 v31, v31
    v_cvt_pk_bf16_f32 v26, 0, v46
    v_add_f32 v24, v24, v30
    v_add_f32 v25, v25, v31
    s_waitcnt lgkmcnt(5)
    v_mfma_f32_32x32x16_bf16 v[56:71], v[96:99], a[96:99], v[56:71]
    ds_read_b128 v[120:123], v8 offset:256
    v_cvt_pk_bf16_f32 v90, v30, v31
    v_cvt_pk_bf16_f32 v27, 0, v47
    v_fma_f32 v26, v26, s36, -v20
    v_fma_f32 v27, v27, s36, -v20
    v_exp_f32 v26, v26
    v_exp_f32 v27, v27
    v_cvt_pk_bf16_f32 v28, 0, v48
    s_waitcnt lgkmcnt(5)
    v_mfma_f32_32x32x16_bf16 v[56:71], v[100:103], a[100:103], v[56:71]
    ds_read_b128 v[124:127], v9 offset:256
    v_add_f32 v24, v24, v26
    v_add_f32 v25, v25, v27
    v_cvt_pk_bf16_f32 v91, v26, v27
    v_cvt_pk_bf16_f32 v29, 0, v49
    v_fma_f32 v28, v28, s36, -v20
    v_fma_f32 v29, v29, s36, -v20
    v_exp_f32 v28, v28
    s_waitcnt lgkmcnt(5)
    v_mfma_f32_32x32x16_bf16 v[56:71], v[104:107], a[104:107], v[56:71]
    v_exp_f32 v29, v29
    v_cvt_pk_bf16_f32 v30, 0, v50
    v_add_f32 v24, v24, v28
    v_add_f32 v25, v25, v29
    v_cvt_pk_bf16_f32 v92, v28, v29
    v_cvt_pk_bf16_f32 v31, 0, v51
    v_fma_f32 v30, v30, s36, -v20
    v_fma_f32 v31, v31, s36, -v20
    s_waitcnt lgkmcnt(4)
    v_mfma_f32_32x32x16_bf16 v[56:71], v[108:111], a[108:111], v[56:71]
    v_exp_f32 v30, v30
    v_exp_f32 v31, v31
    v_cvt_pk_bf16_f32 v26, 0, v52
    v_add_f32 v24, v24, v30
    v_add_f32 v25, v25, v31
    v_cvt_pk_bf16_f32 v93, v30, v31
    v_cvt_pk_bf16_f32 v27, 0, v53
    s_waitcnt lgkmcnt(3)
    v_mfma_f32_32x32x16_bf16 v[56:71], v[112:115], a[112:115], v[56:71]
    s_waitcnt lgkmcnt(0)
    s_waitcnt vmcnt(0)
    s_barrier
    ds_read_b128 v[112:115], v2 offset:32768
    v_fma_f32 v26, v26, s36, -v20
    v_fma_f32 v27, v27, s36, -v20
    v_exp_f32 v26, v26
    v_exp_f32 v27, v27
    v_cvt_pk_bf16_f32 v28, 0, v54
    v_add_f32 v24, v24, v26
    v_add_f32 v25, v25, v27
    v_mfma_f32_32x32x16_bf16 v[56:71], v[116:119], a[116:119], v[56:71]
    ds_read_b128 v[116:119], v3 offset:32768
    v_cvt_pk_bf16_f32 v94, v26, v27
    v_cvt_pk_bf16_f32 v29, 0, v55
    v_fma_f32 v28, v28, s36, -v20
    v_fma_f32 v29, v29, s36, -v20
    v_exp_f32 v28, v28
    v_exp_f32 v29, v29
    v_mfma_f32_32x32x16_bf16 v[56:71], v[120:123], a[120:123], v[56:71]
    ds_read_b128 v[120:123], v4 offset:32768
    s_nop 0
    v_add_f32 v24, v24, v28
    v_add_f32 v25, v25, v29
    v_cvt_pk_bf16_f32 v95, v28, v29
    v_add_f32 v24, v24, v25
    v_mov_b32 v22, v24
    v_mfma_f32_32x32x16_bf16 v[56:71], v[124:127], a[124:127], v[56:71]
    s_nop 7
    s_nop 7
    v_max3_f32 v26, v56, v57, v58
    v_max3_f32 v26, v26, v59, v60
    v_max3_f32 v26, v26, v61, v62
    v_max3_f32 v26, v26, v63, v64
    v_max3_f32 v26, v26, v65, v66
    v_max3_f32 v26, v26, v67, v68
    v_max3_f32 v26, v26, v69, v70
    v_max_f32 v26, v26, v71
    v_mov_b32 v27, v26
    s_nop 1
    v_permlane32_swap_b32 v26, v27
    s_nop 1
    v_max_f32 v26, v26, v27
    v_cvt_pk_bf16_f32 v26, 0, v26
    v_mov_b32 v28, 0x42400000
    v_fma_f32 v21, v26, s36, v28
    v_mov_b64 v[36:37], -1
    v_mov_b64 v[38:39], -1
    s_lshl_b32 s90, s29, 10
    s_lshl_b32 s91, s30, 5
    s_add_u32 s90, s90, s91
    s_mul_i32 s90, s90, 1792
    s_mul_i32 s91, s28, 10240
    s_add_u32 s90, s90, s91
    s_add_u32 s91, s90, 33554432
    s_add_u32 s90, s90, 16777216
    s_lshl_b32 s92, s30, 1
    s_lshr_b32 s93, s29, 2
    s_add_u32 s92, s92, s93
    s_mul_i32 s92, s92, 28672
    s_and_b32 s93, s29, 3
    s_lshl_b32 s93, s93, 7
    s_add_u32 s92, s92, s93
    s_lshl_b32 s93, s28, 13
    s_add_u32 s92, s92, s93
    s_add_u32 s92, s92, 5242880
    s_add_u32 s93, s92, 4096
    s_cmp_eq_u32 s28, 3
    s_cselect_b32 s93, s92, s93
    v_lshrrev_b32 v32, 3, v1
    v_lshlrev_b32 v32, 9, v32
    v_and_b32 v33, 7, v1
    v_lshl_add_u32 v32, v33, 4, v32
    buffer_store_dwordx4 v[36:39], v32, s[24:27], s92 offen sc1
    buffer_store_dwordx4 v[36:39], v32, s[24:27], s93 offen sc1
    s_add_u32 s92, s90, 13312
    s_add_u32 s93, s91, 13312
    s_mov_b32 s35, 0
.p2align 3
Lloop_13:
    s_waitcnt lgkmcnt(2)
    v_mfma_f32_32x32x16_bf16 v[40:55], v[112:115], a[0:3], 0
    ds_read_b128 v[124:127], v5 offset:32768
    v_cvt_pk_bf16_f32 v26, 0, v56
    v_cvt_pk_bf16_f32 v27, 0, v57
    v_fma_f32 v26, v26, s36, -v21
    v_mfma_f32_32x32x16_bf16 v[72:87], v[112:115], a[64:67], 0
    s_cmp_eq_u32 s35, 14
    s_cselect_b32 s94, s92, s90
    s_add_u32 s90, s90, 1024
    buffer_store_dwordx4 v[36:39], v14, s[24:27], s94 offen sc1
    s_add_u32 m0, s38, 0
    v_fma_f32 v27, v27, s36, -v21
    buffer_load_dwordx4 v14, s[8:11], s33 offen offset:0 lds
    s_waitcnt lgkmcnt(2)
    v_mfma_f32_32x32x16_bf16 v[40:55], v[116:119], a[4:7], v[40:55]
    ds_read_b128 v[112:115], v6 offset:32768
    v_exp_f32 v26, v26
    v_exp_f32 v27, v27
    v_cvt_pk_bf16_f32 v28, 0, v58
    v_mfma_f32_32x32x16_bf16 v[72:87], v[116:119], a[68:71], v[72:87]
    buffer_load_dwordx4 v15, s[8:11], s33 offen offset:1024 lds
    v_add_f32 v24, v26, v27
    v_cvt_pk_bf16_f32 v104, v26, v27
    v_cvt_pk_bf16_f32 v29, 0, v59
    s_waitcnt lgkmcnt(2)
    v_mfma_f32_32x32x16_bf16 v[40:55], v[120:123], a[8:11], v[40:55]
    ds_read_b128 v[116:119], v7 offset:32768
    v_fma_f32 v28, v28, s36, -v21
    v_fma_f32 v29, v29, s36, -v21
    v_exp_f32 v28, v28
    v_mfma_f32_32x32x16_bf16 v[72:87], v[120:123], a[72:75], v[72:87]
    v_exp_f32 v29, v29
    s_waitcnt lgkmcnt(2)
    v_mfma_f32_32x32x16_bf16 v[40:55], v[124:127], a[12:15], v[40:55]
    ds_read_b128 v[120:123], v8 offset:32768
    buffer_load_dwordx4 v16, s[8:11], s33 offen offset:2048 lds
    v_cvt_pk_bf16_f32 v30, 0, v60
    v_add_f32 v25, v28, v29
    v_cvt_pk_bf16_f32 v105, v28, v29
    v_mfma_f32_32x32x16_bf16 v[72:87], v[124:127], a[76:79], v[72:87]
    v_cvt_pk_bf16_f32 v31, 0, v61
    v_fma_f32 v30, v30, s36, -v21
    v_fma_f32 v31, v31, s36, -v21
    s_waitcnt lgkmcnt(2)
    v_mfma_f32_32x32x16_bf16 v[40:55], v[112:115], a[16:19], v[40:55]
    ds_read_b128 v[124:127], v9 offset:32768
    v_exp_f32 v30, v30
    v_exp_f32 v31, v31
    v_mfma_f32_32x32x16_bf16 v[72:87], v[112:115], a[80:83], v[72:87]
    buffer_load_dwordx4 v17, s[8:11], s33 offen offset:3072 lds
    v_cvt_pk_bf16_f32 v26, 0, v62
    v_add_f32 v24, v24, v30
    s_waitcnt lgkmcnt(2)
    v_mfma_f32_32x32x16_bf16 v[40:55], v[116:119], a[20:23], v[40:55]
    ds_read_b128 v[112:115], v2 offset:33024
    v_add_f32 v25, v25, v31
    v_cvt_pk_bf16_f32 v106, v30, v31
    v_cvt_pk_bf16_f32 v27, 0, v63
    v_mfma_f32_32x32x16_bf16 v[72:87], v[116:119], a[84:87], v[72:87]
    v_fma_f32 v26, v26, s36, -v21
    v_fma_f32 v27, v27, s36, -v21
    v_exp_f32 v26, v26
    s_waitcnt lgkmcnt(2)
    v_mfma_f32_32x32x16_bf16 v[40:55], v[120:123], a[24:27], v[40:55]
    ds_read_b128 v[116:119], v3 offset:33024
    s_add_u32 s33, s33, 32768
    s_add_u32 m0, s38, 16384
    v_exp_f32 v27, v27
    buffer_load_dwordx4 v14, s[8:11], s84 offen offset:0 lds
    v_mfma_f32_32x32x16_bf16 v[72:87], v[120:123], a[88:91], v[72:87]
    v_cvt_pk_bf16_f32 v28, 0, v64
    v_add_f32 v24, v24, v26
    v_add_f32 v25, v25, v27
    s_waitcnt lgkmcnt(2)
    v_mfma_f32_32x32x16_bf16 v[40:55], v[124:127], a[28:31], v[40:55]
    ds_read_b128 v[120:123], v4 offset:33024
    v_cvt_pk_bf16_f32 v107, v26, v27
    v_cvt_pk_bf16_f32 v29, 0, v65
    v_mfma_f32_32x32x16_bf16 v[72:87], v[124:127], a[92:95], v[72:87]
    buffer_load_dwordx4 v15, s[8:11], s84 offen offset:1024 lds
    v_fma_f32 v28, v28, s36, -v21
    v_fma_f32 v29, v29, s36, -v21
    v_exp_f32 v28, v28
    s_waitcnt lgkmcnt(2)
    v_mfma_f32_32x32x16_bf16 v[40:55], v[112:115], a[32:35], v[40:55]
    ds_read_b128 v[124:127], v5 offset:33024
    v_exp_f32 v29, v29
    v_mfma_f32_32x32x16_bf16 v[72:87], v[112:115], a[96:99], v[72:87]
    buffer_load_dwordx4 v16, s[8:11], s84 offen offset:2048 lds
    v_cvt_pk_bf16_f32 v30, 0, v66
    v_add_f32 v24, v24, v28
    v_add_f32 v25, v25, v29
    s_waitcnt lgkmcnt(2)
    v_mfma_f32_32x32x16_bf16 v[40:55], v[116:119], a[36:39], v[40:55]
    ds_read_b128 v[112:115], v6 offset:33024
    v_cvt_pk_bf16_f32 v108, v28, v29
    v_cvt_pk_bf16_f32 v31, 0, v67
    v_fma_f32 v30, v30, s36, -v21
    v_mfma_f32_32x32x16_bf16 v[72:87], v[116:119], a[100:103], v[72:87]
    v_fma_f32 v31, v31, s36, -v21
    v_exp_f32 v30, v30
    s_waitcnt lgkmcnt(2)
    v_mfma_f32_32x32x16_bf16 v[40:55], v[120:123], a[40:43], v[40:55]
    ds_read_b128 v[116:119], v7 offset:33024
    buffer_load_dwordx4 v17, s[8:11], s84 offen offset:3072 lds
    v_exp_f32 v31, v31
    v_cvt_pk_bf16_f32 v26, 0, v68
    v_mfma_f32_32x32x16_bf16 v[72:87], v[120:123], a[104:107], v[72:87]
    v_add_f32 v24, v24, v30
    v_add_f32 v25, v25, v31
    v_cvt_pk_bf16_f32 v109, v30, v31
    s_waitcnt lgkmcnt(2)
    v_mfma_f32_32x32x16_bf16 v[40:55], v[124:127], a[44:47], v[40:55]
    ds_read_b128 v[120:123], v8 offset:33024
    v_cvt_pk_bf16_f32 v27, 0, v69
    v_fma_f32 v26, v26, s36, -v21
    v_fma_f32 v27, v27, s36, -v21
    v_mfma_f32_32x32x16_bf16 v[72:87], v[124:127], a[108:111], v[72:87]
    v_exp_f32 v26, v26
    v_exp_f32 v27, v27
    s_waitcnt lgkmcnt(2)
    v_mfma_f32_32x32x16_bf16 v[40:55], v[112:115], a[48:51], v[40:55]
    ds_read_b128 v[124:127], v9 offset:33024
    v_cvt_pk_bf16_f32 v28, 0, v70
    v_add_f32 v24, v24, v26
    v_mfma_f32_32x32x16_bf16 v[72:87], v[112:115], a[112:115], v[72:87]
    v_add_f32 v25, v25, v27
    v_cvt_pk_bf16_f32 v110, v26, v27
    v_cvt_pk_bf16_f32 v29, 0, v71
    s_waitcnt lgkmcnt(2)
    v_mfma_f32_32x32x16_bf16 v[40:55], v[116:119], a[52:55], v[40:55]
    s_waitcnt vmcnt(9)
    s_barrier
    ds_read_b64_tr_b16 v[112:113], v10 offset:0
    ds_read_b64_tr_b16 v[114:115], v10 offset:4096
    v_fma_f32 v28, v28, s36, -v21
    v_fma_f32 v29, v29, s36, -v21
    v_exp_f32 v28, v28
    v_mfma_f32_32x32x16_bf16 v[72:87], v[116:119], a[116:119], v[72:87]
    v_exp_f32 v29, v29
    s_waitcnt lgkmcnt(3)
    v_mfma_f32_32x32x16_bf16 v[40:55], v[120:123], a[56:59], v[40:55]
    ds_read_b64_tr_b16 v[116:117], v11 offset:0
    ds_read_b64_tr_b16 v[118:119], v11 offset:4096
    s_nop 0
    v_add_f32 v24, v24, v28
    v_add_f32 v25, v25, v29
    v_mfma_f32_32x32x16_bf16 v[72:87], v[120:123], a[120:123], v[72:87]
    v_cvt_pk_bf16_f32 v111, v28, v29
    v_add_f32 v24, v24, v25
    s_waitcnt lgkmcnt(4)
    v_mfma_f32_32x32x16_bf16 v[40:55], v[124:127], a[60:63], v[40:55]
    ds_read_b64_tr_b16 v[120:121], v12 offset:0
    ds_read_b64_tr_b16 v[122:123], v12 offset:4096
    v_mfma_f32_32x32x16_bf16 v[72:87], v[124:127], a[124:127], v[72:87]
    s_add_u32 s84, s84, 32768
    v_cmp_lt_f32 vcc, s37, v24
    s_nop 1
    s_cbranch_vccnz Lslow_14
Lret_15:
    v_add_f32 v23, v23, v24
    s_waitcnt lgkmcnt(4)
    v_mfma_f32_32x32x16_bf16 v[128:143], v[112:115], v[88:91], v[128:143]
    ds_read_b64_tr_b16 v[124:125], v13 offset:0
    ds_read_b64_tr_b16 v[126:127], v13 offset:4096
    v_mfma_f32_32x32x16_bf16 a[128:143], v[112:115], v[104:107], a[128:143]
    s_add_u32 m0, s38, 98304
    s_nop 0
    buffer_load_dwordx4 v18, s[12:15], s34 offen offset:0 lds
    s_waitcnt lgkmcnt(4)
    v_mfma_f32_32x32x16_bf16 v[144:159], v[116:119], v[88:91], v[144:159]
    ds_read_b64_tr_b16 v[112:113], v10 offset:256
    ds_read_b64_tr_b16 v[114:115], v10 offset:4352
    v_cvt_pk_bf16_f32 v26, 0, v40
    v_cvt_pk_bf16_f32 v27, 0, v41
    v_fma_f32 v26, v26, s36, -v20
    v_fma_f32 v27, v27, s36, -v20
    v_mfma_f32_32x32x16_bf16 a[144:159], v[116:119], v[104:107], a[144:159]
    buffer_load_dwordx4 v19, s[12:15], s34 offen offset:1024 lds
    v_exp_f32 v26, v26
    v_exp_f32 v27, v27
    s_waitcnt lgkmcnt(4)
    v_mfma_f32_32x32x16_bf16 v[160:175], v[120:123], v[88:91], v[160:175]
    ds_read_b64_tr_b16 v[116:117], v11 offset:256
    ds_read_b64_tr_b16 v[118:119], v11 offset:4352
    v_cvt_pk_bf16_f32 v28, 0, v42
    v_add_f32 v24, v26, v27
    v_mfma_f32_32x32x16_bf16 a[160:175], v[120:123], v[104:107], a[160:175]
    v_cvt_pk_bf16_f32 v96, v26, v27
    v_cvt_pk_bf16_f32 v29, 0, v43
    v_fma_f32 v28, v28, s36, -v20
    s_waitcnt lgkmcnt(4)
    v_mfma_f32_32x32x16_bf16 v[176:191], v[124:127], v[88:91], v[176:191]
    ds_read_b64_tr_b16 v[120:121], v12 offset:256
    ds_read_b64_tr_b16 v[122:123], v12 offset:4352
    buffer_load_dwordx4 v18, s[12:15], s34 offen offset:2048 lds
    v_fma_f32 v29, v29, s36, -v20
    v_exp_f32 v28, v28
    v_mfma_f32_32x32x16_bf16 a[176:191], v[124:127], v[104:107], a[176:191]
    v_exp_f32 v29, v29
    v_cvt_pk_bf16_f32 v30, 0, v44
    s_waitcnt lgkmcnt(4)
    v_mfma_f32_32x32x16_bf16 v[192:207], v[112:115], v[88:91], v[192:207]
    ds_read_b64_tr_b16 v[124:125], v13 offset:256
    ds_read_b64_tr_b16 v[126:127], v13 offset:4352
    v_add_f32 v25, v28, v29
    v_cvt_pk_bf16_f32 v97, v28, v29
    v_cvt_pk_bf16_f32 v31, 0, v45
    v_mfma_f32_32x32x16_bf16 a[192:207], v[112:115], v[104:107], a[192:207]
    buffer_load_dwordx4 v19, s[12:15], s34 offen offset:3072 lds
    v_fma_f32 v30, v30, s36, -v20
    v_fma_f32 v31, v31, s36, -v20
    v_exp_f32 v30, v30
    s_waitcnt lgkmcnt(4)
    v_mfma_f32_32x32x16_bf16 v[208:223], v[116:119], v[88:91], v[208:223]
    ds_read_b64_tr_b16 v[112:113], v10 offset:8192
    ds_read_b64_tr_b16 v[114:115], v10 offset:12288
    v_exp_f32 v31, v31
    v_cvt_pk_bf16_f32 v26, 0, v46
    v_mfma_f32_32x32x16_bf16 a[208:223], v[116:119], v[104:107], a[208:223]
    v_add_f32 v24, v24, v30
    v_add_f32 v25, v25, v31
    v_cvt_pk_bf16_f32 v98, v30, v31
    s_waitcnt lgkmcnt(4)
    v_mfma_f32_32x32x16_bf16 v[224:239], v[120:123], v[88:91], v[224:239]
    ds_read_b64_tr_b16 v[116:117], v11 offset:8192
    ds_read_b64_tr_b16 v[118:119], v11 offset:12288
    s_add_u32 s34, s34, 32768
    s_add_u32 m0, s38, 114688
    v_cvt_pk_bf16_f32 v27, 0, v47
    buffer_load_dwordx4 v18, s[12:15], s85 offen offset:0 lds
    v_mfma_f32_32x32x16_bf16 a[224:239], v[120:123], v[104:107], a[224:239]
    v_fma_f32 v26, v26, s36, -v20
    v_fma_f32 v27, v27, s36, -v20
    v_exp_f32 v26, v26
    v_exp_f32 v27, v27
    s_waitcnt lgkmcnt(4)
    v_mfma_f32_32x32x16_bf16 v[240:255], v[124:127], v[88:91], v[240:255]
    ds_read_b64_tr_b16 v[120:121], v12 offset:8192
    ds_read_b64_tr_b16 v[122:123], v12 offset:12288
    v_cvt_pk_bf16_f32 v28, 0, v48
    v_add_f32 v24, v24, v26
    v_mfma_f32_32x32x16_bf16 a[240:255], v[124:127], v[104:107], a[240:255]
    buffer_load_dwordx4 v19, s[12:15], s85 offen offset:1024 lds
    v_add_f32 v25, v25, v27
    v_cvt_pk_bf16_f32 v99, v26, v27
    v_cvt_pk_bf16_f32 v29, 0, v49
    s_waitcnt lgkmcnt(4)
    v_mfma_f32_32x32x16_bf16 v[128:143], v[112:115], v[92:95], v[128:143]
    ds_read_b64_tr_b16 v[124:125], v13 offset:8192
    ds_read_b64_tr_b16 v[126:127], v13 offset:12288
    v_fma_f32 v28, v28, s36, -v20
    v_fma_f32 v29, v29, s36, -v20
    v_exp_f32 v28, v28
    v_mfma_f32_32x32x16_bf16 a[128:143], v[112:115], v[108:111], a[128:143]
    buffer_load_dwordx4 v18, s[12:15], s85 offen offset:2048 lds
    v_exp_f32 v29, v29
    v_cvt_pk_bf16_f32 v30, 0, v50
    s_waitcnt lgkmcnt(4)
    v_mfma_f32_32x32x16_bf16 v[144:159], v[116:119], v[92:95], v[144:159]
    ds_read_b64_tr_b16 v[112:113], v10 offset:8448
    ds_read_b64_tr_b16 v[114:115], v10 offset:12544
    v_add_f32 v24, v24, v28
    v_add_f32 v25, v25, v29
    v_cvt_pk_bf16_f32 v100, v28, v29
    v_mfma_f32_32x32x16_bf16 a[144:159], v[116:119], v[108:111], a[144:159]
    v_cvt_pk_bf16_f32 v31, 0, v51
    v_fma_f32 v30, v30, s36, -v20
    v_fma_f32 v31, v31, s36, -v20
    s_waitcnt lgkmcnt(4)
    v_mfma_f32_32x32x16_bf16 v[160:175], v[120:123], v[92:95], v[160:175]
    ds_read_b64_tr_b16 v[116:117], v11 offset:8448
    ds_read_b64_tr_b16 v[118:119], v11 offset:12544
    buffer_load_dwordx4 v19, s[12:15], s85 offen offset:3072 lds
    v_exp_f32 v30, v30
    v_mfma_f32_32x32x16_bf16 a[160:175], v[120:123], v[108:111], a[160:175]
    v_exp_f32 v31, v31
    v_cvt_pk_bf16_f32 v26, 0, v52
    v_add_f32 v24, v24, v30
    s_waitcnt lgkmcnt(4)
    v_mfma_f32_32x32x16_bf16 v[176:191], v[124:127], v[92:95], v[176:191]
    ds_read_b64_tr_b16 v[120:121], v12 offset:8448
    ds_read_b64_tr_b16 v[122:123], v12 offset:12544
    v_add_f32 v25, v25, v31
    v_cvt_pk_bf16_f32 v101, v30, v31
    v_cvt_pk_bf16_f32 v27, 0, v53
    v_mfma_f32_32x32x16_bf16 a[176:191], v[124:127], v[108:111], a[176:191]
    v_fma_f32 v26, v26, s36, -v20
    v_fma_f32 v27, v27, s36, -v20
    v_exp_f32 v26, v26
    s_waitcnt lgkmcnt(4)
    v_mfma_f32_32x32x16_bf16 v[192:207], v[112:115], v[92:95], v[192:207]
    ds_read_b64_tr_b16 v[124:125], v13 offset:8448
    ds_read_b64_tr_b16 v[126:127], v13 offset:12544
    v_exp_f32 v27, v27
    v_cvt_pk_bf16_f32 v28, 0, v54
    v_mfma_f32_32x32x16_bf16 a[192:207], v[112:115], v[108:111], a[192:207]
    v_add_f32 v24, v24, v26
    v_add_f32 v25, v25, v27
    v_cvt_pk_bf16_f32 v102, v26, v27
    s_waitcnt lgkmcnt(4)
    v_mfma_f32_32x32x16_bf16 v[208:223], v[116:119], v[92:95], v[208:223]
    s_waitcnt vmcnt(8)
    s_barrier
    ds_read_b128 v[112:115], v2 offset:0
    v_cvt_pk_bf16_f32 v29, 0, v55
    v_fma_f32 v28, v28, s36, -v20
    v_fma_f32 v29, v29, s36, -v20
    v_mfma_f32_32x32x16_bf16 a[208:223], v[116:119], v[108:111], a[208:223]
    v_exp_f32 v28, v28
    v_exp_f32 v29, v29
    s_waitcnt lgkmcnt(3)
    v_mfma_f32_32x32x16_bf16 v[224:239], v[120:123], v[92:95], v[224:239]
    ds_read_b128 v[116:119], v3 offset:0
    s_nop 0
    v_add_f32 v24, v24, v28
    v_mfma_f32_32x32x16_bf16 a[224:239], v[120:123], v[108:111], a[224:239]
    v_add_f32 v25, v25, v29
    v_cvt_pk_bf16_f32 v103, v28, v29
    v_add_f32 v24, v24, v25
    s_waitcnt lgkmcnt(2)
    v_mfma_f32_32x32x16_bf16 v[240:255], v[124:127], v[92:95], v[240:255]
    ds_read_b128 v[120:123], v4 offset:0
    v_mfma_f32_32x32x16_bf16 a[240:255], v[124:127], v[108:111], a[240:255]
    s_add_u32 s85, s85, 32768
    v_cmp_lt_f32 vcc, s37, v24
    s_nop 1
    s_cbranch_vccnz Lslow_16
Lret_17:
    v_add_f32 v22, v22, v24
    s_waitcnt lgkmcnt(2)
    v_mfma_f32_32x32x16_bf16 v[40:55], v[112:115], a[0:3], 0
    ds_read_b128 v[124:127], v5 offset:0
    v_cvt_pk_bf16_f32 v26, 0, v72
    v_cvt_pk_bf16_f32 v27, 0, v73
    v_fma_f32 v26, v26, s36, -v21
    v_mfma_f32_32x32x16_bf16 v[56:71], v[112:115], a[64:67], 0
    s_cmp_eq_u32 s35, 14
    s_cselect_b32 s94, s93, s91
    s_add_u32 s91, s91, 1024
    buffer_store_dwordx4 v[36:39], v14, s[24:27], s94 offen sc1
    s_add_u32 m0, s38, 32768
    v_fma_f32 v27, v27, s36, -v21
    buffer_load_dwordx4 v14, s[8:11], s33 offen offset:0 lds
    s_waitcnt lgkmcnt(2)
    v_mfma_f32_32x32x16_bf16 v[40:55], v[116:119], a[4:7], v[40:55]
    ds_read_b128 v[112:115], v6 offset:0
    v_exp_f32 v26, v26
    v_exp_f32 v27, v27
    v_cvt_pk_bf16_f32 v28, 0, v74
    v_mfma_f32_32x32x16_bf16 v[56:71], v[116:119], a[68:71], v[56:71]
    buffer_load_dwordx4 v15, s[8:11], s33 offen offset:1024 lds
    v_add_f32 v24, v26, v27
    v_cvt_pk_bf16_f32 v104, v26, v27
    v_cvt_pk_bf16_f32 v29, 0, v75
    s_waitcnt lgkmcnt(2)
    v_mfma_f32_32x32x16_bf16 v[40:55], v[120:123], a[8:11], v[40:55]
    ds_read_b128 v[116:119], v7 offset:0
    v_fma_f32 v28, v28, s36, -v21
    v_fma_f32 v29, v29, s36, -v21
    v_exp_f32 v28, v28
    v_mfma_f32_32x32x16_bf16 v[56:71], v[120:123], a[72:75], v[56:71]
    v_exp_f32 v29, v29
    s_waitcnt lgkmcnt(2)
    v_mfma_f32_32x32x16_bf16 v[40:55], v[124:127], a[12:15], v[40:55]
    ds_read_b128 v[120:123], v8 offset:0
    buffer_load_dwordx4 v16, s[8:11], s33 offen offset:2048 lds
    v_cvt_pk_bf16_f32 v30, 0, v76
    v_add_f32 v25, v28, v29
    v_cvt_pk_bf16_f32 v105, v28, v29
    v_mfma_f32_32x32x16_bf16 v[56:71], v[124:127], a[76:79], v[56:71]
    v_cvt_pk_bf16_f32 v31, 0, v77
    v_fma_f32 v30, v30, s36, -v21
    v_fma_f32 v31, v31, s36, -v21
    s_waitcnt lgkmcnt(2)
    v_mfma_f32_32x32x16_bf16 v[40:55], v[112:115], a[16:19], v[40:55]
    ds_read_b128 v[124:127], v9 offset:0
    v_exp_f32 v30, v30
    v_exp_f32 v31, v31
    v_mfma_f32_32x32x16_bf16 v[56:71], v[112:115], a[80:83], v[56:71]
    buffer_load_dwordx4 v17, s[8:11], s33 offen offset:3072 lds
    v_cvt_pk_bf16_f32 v26, 0, v78
    v_add_f32 v24, v24, v30
    s_waitcnt lgkmcnt(2)
    v_mfma_f32_32x32x16_bf16 v[40:55], v[116:119], a[20:23], v[40:55]
    ds_read_b128 v[112:115], v2 offset:256
    v_add_f32 v25, v25, v31
    v_cvt_pk_bf16_f32 v106, v30, v31
    v_cvt_pk_bf16_f32 v27, 0, v79
    v_mfma_f32_32x32x16_bf16 v[56:71], v[116:119], a[84:87], v[56:71]
    v_fma_f32 v26, v26, s36, -v21
    v_fma_f32 v27, v27, s36, -v21
    v_exp_f32 v26, v26
    s_waitcnt lgkmcnt(2)
    v_mfma_f32_32x32x16_bf16 v[40:55], v[120:123], a[24:27], v[40:55]
    ds_read_b128 v[116:119], v3 offset:256
    s_add_u32 s33, s33, 32768
    s_add_u32 m0, s38, 49152
    v_exp_f32 v27, v27
    buffer_load_dwordx4 v14, s[8:11], s84 offen offset:0 lds
    v_mfma_f32_32x32x16_bf16 v[56:71], v[120:123], a[88:91], v[56:71]
    v_cvt_pk_bf16_f32 v28, 0, v80
    v_add_f32 v24, v24, v26
    v_add_f32 v25, v25, v27
    s_waitcnt lgkmcnt(2)
    v_mfma_f32_32x32x16_bf16 v[40:55], v[124:127], a[28:31], v[40:55]
    ds_read_b128 v[120:123], v4 offset:256
    v_cvt_pk_bf16_f32 v107, v26, v27
    v_cvt_pk_bf16_f32 v29, 0, v81
    v_mfma_f32_32x32x16_bf16 v[56:71], v[124:127], a[92:95], v[56:71]
    buffer_load_dwordx4 v15, s[8:11], s84 offen offset:1024 lds
    v_fma_f32 v28, v28, s36, -v21
    v_fma_f32 v29, v29, s36, -v21
    v_exp_f32 v28, v28
    s_waitcnt lgkmcnt(2)
    v_mfma_f32_32x32x16_bf16 v[40:55], v[112:115], a[32:35], v[40:55]
    ds_read_b128 v[124:127], v5 offset:256
    v_exp_f32 v29, v29
    v_mfma_f32_32x32x16_bf16 v[56:71], v[112:115], a[96:99], v[56:71]
    buffer_load_dwordx4 v16, s[8:11], s84 offen offset:2048 lds
    v_cvt_pk_bf16_f32 v30, 0, v82
    v_add_f32 v24, v24, v28
    v_add_f32 v25, v25, v29
    s_waitcnt lgkmcnt(2)
    v_mfma_f32_32x32x16_bf16 v[40:55], v[116:119], a[36:39], v[40:55]
    ds_read_b128 v[112:115], v6 offset:256
    v_cvt_pk_bf16_f32 v108, v28, v29
    v_cvt_pk_bf16_f32 v31, 0, v83
    v_fma_f32 v30, v30, s36, -v21
    v_mfma_f32_32x32x16_bf16 v[56:71], v[116:119], a[100:103], v[56:71]
    v_fma_f32 v31, v31, s36, -v21
    v_exp_f32 v30, v30
    s_waitcnt lgkmcnt(2)
    v_mfma_f32_32x32x16_bf16 v[40:55], v[120:123], a[40:43], v[40:55]
    ds_read_b128 v[116:119], v7 offset:256
    buffer_load_dwordx4 v17, s[8:11], s84 offen offset:3072 lds
    v_exp_f32 v31, v31
    v_cvt_pk_bf16_f32 v26, 0, v84
    v_mfma_f32_32x32x16_bf16 v[56:71], v[120:123], a[104:107], v[56:71]
    v_add_f32 v24, v24, v30
    v_add_f32 v25, v25, v31
    v_cvt_pk_bf16_f32 v109, v30, v31
    s_waitcnt lgkmcnt(2)
    v_mfma_f32_32x32x16_bf16 v[40:55], v[124:127], a[44:47], v[40:55]
    ds_read_b128 v[120:123], v8 offset:256
    v_cvt_pk_bf16_f32 v27, 0, v85
    v_fma_f32 v26, v26, s36, -v21
    v_fma_f32 v27, v27, s36, -v21
    v_mfma_f32_32x32x16_bf16 v[56:71], v[124:127], a[108:111], v[56:71]
    v_exp_f32 v26, v26
    v_exp_f32 v27, v27
    s_waitcnt lgkmcnt(2)
    v_mfma_f32_32x32x16_bf16 v[40:55], v[112:115], a[48:51], v[40:55]
    ds_read_b128 v[124:127], v9 offset:256
    v_cvt_pk_bf16_f32 v28, 0, v86
    v_add_f32 v24, v24, v26
    v_mfma_f32_32x32x16_bf16 v[56:71], v[112:115], a[112:115], v[56:71]
    v_add_f32 v25, v25, v27
    v_cvt_pk_bf16_f32 v110, v26, v27
    v_cvt_pk_bf16_f32 v29, 0, v87
    s_waitcnt lgkmcnt(2)
    v_mfma_f32_32x32x16_bf16 v[40:55], v[116:119], a[52:55], v[40:55]
    s_waitcnt vmcnt(9)
    s_barrier
    ds_read_b64_tr_b16 v[112:113], v10 offset:32768
    ds_read_b64_tr_b16 v[114:115], v10 offset:36864
    v_fma_f32 v28, v28, s36, -v21
    v_fma_f32 v29, v29, s36, -v21
    v_exp_f32 v28, v28
    v_mfma_f32_32x32x16_bf16 v[56:71], v[116:119], a[116:119], v[56:71]
    v_exp_f32 v29, v29
    s_waitcnt lgkmcnt(3)
    v_mfma_f32_32x32x16_bf16 v[40:55], v[120:123], a[56:59], v[40:55]
    ds_read_b64_tr_b16 v[116:117], v11 offset:32768
    ds_read_b64_tr_b16 v[118:119], v11 offset:36864
    s_nop 0
    v_add_f32 v24, v24, v28
    v_add_f32 v25, v25, v29
    v_mfma_f32_32x32x16_bf16 v[56:71], v[120:123], a[120:123], v[56:71]
    v_cvt_pk_bf16_f32 v111, v28, v29
    v_add_f32 v24, v24, v25
    s_waitcnt lgkmcnt(4)
    v_mfma_f32_32x32x16_bf16 v[40:55], v[124:127], a[60:63], v[40:55]
    ds_read_b64_tr_b16 v[120:121], v12 offset:32768
    ds_read_b64_tr_b16 v[122:123], v12 offset:36864
    v_mfma_f32_32x32x16_bf16 v[56:71], v[124:127], a[124:127], v[56:71]
    s_add_u32 s84, s84, 32768
    v_cmp_lt_f32 vcc, s37, v24
    s_nop 1
    s_cbranch_vccnz Lslow_18
Lret_19:
    v_add_f32 v23, v23, v24
    s_waitcnt lgkmcnt(4)
    v_mfma_f32_32x32x16_bf16 v[128:143], v[112:115], v[96:99], v[128:143]
    ds_read_b64_tr_b16 v[124:125], v13 offset:32768
    ds_read_b64_tr_b16 v[126:127], v13 offset:36864
    v_mfma_f32_32x32x16_bf16 a[128:143], v[112:115], v[104:107], a[128:143]
    s_add_u32 m0, s38, 65536
    s_nop 0
    buffer_load_dwordx4 v18, s[12:15], s34 offen offset:0 lds
    s_waitcnt lgkmcnt(4)
    v_mfma_f32_32x32x16_bf16 v[144:159], v[116:119], v[96:99], v[144:159]
    ds_read_b64_tr_b16 v[112:113], v10 offset:33024
    ds_read_b64_tr_b16 v[114:115], v10 offset:37120
    v_cvt_pk_bf16_f32 v26, 0, v40
    v_cvt_pk_bf16_f32 v27, 0, v41
    v_fma_f32 v26, v26, s36, -v20
    v_fma_f32 v27, v27, s36, -v20
    v_mfma_f32_32x32x16_bf16 a[144:159], v[116:119], v[104:107], a[144:159]
    buffer_load_dwordx4 v19, s[12:15], s34 offen offset:1024 lds
    v_exp_f32 v26, v26
    v_exp_f32 v27, v27
    s_waitcnt lgkmcnt(4)
    v_mfma_f32_32x32x16_bf16 v[160:175], v[120:123], v[96:99], v[160:175]
    ds_read_b64_tr_b16 v[116:117], v11 offset:33024
    ds_read_b64_tr_b16 v[118:119], v11 offset:37120
    v_cvt_pk_bf16_f32 v28, 0, v42
    v_add_f32 v24, v26, v27
    v_mfma_f32_32x32x16_bf16 a[160:175], v[120:123], v[104:107], a[160:175]
    v_cvt_pk_bf16_f32 v88, v26, v27
    v_cvt_pk_bf16_f32 v29, 0, v43
    v_fma_f32 v28, v28, s36, -v20
    s_waitcnt lgkmcnt(4)
    v_mfma_f32_32x32x16_bf16 v[176:191], v[124:127], v[96:99], v[176:191]
    ds_read_b64_tr_b16 v[120:121], v12 offset:33024
    ds_read_b64_tr_b16 v[122:123], v12 offset:37120
    buffer_load_dwordx4 v18, s[12:15], s34 offen offset:2048 lds
    v_fma_f32 v29, v29, s36, -v20
    v_exp_f32 v28, v28
    v_mfma_f32_32x32x16_bf16 a[176:191], v[124:127], v[104:107], a[176:191]
    v_exp_f32 v29, v29
    v_cvt_pk_bf16_f32 v30, 0, v44
    s_waitcnt lgkmcnt(4)
    v_mfma_f32_32x32x16_bf16 v[192:207], v[112:115], v[96:99], v[192:207]
    ds_read_b64_tr_b16 v[124:125], v13 offset:33024
    ds_read_b64_tr_b16 v[126:127], v13 offset:37120
    v_add_f32 v25, v28, v29
    v_cvt_pk_bf16_f32 v89, v28, v29
    v_cvt_pk_bf16_f32 v31, 0, v45
    v_mfma_f32_32x32x16_bf16 a[192:207], v[112:115], v[104:107], a[192:207]
    buffer_load_dwordx4 v19, s[12:15], s34 offen offset:3072 lds
    v_fma_f32 v30, v30, s36, -v20
    v_fma_f32 v31, v31, s36, -v20
    v_exp_f32 v30, v30
    s_waitcnt lgkmcnt(4)
    v_mfma_f32_32x32x16_bf16 v[208:223], v[116:119], v[96:99], v[208:223]
    ds_read_b64_tr_b16 v[112:113], v10 offset:40960
    ds_read_b64_tr_b16 v[114:115], v10 offset:45056
    v_exp_f32 v31, v31
    v_cvt_pk_bf16_f32 v26, 0, v46
    v_mfma_f32_32x32x16_bf16 a[208:223], v[116:119], v[104:107], a[208:223]
    v_add_f32 v24, v24, v30
    v_add_f32 v25, v25, v31
    v_cvt_pk_bf16_f32 v90, v30, v31
    s_waitcnt lgkmcnt(4)
    v_mfma_f32_32x32x16_bf16 v[224:239], v[120:123], v[96:99], v[224:239]
    ds_read_b64_tr_b16 v[116:117], v11 offset:40960
    ds_read_b64_tr_b16 v[118:119], v11 offset:45056
    s_add_u32 s34, s34, 32768
    s_add_u32 m0, s38, 81920
    v_cvt_pk_bf16_f32 v27, 0, v47
    buffer_load_dwordx4 v18, s[12:15], s85 offen offset:0 lds
    v_mfma_f32_32x32x16_bf16 a[224:239], v[120:123], v[104:107], a[224:239]
    v_fma_f32 v26, v26, s36, -v20
    v_fma_f32 v27, v27, s36, -v20
    v_exp_f32 v26, v26
    v_exp_f32 v27, v27
    s_waitcnt lgkmcnt(4)
    v_mfma_f32_32x32x16_bf16 v[240:255], v[124:127], v[96:99], v[240:255]
    ds_read_b64_tr_b16 v[120:121], v12 offset:40960
    ds_read_b64_tr_b16 v[122:123], v12 offset:45056
    v_cvt_pk_bf16_f32 v28, 0, v48
    v_add_f32 v24, v24, v26
    v_mfma_f32_32x32x16_bf16 a[240:255], v[124:127], v[104:107], a[240:255]
    buffer_load_dwordx4 v19, s[12:15], s85 offen offset:1024 lds
    v_add_f32 v25, v25, v27
    v_cvt_pk_bf16_f32 v91, v26, v27
    v_cvt_pk_bf16_f32 v29, 0, v49
    s_waitcnt lgkmcnt(4)
    v_mfma_f32_32x32x16_bf16 v[128:143], v[112:115], v[100:103], v[128:143]
    ds_read_b64_tr_b16 v[124:125], v13 offset:40960
    ds_read_b64_tr_b16 v[126:127], v13 offset:45056
    v_fma_f32 v28, v28, s36, -v20
    v_fma_f32 v29, v29, s36, -v20
    v_exp_f32 v28, v28
    v_mfma_f32_32x32x16_bf16 a[128:143], v[112:115], v[108:111], a[128:143]
    buffer_load_dwordx4 v18, s[12:15], s85 offen offset:2048 lds
    v_exp_f32 v29, v29
    v_cvt_pk_bf16_f32 v30, 0, v50
    s_waitcnt lgkmcnt(4)
    v_mfma_f32_32x32x16_bf16 v[144:159], v[116:119], v[100:103], v[144:159]
    ds_read_b64_tr_b16 v[112:113], v10 offset:41216
    ds_read_b64_tr_b16 v[114:115], v10 offset:45312
    v_add_f32 v24, v24, v28
    v_add_f32 v25, v25, v29
    v_cvt_pk_bf16_f32 v92, v28, v29
    v_mfma_f32_32x32x16_bf16 a[144:159], v[116:119], v[108:111], a[144:159]
    v_cvt_pk_bf16_f32 v31, 0, v51
    v_fma_f32 v30, v30, s36, -v20
    v_fma_f32 v31, v31, s36, -v20
    s_waitcnt lgkmcnt(4)
    v_mfma_f32_32x32x16_bf16 v[160:175], v[120:123], v[100:103], v[160:175]
    ds_read_b64_tr_b16 v[116:117], v11 offset:41216
    ds_read_b64_tr_b16 v[118:119], v11 offset:45312
    buffer_load_dwordx4 v19, s[12:15], s85 offen offset:3072 lds
    v_exp_f32 v30, v30
    v_mfma_f32_32x32x16_bf16 a[160:175], v[120:123], v[108:111], a[160:175]
    v_exp_f32 v31, v31
    v_cvt_pk_bf16_f32 v26, 0, v52
    v_add_f32 v24, v24, v30
    s_waitcnt lgkmcnt(4)
    v_mfma_f32_32x32x16_bf16 v[176:191], v[124:127], v[100:103], v[176:191]
    ds_read_b64_tr_b16 v[120:121], v12 offset:41216
    ds_read_b64_tr_b16 v[122:123], v12 offset:45312
    v_add_f32 v25, v25, v31
    v_cvt_pk_bf16_f32 v93, v30, v31
    v_cvt_pk_bf16_f32 v27, 0, v53
    v_mfma_f32_32x32x16_bf16 a[176:191], v[124:127], v[108:111], a[176:191]
    v_fma_f32 v26, v26, s36, -v20
    v_fma_f32 v27, v27, s36, -v20
    v_exp_f32 v26, v26
    s_waitcnt lgkmcnt(4)
    v_mfma_f32_32x32x16_bf16 v[192:207], v[112:115], v[100:103], v[192:207]
    ds_read_b64_tr_b16 v[124:125], v13 offset:41216
    ds_read_b64_tr_b16 v[126:127], v13 offset:45312
    v_exp_f32 v27, v27
    v_cvt_pk_bf16_f32 v28, 0, v54
    v_mfma_f32_32x32x16_bf16 a[192:207], v[112:115], v[108:111], a[192:207]
    v_add_f32 v24, v24, v26
    v_add_f32 v25, v25, v27
    v_cvt_pk_bf16_f32 v94, v26, v27
    s_waitcnt lgkmcnt(4)
    v_mfma_f32_32x32x16_bf16 v[208:223], v[116:119], v[100:103], v[208:223]
    s_waitcnt vmcnt(8)
    s_barrier
    ds_read_b128 v[112:115], v2 offset:32768
    v_cvt_pk_bf16_f32 v29, 0, v55
    v_fma_f32 v28, v28, s36, -v20
    v_fma_f32 v29, v29, s36, -v20
    v_mfma_f32_32x32x16_bf16 a[208:223], v[116:119], v[108:111], a[208:223]
    v_exp_f32 v28, v28
    v_exp_f32 v29, v29
    s_waitcnt lgkmcnt(3)
    v_mfma_f32_32x32x16_bf16 v[224:239], v[120:123], v[100:103], v[224:239]
    ds_read_b128 v[116:119], v3 offset:32768
    s_nop 0
    v_add_f32 v24, v24, v28
    v_mfma_f32_32x32x16_bf16 a[224:239], v[120:123], v[108:111], a[224:239]
    v_add_f32 v25, v25, v29
    v_cvt_pk_bf16_f32 v95, v28, v29
    v_add_f32 v24, v24, v25
    s_waitcnt lgkmcnt(2)
    v_mfma_f32_32x32x16_bf16 v[240:255], v[124:127], v[100:103], v[240:255]
    ds_read_b128 v[120:123], v4 offset:32768
    v_mfma_f32_32x32x16_bf16 a[240:255], v[124:127], v[108:111], a[240:255]
    s_add_u32 s85, s85, 32768
    v_cmp_lt_f32 vcc, s37, v24
    s_nop 1
    s_cbranch_vccnz Lslow_20
Lret_21:
    v_add_f32 v22, v22, v24
    s_add_u32 s35, s35, 1
    s_cmp_lt_u32 s35, 15
    s_cbranch_scc1 Lloop_13
    s_lshl_b32 s54, s29, 9
    s_lshl_b32 s43, s31, 8
    s_add_u32 s54, s54, s43
    s_lshl_b32 s43, s32, 5
    s_add_u32 s54, s54, s43
    s_mul_i32 s54, s54, 896
    v_lshrrev_b32 v33, 3, v1
    v_bfe_u32 v34, v33, 1, 1
    v_lshlrev_b32 v34, 2, v34
    v_and_b32 v35, 7, v1
    v_xor_b32 v34, v34, v35
    v_mul_u32_u24 v33, 896, v33
    v_lshl_add_u32 v33, v34, 4, v33
    v_add_u32 v14, 0, v33
    v_add_u32 v15, 6144, v33
    v_add_u32 v16, 12288, v33
    v_add_u32 v17, 18432, v33
    v_lshlrev_b32 v36, 4, v1
    s_lshl_b32 s40, s32, 15
    s_lshl_b32 s41, s31, 14
    s_add_u32 s40, 98304, s40
    s_add_u32 s40, s40, s41
    s_lshl_b32 s41, s28, 10
    s_add_u32 s41, s41, 98304
    v_add_u32 v38, s41, v36
    v_add_u32 v36, s40, v36
    v_xor_b32 v37, 16384, v36
    v_xor_b32 v39, 2048, v38
    s_waitcnt lgkmcnt(2)
    v_mfma_f32_32x32x16_bf16 v[40:55], v[112:115], a[0:3], 0
    ds_read_b128 v[124:127], v5 offset:32768
    v_cvt_pk_bf16_f32 v26, 0, v56
    v_cvt_pk_bf16_f32 v27, 0, v57
    v_fma_f32 v26, v26, s36, -v21
    v_mfma_f32_32x32x16_bf16 v[72:87], v[112:115], a[64:67], 0
    s_add_u32 m0, s38, 131072
    v_fma_f32 v27, v27, s36, -v21
    buffer_load_dwordx4 v18, s[12:15], s34 offen offset:0 lds
    v_exp_f32 v26, v26
    s_waitcnt lgkmcnt(2)
    v_mfma_f32_32x32x16_bf16 v[40:55], v[116:119], a[4:7], v[40:55]
    ds_read_b128 v[112:115], v6 offset:32768
    v_exp_f32 v27, v27
    v_cvt_pk_bf16_f32 v28, 0, v58
    v_mfma_f32_32x32x16_bf16 v[72:87], v[116:119], a[68:71], v[72:87]
    buffer_load_dwordx4 v19, s[12:15], s34 offen offset:1024 lds
    v_add_f32 v24, v26, v27
    v_cvt_pk_bf16_f32 v104, v26, v27
    v_cvt_pk_bf16_f32 v29, 0, v59
    s_waitcnt lgkmcnt(2)
    v_mfma_f32_32x32x16_bf16 v[40:55], v[120:123], a[8:11], v[40:55]
    ds_read_b128 v[116:119], v7 offset:32768
    v_fma_f32 v28, v28, s36, -v21
    v_fma_f32 v29, v29, s36, -v21
    v_exp_f32 v28, v28
    v_mfma_f32_32x32x16_bf16 v[72:87], v[120:123], a[72:75], v[72:87]
    v_exp_f32 v29, v29
    s_waitcnt lgkmcnt(2)
    v_mfma_f32_32x32x16_bf16 v[40:55], v[124:127], a[12:15], v[40:55]
    ds_read_b128 v[120:123], v8 offset:32768
    buffer_load_dwordx4 v18, s[12:15], s34 offen offset:2048 lds
    v_cvt_pk_bf16_f32 v30, 0, v60
    v_add_f32 v25, v28, v29
    v_cvt_pk_bf16_f32 v105, v28, v29
    v_mfma_f32_32x32x16_bf16 v[72:87], v[124:127], a[76:79], v[72:87]
    v_cvt_pk_bf16_f32 v31, 0, v61
    v_fma_f32 v30, v30, s36, -v21
    v_fma_f32 v31, v31, s36, -v21
    s_waitcnt lgkmcnt(2)
    v_mfma_f32_32x32x16_bf16 v[40:55], v[112:115], a[16:19], v[40:55]
    ds_read_b128 v[124:127], v9 offset:32768
    v_exp_f32 v30, v30
    v_exp_f32 v31, v31
    v_mfma_f32_32x32x16_bf16 v[72:87], v[112:115], a[80:83], v[72:87]
    buffer_load_dwordx4 v19, s[12:15], s34 offen offset:3072 lds
    v_cvt_pk_bf16_f32 v26, 0, v62
    v_add_f32 v24, v24, v30
    s_waitcnt lgkmcnt(2)
    v_mfma_f32_32x32x16_bf16 v[40:55], v[116:119], a[20:23], v[40:55]
    ds_read_b128 v[112:115], v2 offset:33024
    v_add_f32 v25, v25, v31
    v_cvt_pk_bf16_f32 v106, v30, v31
    v_cvt_pk_bf16_f32 v27, 0, v63
    v_mfma_f32_32x32x16_bf16 v[72:87], v[116:119], a[84:87], v[72:87]
    v_fma_f32 v26, v26, s36, -v21
    v_fma_f32 v27, v27, s36, -v21
    v_exp_f32 v26, v26
    s_waitcnt lgkmcnt(2)
    v_mfma_f32_32x32x16_bf16 v[40:55], v[120:123], a[24:27], v[40:55]
    ds_read_b128 v[116:119], v3 offset:33024
    s_add_u32 s34, s34, 32768
    s_add_u32 m0, s38, 147456
    v_exp_f32 v27, v27
    buffer_load_dwordx4 v18, s[12:15], s85 offen offset:0 lds
    v_mfma_f32_32x32x16_bf16 v[72:87], v[120:123], a[88:91], v[72:87]
    v_cvt_pk_bf16_f32 v28, 0, v64
    v_add_f32 v24, v24, v26
    v_add_f32 v25, v25, v27
    s_waitcnt lgkmcnt(2)
    v_mfma_f32_32x32x16_bf16 v[40:55], v[124:127], a[28:31], v[40:55]
    ds_read_b128 v[120:123], v4 offset:33024
    v_cvt_pk_bf16_f32 v107, v26, v27
    v_cvt_pk_bf16_f32 v29, 0, v65
    v_mfma_f32_32x32x16_bf16 v[72:87], v[124:127], a[92:95], v[72:87]
    buffer_load_dwordx4 v19, s[12:15], s85 offen offset:1024 lds
    v_fma_f32 v28, v28, s36, -v21
    v_fma_f32 v29, v29, s36, -v21
    v_exp_f32 v28, v28
    s_waitcnt lgkmcnt(2)
    v_mfma_f32_32x32x16_bf16 v[40:55], v[112:115], a[32:35], v[40:55]
    ds_read_b128 v[124:127], v5 offset:33024
    v_exp_f32 v29, v29
    v_mfma_f32_32x32x16_bf16 v[72:87], v[112:115], a[96:99], v[72:87]
    buffer_load_dwordx4 v18, s[12:15], s85 offen offset:2048 lds
    v_cvt_pk_bf16_f32 v30, 0, v66
    v_add_f32 v24, v24, v28
    v_add_f32 v25, v25, v29
    s_waitcnt lgkmcnt(2)
    v_mfma_f32_32x32x16_bf16 v[40:55], v[116:119], a[36:39], v[40:55]
    ds_read_b128 v[112:115], v6 offset:33024
    v_cvt_pk_bf16_f32 v108, v28, v29
    v_cvt_pk_bf16_f32 v31, 0, v67
    v_fma_f32 v30, v30, s36, -v21
    v_mfma_f32_32x32x16_bf16 v[72:87], v[116:119], a[100:103], v[72:87]
    v_fma_f32 v31, v31, s36, -v21
    v_exp_f32 v30, v30
    s_waitcnt lgkmcnt(2)
    v_mfma_f32_32x32x16_bf16 v[40:55], v[120:123], a[40:43], v[40:55]
    ds_read_b128 v[116:119], v7 offset:33024
    buffer_load_dwordx4 v19, s[12:15], s85 offen offset:3072 lds
    v_exp_f32 v31, v31
    v_cvt_pk_bf16_f32 v26, 0, v68
    v_mfma_f32_32x32x16_bf16 v[72:87], v[120:123], a[104:107], v[72:87]
    v_add_f32 v24, v24, v30
    v_add_f32 v25, v25, v31
    v_cvt_pk_bf16_f32 v109, v30, v31
    s_waitcnt lgkmcnt(2)
    v_mfma_f32_32x32x16_bf16 v[40:55], v[124:127], a[44:47], v[40:55]
    ds_read_b128 v[120:123], v8 offset:33024
    v_cvt_pk_bf16_f32 v27, 0, v69
    v_fma_f32 v26, v26, s36, -v21
    v_fma_f32 v27, v27, s36, -v21
    v_mfma_f32_32x32x16_bf16 v[72:87], v[124:127], a[108:111], v[72:87]
    v_exp_f32 v26, v26
    v_exp_f32 v27, v27
    s_waitcnt lgkmcnt(2)
    v_mfma_f32_32x32x16_bf16 v[40:55], v[112:115], a[48:51], v[40:55]
    ds_read_b128 v[124:127], v9 offset:33024
    v_cvt_pk_bf16_f32 v28, 0, v70
    v_add_f32 v24, v24, v26
    v_mfma_f32_32x32x16_bf16 v[72:87], v[112:115], a[112:115], v[72:87]
    v_add_f32 v25, v25, v27
    v_cvt_pk_bf16_f32 v110, v26, v27
    v_cvt_pk_bf16_f32 v29, 0, v71
    s_waitcnt lgkmcnt(2)
    v_mfma_f32_32x32x16_bf16 v[40:55], v[116:119], a[52:55], v[40:55]
    s_waitcnt vmcnt(8)
    s_barrier
    ds_read_b64_tr_b16 v[112:113], v10 offset:0
    ds_read_b64_tr_b16 v[114:115], v10 offset:4096
    v_fma_f32 v28, v28, s36, -v21
    v_fma_f32 v29, v29, s36, -v21
    v_exp_f32 v28, v28
    v_mfma_f32_32x32x16_bf16 v[72:87], v[116:119], a[116:119], v[72:87]
    v_exp_f32 v29, v29
    s_waitcnt lgkmcnt(3)
    v_mfma_f32_32x32x16_bf16 v[40:55], v[120:123], a[56:59], v[40:55]
    ds_read_b64_tr_b16 v[116:117], v11 offset:0
    ds_read_b64_tr_b16 v[118:119], v11 offset:4096
    s_nop 0
    v_add_f32 v24, v24, v28
    v_add_f32 v25, v25, v29
    v_mfma_f32_32x32x16_bf16 v[72:87], v[120:123], a[120:123], v[72:87]
    v_cvt_pk_bf16_f32 v111, v28, v29
    v_add_f32 v24, v24, v25
    s_waitcnt lgkmcnt(4)
    v_mfma_f32_32x32x16_bf16 v[40:55], v[124:127], a[60:63], v[40:55]
    ds_read_b64_tr_b16 v[120:121], v12 offset:0
    ds_read_b64_tr_b16 v[122:123], v12 offset:4096
    v_mfma_f32_32x32x16_bf16 v[72:87], v[124:127], a[124:127], v[72:87]
    s_add_u32 s85, s85, 32768
    v_cmp_lt_f32 vcc, s37, v24
    s_nop 1
    s_cbranch_vccnz Lslow_22
Lret_23:
    v_add_f32 v23, v23, v24
    s_waitcnt lgkmcnt(4)
    v_mfma_f32_32x32x16_bf16 v[128:143], v[112:115], v[88:91], v[128:143]
    ds_read_b64_tr_b16 v[124:125], v13 offset:0
    ds_read_b64_tr_b16 v[126:127], v13 offset:4096
    v_mfma_f32_32x32x16_bf16 a[128:143], v[112:115], v[104:107], a[128:143]
    s_add_u32 m0, s38, 0
    s_nop 0
    s_add_u32 s43, s54, 0
    buffer_load_dwordx4 v14, s[20:23], s43 offen offset:0 lds
    s_waitcnt lgkmcnt(4)
    v_mfma_f32_32x32x16_bf16 v[144:159], v[116:119], v[88:91], v[144:159]
    ds_read_b64_tr_b16 v[112:113], v10 offset:256
    ds_read_b64_tr_b16 v[114:115], v10 offset:4352
    v_cvt_pk_bf16_f32 v26, 0, v40
    v_cvt_pk_bf16_f32 v27, 0, v41
    v_fma_f32 v26, v26, s36, -v20
    v_fma_f32 v27, v27, s36, -v20
    v_mfma_f32_32x32x16_bf16 a[144:159], v[116:119], v[104:107], a[144:159]
    buffer_load_dwordx4 v15, s[20:23], s43 offen offset:1024 lds
    v_exp_f32 v26, v26
    v_exp_f32 v27, v27
    s_waitcnt lgkmcnt(4)
    v_mfma_f32_32x32x16_bf16 v[160:175], v[120:123], v[88:91], v[160:175]
    ds_read_b64_tr_b16 v[116:117], v11 offset:256
    ds_read_b64_tr_b16 v[118:119], v11 offset:4352
    v_cvt_pk_bf16_f32 v28, 0, v42
    v_add_f32 v24, v26, v27
    v_mfma_f32_32x32x16_bf16 a[160:175], v[120:123], v[104:107], a[160:175]
    v_cvt_pk_bf16_f32 v96, v26, v27
    v_cvt_pk_bf16_f32 v29, 0, v43
    v_fma_f32 v28, v28, s36, -v20
    s_waitcnt lgkmcnt(4)
    v_mfma_f32_32x32x16_bf16 v[176:191], v[124:127], v[88:91], v[176:191]
    ds_read_b64_tr_b16 v[120:121], v12 offset:256
    ds_read_b64_tr_b16 v[122:123], v12 offset:4352
    buffer_load_dwordx4 v16, s[20:23], s43 offen offset:2048 lds
    v_fma_f32 v29, v29, s36, -v20
    v_exp_f32 v28, v28
    v_mfma_f32_32x32x16_bf16 a[176:191], v[124:127], v[104:107], a[176:191]
    v_exp_f32 v29, v29
    v_cvt_pk_bf16_f32 v30, 0, v44
    s_waitcnt lgkmcnt(4)
    v_mfma_f32_32x32x16_bf16 v[192:207], v[112:115], v[88:91], v[192:207]
    ds_read_b64_tr_b16 v[124:125], v13 offset:256
    ds_read_b64_tr_b16 v[126:127], v13 offset:4352
    v_add_f32 v25, v28, v29
    v_cvt_pk_bf16_f32 v97, v28, v29
    v_cvt_pk_bf16_f32 v31, 0, v45
    v_mfma_f32_32x32x16_bf16 a[192:207], v[112:115], v[104:107], a[192:207]
    buffer_load_dwordx4 v17, s[20:23], s43 offen offset:3072 lds
    v_fma_f32 v30, v30, s36, -v20
    v_fma_f32 v31, v31, s36, -v20
    v_exp_f32 v30, v30
    s_waitcnt lgkmcnt(4)
    v_mfma_f32_32x32x16_bf16 v[208:223], v[116:119], v[88:91], v[208:223]
    ds_read_b64_tr_b16 v[112:113], v10 offset:8192
    ds_read_b64_tr_b16 v[114:115], v10 offset:12288
    v_exp_f32 v31, v31
    v_cvt_pk_bf16_f32 v26, 0, v46
    v_mfma_f32_32x32x16_bf16 a[208:223], v[116:119], v[104:107], a[208:223]
    v_add_f32 v24, v24, v30
    v_add_f32 v25, v25, v31
    v_cvt_pk_bf16_f32 v98, v30, v31
    s_waitcnt lgkmcnt(4)
    v_mfma_f32_32x32x16_bf16 v[224:239], v[120:123], v[88:91], v[224:239]
    ds_read_b64_tr_b16 v[116:117], v11 offset:8192
    ds_read_b64_tr_b16 v[118:119], v11 offset:12288
    s_add_u32 m0, s38, 16384
    v_cvt_pk_bf16_f32 v27, 0, v47
    s_add_u32 s43, s54, 57344
    buffer_load_dwordx4 v14, s[20:23], s43 offen offset:0 lds
    v_mfma_f32_32x32x16_bf16 a[224:239], v[120:123], v[104:107], a[224:239]
    v_fma_f32 v26, v26, s36, -v20
    v_fma_f32 v27, v27, s36, -v20
    v_exp_f32 v26, v26
    v_exp_f32 v27, v27
    s_waitcnt lgkmcnt(4)
    v_mfma_f32_32x32x16_bf16 v[240:255], v[124:127], v[88:91], v[240:255]
    ds_read_b64_tr_b16 v[120:121], v12 offset:8192
    ds_read_b64_tr_b16 v[122:123], v12 offset:12288
    v_cvt_pk_bf16_f32 v28, 0, v48
    v_add_f32 v24, v24, v26
    v_mfma_f32_32x32x16_bf16 a[240:255], v[124:127], v[104:107], a[240:255]
    buffer_load_dwordx4 v15, s[20:23], s43 offen offset:1024 lds
    v_add_f32 v25, v25, v27
    v_cvt_pk_bf16_f32 v99, v26, v27
    v_cvt_pk_bf16_f32 v29, 0, v49
    s_waitcnt lgkmcnt(4)
    v_mfma_f32_32x32x16_bf16 v[128:143], v[112:115], v[92:95], v[128:143]
    ds_read_b64_tr_b16 v[124:125], v13 offset:8192
    ds_read_b64_tr_b16 v[126:127], v13 offset:12288
    v_fma_f32 v28, v28, s36, -v20
    v_fma_f32 v29, v29, s36, -v20
    v_exp_f32 v28, v28
    v_mfma_f32_32x32x16_bf16 a[128:143], v[112:115], v[108:111], a[128:143]
    buffer_load_dwordx4 v16, s[20:23], s43 offen offset:2048 lds
    v_exp_f32 v29, v29
    v_cvt_pk_bf16_f32 v30, 0, v50
    s_waitcnt lgkmcnt(4)
    v_mfma_f32_32x32x16_bf16 v[144:159], v[116:119], v[92:95], v[144:159]
    ds_read_b64_tr_b16 v[112:113], v10 offset:8448
    ds_read_b64_tr_b16 v[114:115], v10 offset:12544
    v_add_f32 v24, v24, v28
    v_add_f32 v25, v25, v29
    v_cvt_pk_bf16_f32 v100, v28, v29
    v_mfma_f32_32x32x16_bf16 a[144:159], v[116:119], v[108:111], a[144:159]
    v_cvt_pk_bf16_f32 v31, 0, v51
    v_fma_f32 v30, v30, s36, -v20
    v_fma_f32 v31, v31, s36, -v20
    s_waitcnt lgkmcnt(4)
    v_mfma_f32_32x32x16_bf16 v[160:175], v[120:123], v[92:95], v[160:175]
    ds_read_b64_tr_b16 v[116:117], v11 offset:8448
    ds_read_b64_tr_b16 v[118:119], v11 offset:12544
    buffer_load_dwordx4 v17, s[20:23], s43 offen offset:3072 lds
    v_exp_f32 v30, v30
    v_mfma_f32_32x32x16_bf16 a[160:175], v[120:123], v[108:111], a[160:175]
    v_exp_f32 v31, v31
    v_cvt_pk_bf16_f32 v26, 0, v52
    v_add_f32 v24, v24, v30
    s_waitcnt lgkmcnt(4)
    v_mfma_f32_32x32x16_bf16 v[176:191], v[124:127], v[92:95], v[176:191]
    ds_read_b64_tr_b16 v[120:121], v12 offset:8448
    ds_read_b64_tr_b16 v[122:123], v12 offset:12544
    v_add_f32 v25, v25, v31
    v_cvt_pk_bf16_f32 v101, v30, v31
    v_cvt_pk_bf16_f32 v27, 0, v53
    v_mfma_f32_32x32x16_bf16 a[176:191], v[124:127], v[108:111], a[176:191]
    v_fma_f32 v26, v26, s36, -v20
    v_fma_f32 v27, v27, s36, -v20
    v_exp_f32 v26, v26
    s_waitcnt lgkmcnt(4)
    v_mfma_f32_32x32x16_bf16 v[192:207], v[112:115], v[92:95], v[192:207]
    ds_read_b64_tr_b16 v[124:125], v13 offset:8448
    ds_read_b64_tr_b16 v[126:127], v13 offset:12544
    v_exp_f32 v27, v27
    v_cvt_pk_bf16_f32 v28, 0, v54
    v_mfma_f32_32x32x16_bf16 a[192:207], v[112:115], v[108:111], a[192:207]
    v_add_f32 v24, v24, v26
    v_add_f32 v25, v25, v27
    v_cvt_pk_bf16_f32 v102, v26, v27
    s_waitcnt lgkmcnt(4)
    v_mfma_f32_32x32x16_bf16 v[208:223], v[116:119], v[92:95], v[208:223]
    s_waitcnt vmcnt(8)
    s_barrier
    v_add_u32 v10, 65536, v10
    v_add_u32 v11, 65536, v11
    v_add_u32 v12, 65536, v12
    v_add_u32 v13, 65536, v13
    ds_read_b64_tr_b16 v[112:113], v10 offset:0
    ds_read_b64_tr_b16 v[114:115], v10 offset:4096
    v_cvt_pk_bf16_f32 v29, 0, v55
    v_fma_f32 v28, v28, s36, -v20
    v_fma_f32 v29, v29, s36, -v20
    v_mfma_f32_32x32x16_bf16 a[208:223], v[116:119], v[108:111], a[208:223]
    ds_read_b64_tr_b16 v[116:117], v11 offset:0
    ds_read_b64_tr_b16 v[118:119], v11 offset:4096
    v_exp_f32 v28, v28
    v_exp_f32 v29, v29
    s_waitcnt lgkmcnt(6)
    v_mfma_f32_32x32x16_bf16 v[224:239], v[120:123], v[92:95], v[224:239]
    s_nop 0
    v_add_f32 v24, v24, v28
    v_mfma_f32_32x32x16_bf16 a[224:239], v[120:123], v[108:111], a[224:239]
    ds_read_b64_tr_b16 v[120:121], v12 offset:0
    ds_read_b64_tr_b16 v[122:123], v12 offset:4096
    v_add_f32 v25, v25, v29
    v_cvt_pk_bf16_f32 v103, v28, v29
    v_add_f32 v24, v24, v25
    s_waitcnt lgkmcnt(6)
    v_mfma_f32_32x32x16_bf16 v[240:255], v[124:127], v[92:95], v[240:255]
    v_mfma_f32_32x32x16_bf16 a[240:255], v[124:127], v[108:111], a[240:255]
    ds_read_b64_tr_b16 v[124:125], v13 offset:0
    ds_read_b64_tr_b16 v[126:127], v13 offset:4096
    ds_read_b64_tr_b16 v[56:57], v10 offset:256
    ds_read_b64_tr_b16 v[58:59], v10 offset:4352
    ds_read_b64_tr_b16 v[60:61], v11 offset:256
    ds_read_b64_tr_b16 v[62:63], v11 offset:4352
    v_cmp_lt_f32 vcc, s37, v24
    s_nop 1
    s_cbranch_vccnz Lslow_24
Lret_25:
    v_add_f32 v22, v22, v24
    s_waitcnt lgkmcnt(10)
    v_mfma_f32_32x32x16_bf16 v[128:143], v[112:115], v[96:99], v[128:143]
    ds_read_b64_tr_b16 v[64:65], v12 offset:256
    ds_read_b64_tr_b16 v[66:67], v12 offset:4352
    v_cvt_pk_bf16_f32 v26, 0, v72
    v_cvt_pk_bf16_f32 v27, 0, v73
    v_fma_f32 v26, v26, s36, -v21
    v_fma_f32 v27, v27, s36, -v21
    s_waitcnt lgkmcnt(10)
    v_mfma_f32_32x32x16_bf16 v[144:159], v[116:119], v[96:99], v[144:159]
    ds_read_b64_tr_b16 v[68:69], v13 offset:256
    ds_read_b64_tr_b16 v[70:71], v13 offset:4352
    s_add_u32 m0, s38, 32768
    v_exp_f32 v26, v26
    s_add_u32 s43, s54, 114688
    buffer_load_dwordx4 v14, s[20:23], s43 offen offset:0 lds
    v_exp_f32 v27, v27
    s_waitcnt lgkmcnt(10)
    v_mfma_f32_32x32x16_bf16 v[160:175], v[120:123], v[96:99], v[160:175]
    ds_read_b64_tr_b16 v[112:113], v10 offset:8192
    ds_read_b64_tr_b16 v[114:115], v10 offset:12288
    buffer_load_dwordx4 v15, s[20:23], s43 offen offset:1024 lds
    v_cvt_pk_bf16_f32 v28, 0, v74
    v_add_f32 v24, v26, v27
    v_cvt_pk_bf16_f32 v104, v26, v27
    v_cvt_pk_bf16_f32 v29, 0, v75
    v_fma_f32 v28, v28, s36, -v21
    s_waitcnt lgkmcnt(10)
    v_mfma_f32_32x32x16_bf16 v[176:191], v[124:127], v[96:99], v[176:191]
    ds_read_b64_tr_b16 v[116:117], v11 offset:8192
    ds_read_b64_tr_b16 v[118:119], v11 offset:12288
    buffer_load_dwordx4 v16, s[20:23], s43 offen offset:2048 lds
    v_fma_f32 v29, v29, s36, -v21
    v_exp_f32 v28, v28
    v_exp_f32 v29, v29
    v_cvt_pk_bf16_f32 v30, 0, v76
    v_add_f32 v25, v28, v29
    s_waitcnt lgkmcnt(10)
    v_mfma_f32_32x32x16_bf16 v[192:207], v[56:59], v[96:99], v[192:207]
    ds_read_b64_tr_b16 v[120:121], v12 offset:8192
    ds_read_b64_tr_b16 v[122:123], v12 offset:12288
    v_cvt_pk_bf16_f32 v105, v28, v29
    v_cvt_pk_bf16_f32 v31, 0, v77
    v_fma_f32 v30, v30, s36, -v21
    v_fma_f32 v31, v31, s36, -v21
    v_exp_f32 v30, v30
    s_waitcnt lgkmcnt(10)
    v_mfma_f32_32x32x16_bf16 v[208:223], v[60:63], v[96:99], v[208:223]
    ds_read_b64_tr_b16 v[124:125], v13 offset:8192
    ds_read_b64_tr_b16 v[126:127], v13 offset:12288
    buffer_load_dwordx4 v17, s[20:23], s43 offen offset:3072 lds
    v_exp_f32 v31, v31
    v_cvt_pk_bf16_f32 v26, 0, v78
    v_add_f32 v24, v24, v30
    v_add_f32 v25, v25, v31
    v_cvt_pk_bf16_f32 v106, v30, v31
    s_waitcnt lgkmcnt(10)
    v_mfma_f32_32x32x16_bf16 v[224:239], v[64:67], v[96:99], v[224:239]
    ds_read_b64_tr_b16 v[56:57], v10 offset:8448
    ds_read_b64_tr_b16 v[58:59], v10 offset:12544
    s_add_u32 m0, s38, 49152
    v_cvt_pk_bf16_f32 v27, 0, v79
    s_add_u32 s43, s54, 172032
    buffer_load_dwordx4 v14, s[20:23], s43 offen offset:0 lds
    v_fma_f32 v26, v26, s36, -v21
    v_fma_f32 v27, v27, s36, -v21
    v_exp_f32 v26, v26
    v_exp_f32 v27, v27
    s_waitcnt lgkmcnt(10)
    v_mfma_f32_32x32x16_bf16 v[240:255], v[68:71], v[96:99], v[240:255]
    ds_read_b64_tr_b16 v[60:61], v11 offset:8448
    ds_read_b64_tr_b16 v[62:63], v11 offset:12544
    v_cvt_pk_bf16_f32 v28, 0, v80
    v_add_f32 v24, v24, v26
    v_add_f32 v25, v25, v27
    v_cvt_pk_bf16_f32 v107, v26, v27
    v_cvt_pk_bf16_f32 v29, 0, v81
    v_fma_f32 v28, v28, s36, -v21
    s_waitcnt lgkmcnt(10)
    v_mfma_f32_32x32x16_bf16 v[128:143], v[112:115], v[100:103], v[128:143]
    ds_read_b64_tr_b16 v[64:65], v12 offset:8448
    ds_read_b64_tr_b16 v[66:67], v12 offset:12544
    buffer_load_dwordx4 v15, s[20:23], s43 offen offset:1024 lds
    v_fma_f32 v29, v29, s36, -v21
    v_exp_f32 v28, v28
    v_exp_f32 v29, v29
    v_cvt_pk_bf16_f32 v30, 0, v82
    s_waitcnt lgkmcnt(10)
    v_mfma_f32_32x32x16_bf16 v[144:159], v[116:119], v[100:103], v[144:159]
    ds_read_b64_tr_b16 v[68:69], v13 offset:8448
    ds_read_b64_tr_b16 v[70:71], v13 offset:12544
    buffer_load_dwordx4 v16, s[20:23], s43 offen offset:2048 lds
    v_add_f32 v24, v24, v28
    v_add_f32 v25, v25, v29
    v_cvt_pk_bf16_f32 v108, v28, v29
    v_cvt_pk_bf16_f32 v31, 0, v83
    v_fma_f32 v30, v30, s36, -v21
    v_fma_f32 v31, v31, s36, -v21
    s_waitcnt lgkmcnt(10)
    v_mfma_f32_32x32x16_bf16 v[160:175], v[120:123], v[100:103], v[160:175]
    ds_read_b64_tr_b16 v[112:113], v10 offset:0
    ds_read_b64_tr_b16 v[114:115], v10 offset:4096
    buffer_load_dwordx4 v17, s[20:23], s43 offen offset:3072 lds
    v_exp_f32 v30, v30
    v_exp_f32 v31, v31
    v_cvt_pk_bf16_f32 v26, 0, v84
    v_add_f32 v24, v24, v30
    v_add_f32 v25, v25, v31
    s_waitcnt lgkmcnt(10)
    v_mfma_f32_32x32x16_bf16 v[176:191], v[124:127], v[100:103], v[176:191]
    ds_read_b64_tr_b16 v[116:117], v11 offset:0
    ds_read_b64_tr_b16 v[118:119], v11 offset:4096
    v_cvt_pk_bf16_f32 v109, v30, v31
    v_cvt_pk_bf16_f32 v27, 0, v85
    v_fma_f32 v26, v26, s36, -v21
    v_fma_f32 v27, v27, s36, -v21
    v_exp_f32 v26, v26
    s_waitcnt lgkmcnt(10)
    v_mfma_f32_32x32x16_bf16 v[192:207], v[56:59], v[100:103], v[192:207]
    ds_read_b64_tr_b16 v[120:121], v12 offset:0
    ds_read_b64_tr_b16 v[122:123], v12 offset:4096
    v_exp_f32 v27, v27
    v_cvt_pk_bf16_f32 v28, 0, v86
    v_add_f32 v24, v24, v26
    v_add_f32 v25, v25, v27
    v_cvt_pk_bf16_f32 v110, v26, v27
    s_waitcnt lgkmcnt(10)
    v_mfma_f32_32x32x16_bf16 v[208:223], v[60:63], v[100:103], v[208:223]
    ds_read_b64_tr_b16 v[124:125], v13 offset:0
    ds_read_b64_tr_b16 v[126:127], v13 offset:4096
    v_cvt_pk_bf16_f32 v29, 0, v87
    v_fma_f32 v28, v28, s36, -v21
    v_fma_f32 v29, v29, s36, -v21
    v_exp_f32 v28, v28
    v_exp_f32 v29, v29
    s_waitcnt lgkmcnt(10)
    v_mfma_f32_32x32x16_bf16 v[224:239], v[64:67], v[100:103], v[224:239]
    ds_read_b64_tr_b16 v[56:57], v10 offset:256
    ds_read_b64_tr_b16 v[58:59], v10 offset:4352
    s_nop 0
    v_add_f32 v24, v24, v28
    v_add_f32 v25, v25, v29
    v_cvt_pk_bf16_f32 v111, v28, v29
    v_add_f32 v24, v24, v25
    s_waitcnt lgkmcnt(10)
    v_mfma_f32_32x32x16_bf16 v[240:255], v[68:71], v[100:103], v[240:255]
    ds_read_b64_tr_b16 v[60:61], v11 offset:256
    ds_read_b64_tr_b16 v[62:63], v11 offset:4352
    v_cmp_lt_f32 vcc, s37, v24
    s_nop 1
    s_cbranch_vccnz Lslow_26
Lret_27:
    v_add_f32 v23, v23, v24
    v_mov_b32 v26, v22
    v_mov_b32 v27, v23
    s_nop 1
    v_permlane32_swap_b32 v22, v26
    v_permlane32_swap_b32 v23, v27
    v_mov_b32 v32, v20
    v_mov_b32 v34, v21
    v_add_f32 v33, v22, v26
    v_add_f32 v35, v23, v27
    ds_write_b128 v38, v[32:35]
    s_waitcnt lgkmcnt(0)
    s_barrier
    ds_read_b128 v[40:43], v39
    v_mfma_f32_32x32x16_bf16 a[128:143], v[112:115], v[104:107], a[128:143]
    ds_read_b64_tr_b16 v[64:65], v12 offset:256
    ds_read_b64_tr_b16 v[66:67], v12 offset:4352
    v_mfma_f32_32x32x16_bf16 a[144:159], v[116:119], v[104:107], a[144:159]
    ds_read_b64_tr_b16 v[68:69], v13 offset:256
    ds_read_b64_tr_b16 v[70:71], v13 offset:4352
    s_add_u32 m0, s38, 65536
    s_nop 0
    s_add_u32 s43, s54, 128
    buffer_load_dwordx4 v14, s[20:23], s43 offen offset:0 lds
    v_mfma_f32_32x32x16_bf16 a[160:175], v[120:123], v[104:107], a[160:175]
    ds_read_b64_tr_b16 v[112:113], v10 offset:8192
    ds_read_b64_tr_b16 v[114:115], v10 offset:12288
    buffer_load_dwordx4 v15, s[20:23], s43 offen offset:1024 lds
    v_mfma_f32_32x32x16_bf16 a[176:191], v[124:127], v[104:107], a[176:191]
    ds_read_b64_tr_b16 v[116:117], v11 offset:8192
    ds_read_b64_tr_b16 v[118:119], v11 offset:12288
    buffer_load_dwordx4 v16, s[20:23], s43 offen offset:2048 lds
    s_waitcnt lgkmcnt(8)
    v_max_f32 v44, v32, v42
    v_max_f32 v45, v34, v40
    v_sub_f32 v46, v32, v44
    v_mfma_f32_32x32x16_bf16 a[192:207], v[56:59], v[104:107], a[192:207]
    ds_read_b64_tr_b16 v[120:121], v12 offset:8192
    ds_read_b64_tr_b16 v[122:123], v12 offset:12288
    v_sub_f32 v47, v42, v44
    v_sub_f32 v48, v34, v45
    v_mfma_f32_32x32x16_bf16 a[208:223], v[60:63], v[104:107], a[208:223]
    ds_read_b64_tr_b16 v[124:125], v13 offset:8192
    ds_read_b64_tr_b16 v[126:127], v13 offset:12288
    buffer_load_dwordx4 v17, s[20:23], s43 offen offset:3072 lds
    v_sub_f32 v49, v40, v45
    v_exp_f32 v46, v46
    s_waitcnt lgkmcnt(10)
    v_mfma_f32_32x32x16_bf16 a[224:239], v[64:67], v[104:107], a[224:239]
    ds_read_b64_tr_b16 v[56:57], v10 offset:8448
    ds_read_b64_tr_b16 v[58:59], v10 offset:12544
    s_add_u32 m0, s38, 81920
    v_exp_f32 v47, v47
    s_add_u32 s43, s54, 57472
    buffer_load_dwordx4 v14, s[20:23], s43 offen offset:0 lds
    s_waitcnt lgkmcnt(10)
    v_mfma_f32_32x32x16_bf16 a[240:255], v[68:71], v[104:107], a[240:255]
    ds_read_b64_tr_b16 v[60:61], v11 offset:8448
    ds_read_b64_tr_b16 v[62:63], v11 offset:12544
    v_exp_f32 v48, v48
    s_waitcnt lgkmcnt(10)
    v_mfma_f32_32x32x16_bf16 a[128:143], v[112:115], v[108:111], a[128:143]
    ds_read_b64_tr_b16 v[64:65], v12 offset:8448
    ds_read_b64_tr_b16 v[66:67], v12 offset:12544
    buffer_load_dwordx4 v15, s[20:23], s43 offen offset:1024 lds
    v_exp_f32 v49, v49
    v_mul_f32 v50, v33, v46
    s_waitcnt lgkmcnt(10)
    v_mfma_f32_32x32x16_bf16 a[144:159], v[116:119], v[108:111], a[144:159]
    ds_read_b64_tr_b16 v[68:69], v13 offset:8448
    ds_read_b64_tr_b16 v[70:71], v13 offset:12544
    buffer_load_dwordx4 v16, s[20:23], s43 offen offset:2048 lds
    v_mul_f32 v51, v41, v49
    v_fmac_f32 v50, v43, v47
    s_waitcnt lgkmcnt(10)
    v_mfma_f32_32x32x16_bf16 a[160:175], v[120:123], v[108:111], a[160:175]
    buffer_load_dwordx4 v17, s[20:23], s43 offen offset:3072 lds
    v_fmac_f32 v51, v35, v48
    v_rcp_f32 v50, v50
    s_waitcnt lgkmcnt(8)
    v_mfma_f32_32x32x16_bf16 a[176:191], v[124:127], v[108:111], a[176:191]
    v_rcp_f32 v51, v51
    s_waitcnt lgkmcnt(6)
    v_mfma_f32_32x32x16_bf16 a[192:207], v[56:59], v[108:111], a[192:207]
    s_nop 0
    v_mul_f32 v28, v46, v50
    s_waitcnt lgkmcnt(4)
    v_mfma_f32_32x32x16_bf16 a[208:223], v[60:63], v[108:111], a[208:223]
    v_mul_f32 v30, v48, v51
    v_mov_b32 v29, v28
    s_waitcnt lgkmcnt(2)
    v_mfma_f32_32x32x16_bf16 a[224:239], v[64:67], v[108:111], a[224:239]
    s_waitcnt lgkmcnt(0)
    v_mfma_f32_32x32x16_bf16 a[240:255], v[68:71], v[108:111], a[240:255]
    s_barrier
    v_pk_mul_f32 v[128:129], v[128:129], v[28:29]
    v_pk_mul_f32 v[130:131], v[130:131], v[28:29]
    v_pk_mul_f32 v[132:133], v[132:133], v[28:29]
    v_pk_mul_f32 v[134:135], v[134:135], v[28:29]
    v_cvt_pk_f16_f32 v128, v128, v129
    v_cvt_pk_f16_f32 v129, v130, v131
    v_cvt_pk_f16_f32 v130, v132, v133
    v_cvt_pk_f16_f32 v131, v134, v135
    ds_write_b128 v36, v[128:131] offset:0
    v_pk_mul_f32 v[136:137], v[136:137], v[28:29]
    v_pk_mul_f32 v[138:139], v[138:139], v[28:29]
    v_pk_mul_f32 v[140:141], v[140:141], v[28:29]
    v_pk_mul_f32 v[142:143], v[142:143], v[28:29]
    v_cvt_pk_f16_f32 v136, v136, v137
    v_cvt_pk_f16_f32 v137, v138, v139
    v_cvt_pk_f16_f32 v138, v140, v141
    v_cvt_pk_f16_f32 v139, v142, v143
    ds_write_b128 v36, v[136:139] offset:1024
    v_pk_mul_f32 v[144:145], v[144:145], v[28:29]
    v_pk_mul_f32 v[146:147], v[146:147], v[28:29]
    v_pk_mul_f32 v[148:149], v[148:149], v[28:29]
    v_pk_mul_f32 v[150:151], v[150:151], v[28:29]
    v_cvt_pk_f16_f32 v144, v144, v145
    v_cvt_pk_f16_f32 v145, v146, v147
    v_cvt_pk_f16_f32 v146, v148, v149
    v_cvt_pk_f16_f32 v147, v150, v151
    ds_write_b128 v36, v[144:147] offset:2048
    v_pk_mul_f32 v[152:153], v[152:153], v[28:29]
    v_pk_mul_f32 v[154:155], v[154:155], v[28:29]
    v_pk_mul_f32 v[156:157], v[156:157], v[28:29]
    v_pk_mul_f32 v[158:159], v[158:159], v[28:29]
    v_cvt_pk_f16_f32 v152, v152, v153
    v_cvt_pk_f16_f32 v153, v154, v155
    v_cvt_pk_f16_f32 v154, v156, v157
    v_cvt_pk_f16_f32 v155, v158, v159
    ds_write_b128 v36, v[152:155] offset:3072
    v_pk_mul_f32 v[160:161], v[160:161], v[28:29]
    v_pk_mul_f32 v[162:163], v[162:163], v[28:29]
    v_pk_mul_f32 v[164:165], v[164:165], v[28:29]
    v_pk_mul_f32 v[166:167], v[166:167], v[28:29]
    v_cvt_pk_f16_f32 v160, v160, v161
    v_cvt_pk_f16_f32 v161, v162, v163
    v_cvt_pk_f16_f32 v162, v164, v165
    v_cvt_pk_f16_f32 v163, v166, v167
    ds_write_b128 v36, v[160:163] offset:4096
    v_pk_mul_f32 v[168:169], v[168:169], v[28:29]
    v_pk_mul_f32 v[170:171], v[170:171], v[28:29]
    v_pk_mul_f32 v[172:173], v[172:173], v[28:29]
    v_pk_mul_f32 v[174:175], v[174:175], v[28:29]
    v_cvt_pk_f16_f32 v168, v168, v169
    v_cvt_pk_f16_f32 v169, v170, v171
    v_cvt_pk_f16_f32 v170, v172, v173
    v_cvt_pk_f16_f32 v171, v174, v175
    ds_write_b128 v36, v[168:171] offset:5120
    v_pk_mul_f32 v[176:177], v[176:177], v[28:29]
    v_pk_mul_f32 v[178:179], v[178:179], v[28:29]
    v_pk_mul_f32 v[180:181], v[180:181], v[28:29]
    v_pk_mul_f32 v[182:183], v[182:183], v[28:29]
    v_cvt_pk_f16_f32 v176, v176, v177
    v_cvt_pk_f16_f32 v177, v178, v179
    v_cvt_pk_f16_f32 v178, v180, v181
    v_cvt_pk_f16_f32 v179, v182, v183
    ds_write_b128 v36, v[176:179] offset:6144
    v_pk_mul_f32 v[184:185], v[184:185], v[28:29]
    v_pk_mul_f32 v[186:187], v[186:187], v[28:29]
    v_pk_mul_f32 v[188:189], v[188:189], v[28:29]
    v_pk_mul_f32 v[190:191], v[190:191], v[28:29]
    v_cvt_pk_f16_f32 v184, v184, v185
    v_cvt_pk_f16_f32 v185, v186, v187
    v_cvt_pk_f16_f32 v186, v188, v189
    v_cvt_pk_f16_f32 v187, v190, v191
    ds_write_b128 v36, v[184:187] offset:7168
    v_pk_mul_f32 v[192:193], v[192:193], v[28:29]
    v_pk_mul_f32 v[194:195], v[194:195], v[28:29]
    v_pk_mul_f32 v[196:197], v[196:197], v[28:29]
    v_pk_mul_f32 v[198:199], v[198:199], v[28:29]
    v_cvt_pk_f16_f32 v192, v192, v193
    v_cvt_pk_f16_f32 v193, v194, v195
    v_cvt_pk_f16_f32 v194, v196, v197
    v_cvt_pk_f16_f32 v195, v198, v199
    ds_write_b128 v36, v[192:195] offset:8192
    v_pk_mul_f32 v[200:201], v[200:201], v[28:29]
    v_pk_mul_f32 v[202:203], v[202:203], v[28:29]
    v_pk_mul_f32 v[204:205], v[204:205], v[28:29]
    v_pk_mul_f32 v[206:207], v[206:207], v[28:29]
    v_cvt_pk_f16_f32 v200, v200, v201
    v_cvt_pk_f16_f32 v201, v202, v203
    v_cvt_pk_f16_f32 v202, v204, v205
    v_cvt_pk_f16_f32 v203, v206, v207
    ds_write_b128 v36, v[200:203] offset:9216
    v_pk_mul_f32 v[208:209], v[208:209], v[28:29]
    v_pk_mul_f32 v[210:211], v[210:211], v[28:29]
    v_pk_mul_f32 v[212:213], v[212:213], v[28:29]
    v_pk_mul_f32 v[214:215], v[214:215], v[28:29]
    v_cvt_pk_f16_f32 v208, v208, v209
    v_cvt_pk_f16_f32 v209, v210, v211
    v_cvt_pk_f16_f32 v210, v212, v213
    v_cvt_pk_f16_f32 v211, v214, v215
    ds_write_b128 v36, v[208:211] offset:10240
    v_pk_mul_f32 v[216:217], v[216:217], v[28:29]
    v_pk_mul_f32 v[218:219], v[218:219], v[28:29]
    v_pk_mul_f32 v[220:221], v[220:221], v[28:29]
    v_pk_mul_f32 v[222:223], v[222:223], v[28:29]
    v_cvt_pk_f16_f32 v216, v216, v217
    v_cvt_pk_f16_f32 v217, v218, v219
    v_cvt_pk_f16_f32 v218, v220, v221
    v_cvt_pk_f16_f32 v219, v222, v223
    ds_write_b128 v36, v[216:219] offset:11264
    v_pk_mul_f32 v[224:225], v[224:225], v[28:29]
    v_pk_mul_f32 v[226:227], v[226:227], v[28:29]
    v_pk_mul_f32 v[228:229], v[228:229], v[28:29]
    v_pk_mul_f32 v[230:231], v[230:231], v[28:29]
    v_cvt_pk_f16_f32 v224, v224, v225
    v_cvt_pk_f16_f32 v225, v226, v227
    v_cvt_pk_f16_f32 v226, v228, v229
    v_cvt_pk_f16_f32 v227, v230, v231
    ds_write_b128 v36, v[224:227] offset:12288
    v_pk_mul_f32 v[232:233], v[232:233], v[28:29]
    v_pk_mul_f32 v[234:235], v[234:235], v[28:29]
    v_pk_mul_f32 v[236:237], v[236:237], v[28:29]
    v_pk_mul_f32 v[238:239], v[238:239], v[28:29]
    v_cvt_pk_f16_f32 v232, v232, v233
    v_cvt_pk_f16_f32 v233, v234, v235
    v_cvt_pk_f16_f32 v234, v236, v237
    v_cvt_pk_f16_f32 v235, v238, v239
    ds_write_b128 v36, v[232:235] offset:13312
    v_pk_mul_f32 v[240:241], v[240:241], v[28:29]
    v_pk_mul_f32 v[242:243], v[242:243], v[28:29]
    v_pk_mul_f32 v[244:245], v[244:245], v[28:29]
    v_pk_mul_f32 v[246:247], v[246:247], v[28:29]
    v_cvt_pk_f16_f32 v240, v240, v241
    v_cvt_pk_f16_f32 v241, v242, v243
    v_cvt_pk_f16_f32 v242, v244, v245
    v_cvt_pk_f16_f32 v243, v246, v247
    ds_write_b128 v36, v[240:243] offset:14336
    v_pk_mul_f32 v[248:249], v[248:249], v[28:29]
    v_pk_mul_f32 v[250:251], v[250:251], v[28:29]
    v_pk_mul_f32 v[252:253], v[252:253], v[28:29]
    v_pk_mul_f32 v[254:255], v[254:255], v[28:29]
    v_cvt_pk_f16_f32 v248, v248, v249
    v_cvt_pk_f16_f32 v249, v250, v251
    v_cvt_pk_f16_f32 v250, v252, v253
    v_cvt_pk_f16_f32 v251, v254, v255
    ds_write_b128 v36, v[248:251] offset:15360
    v_and_b32 v1, 63, v0
    v_lshrrev_b32 v120, 5, v1
    v_bfe_u32 v121, v1, 2, 2
    v_and_b32 v122, 3, v1
    v_bfe_u32 v123, v1, 4, 1
    v_and_b32 v124, 31, v1
    v_accvgpr_read_b32 v132, a132
    v_accvgpr_read_b32 v133, a133
    v_accvgpr_read_b32 v134, a134
    v_accvgpr_read_b32 v135, a135
    v_accvgpr_read_b32 v140, a140
    v_accvgpr_read_b32 v141, a141
    v_accvgpr_read_b32 v142, a142
    v_accvgpr_read_b32 v143, a143
    v_accvgpr_read_b32 v148, a148
    v_accvgpr_read_b32 v149, a149
    v_accvgpr_read_b32 v150, a150
    v_accvgpr_read_b32 v151, a151
    v_accvgpr_read_b32 v156, a156
    v_accvgpr_read_b32 v157, a157
    v_accvgpr_read_b32 v158, a158
    v_accvgpr_read_b32 v159, a159
    v_accvgpr_read_b32 v164, a164
    v_accvgpr_read_b32 v165, a165
    v_accvgpr_read_b32 v166, a166
    v_accvgpr_read_b32 v167, a167
    v_accvgpr_read_b32 v172, a172
    v_accvgpr_read_b32 v173, a173
    v_accvgpr_read_b32 v174, a174
    v_accvgpr_read_b32 v175, a175
    v_accvgpr_read_b32 v180, a180
    v_accvgpr_read_b32 v181, a181
    v_accvgpr_read_b32 v182, a182
    v_accvgpr_read_b32 v183, a183
    v_accvgpr_read_b32 v188, a188
    v_accvgpr_read_b32 v189, a189
    v_accvgpr_read_b32 v190, a190
    v_accvgpr_read_b32 v191, a191
    v_accvgpr_read_b32 v196, a196
    v_accvgpr_read_b32 v197, a197
    v_accvgpr_read_b32 v198, a198
    v_accvgpr_read_b32 v199, a199
    v_accvgpr_read_b32 v204, a204
    v_accvgpr_read_b32 v205, a205
    v_accvgpr_read_b32 v206, a206
    v_accvgpr_read_b32 v207, a207
    v_accvgpr_read_b32 v212, a212
    v_accvgpr_read_b32 v213, a213
    v_accvgpr_read_b32 v214, a214
    v_accvgpr_read_b32 v215, a215
    v_accvgpr_read_b32 v220, a220
    v_accvgpr_read_b32 v221, a221
    v_accvgpr_read_b32 v222, a222
    v_accvgpr_read_b32 v223, a223
    v_accvgpr_read_b32 v228, a228
    v_accvgpr_read_b32 v229, a229
    v_accvgpr_read_b32 v230, a230
    v_accvgpr_read_b32 v231, a231
    v_accvgpr_read_b32 v236, a236
    v_accvgpr_read_b32 v237, a237
    v_accvgpr_read_b32 v238, a238
    v_accvgpr_read_b32 v239, a239
    v_accvgpr_read_b32 v244, a244
    v_accvgpr_read_b32 v245, a245
    v_accvgpr_read_b32 v246, a246
    v_accvgpr_read_b32 v247, a247
    v_accvgpr_read_b32 v252, a252
    v_accvgpr_read_b32 v253, a253
    v_accvgpr_read_b32 v254, a254
    v_accvgpr_read_b32 v255, a255
    v_lshl_add_u32 v126, v120, 2, v121
    v_lshlrev_b32 v126, 7, v126
    v_lshl_add_u32 v126, v123, 5, v126
    v_lshl_add_u32 v126, v122, 3, v126
    s_xor_b32 s40, s31, 1
    s_lshl_b32 s40, s40, 13
    v_add_u32 v126, s40, v126
    v_bfe_u32 v127, v121, 1, 1
    v_xor_b32 v127, s31, v127
    v_lshl_add_u32 v10, v127, 6, v126
    v_xor_b32 v11, 8192, v10
    v_mul_u32_u24 v126, 3584, v120
    v_lshl_add_u32 v126, v124, 2, v126
    v_add_u32 v2, 0, v126
    v_add_u32 v3, 7168, v126
    v_add_u32 v4, 14336, v126
    v_add_u32 v5, 21504, v126
    s_lshl_b32 s40, s30, 5
    s_lshl_b32 s41, s32, 4
    s_add_u32 s40, s40, s41
    s_lshl_b32 s41, s29, 10
    s_add_u32 s40, s40, s41
    s_mul_i32 s40, s40, 1792
    s_lshl_b32 s41, s31, 7
    s_add_u32 s41, s41, 16777216
    s_add_u32 s57, s41, s40
    s_waitcnt vmcnt(0) lgkmcnt(0)
    s_barrier
    s_cmp_lg_u32 s28, 0
    s_cbranch_scc1 Lmf_28
    v_mov_b32 v8, 1
    v_mov_b32 v9, 0
    s_lshl_b32 s90, s2, 7
    s_add_u32 s90, s90, 524288
    s_mov_b64 exec, 1
    buffer_store_dword v8, v9, s[24:27], s90 offen sc1
    s_mov_b64 exec, -1
Lmf_28:
    ds_read_b128 v[40:43], v37 offset:0
    ds_read_b128 v[44:47], v37 offset:1024
    ds_read_b128 v[48:51], v37 offset:2048
    ds_read_b128 v[52:55], v37 offset:3072
    ds_read_b128 v[56:59], v37 offset:4096
    ds_read_b128 v[60:63], v37 offset:5120
    ds_read_b128 v[64:67], v37 offset:6144
    ds_read_b128 v[68:71], v37 offset:7168
    ds_read_b128 v[72:75], v37 offset:8192
    ds_read_b128 v[76:79], v37 offset:9216
    ds_read_b128 v[80:83], v37 offset:10240
    ds_read_b128 v[84:87], v37 offset:11264
    ds_read_b128 v[88:91], v37 offset:12288
    ds_read_b128 v[92:95], v37 offset:13312
    ds_read_b128 v[96:99], v37 offset:14336
    ds_read_b128 v[100:103], v37 offset:15360
    s_add_u32 s90, s57, 0
    s_add_u32 s91, s57, 256
    s_add_u32 s92, s57, 512
    s_add_u32 s93, s57, 768
    ds_read_b64_tr_b16 a[0:1], v10 offset:0
    ds_read_b64_tr_b16 a[2:3], v10 offset:1024
    ds_read_b64_tr_b16 a[4:5], v10 offset:2048
    ds_read_b64_tr_b16 a[6:7], v10 offset:3072
    ds_read_b64_tr_b16 a[8:9], v10 offset:4096
    ds_read_b64_tr_b16 a[10:11], v10 offset:5120
    ds_read_b64_tr_b16 a[12:13], v10 offset:6144
    ds_read_b64_tr_b16 a[14:15], v10 offset:7168
    v_accvgpr_read_b32 v128, a128
    v_accvgpr_read_b32 v129, a129
    v_accvgpr_read_b32 v130, a130
    v_accvgpr_read_b32 v131, a131
    v_accvgpr_read_b32 v136, a136
    v_accvgpr_read_b32 v137, a137
    v_accvgpr_read_b32 v138, a138
    v_accvgpr_read_b32 v139, a139
    v_accvgpr_read_b32 v144, a144
    v_accvgpr_read_b32 v145, a145
    v_accvgpr_read_b32 v146, a146
    v_accvgpr_read_b32 v147, a147
    v_accvgpr_read_b32 v152, a152
    v_accvgpr_read_b32 v153, a153
    v_accvgpr_read_b32 v154, a154
    v_accvgpr_read_b32 v155, a155
    v_accvgpr_read_b32 v160, a160
    v_accvgpr_read_b32 v161, a161
    v_accvgpr_read_b32 v162, a162
    v_accvgpr_read_b32 v163, a163
    v_accvgpr_read_b32 v168, a168
    v_accvgpr_read_b32 v169, a169
    v_accvgpr_read_b32 v170, a170
    v_accvgpr_read_b32 v171, a171
    v_accvgpr_read_b32 v176, a176
    v_accvgpr_read_b32 v177, a177
    v_accvgpr_read_b32 v178, a178
    v_accvgpr_read_b32 v179, a179
    v_accvgpr_read_b32 v184, a184
    v_accvgpr_read_b32 v185, a185
    v_accvgpr_read_b32 v186, a186
    v_accvgpr_read_b32 v187, a187
    v_accvgpr_read_b32 v192, a192
    v_accvgpr_read_b32 v193, a193
    v_accvgpr_read_b32 v194, a194
    v_accvgpr_read_b32 v195, a195
    v_accvgpr_read_b32 v200, a200
    v_accvgpr_read_b32 v201, a201
    v_accvgpr_read_b32 v202, a202
    v_accvgpr_read_b32 v203, a203
    v_accvgpr_read_b32 v208, a208
    v_accvgpr_read_b32 v209, a209
    v_accvgpr_read_b32 v210, a210
    v_accvgpr_read_b32 v211, a211
    v_accvgpr_read_b32 v216, a216
    v_accvgpr_read_b32 v217, a217
    v_accvgpr_read_b32 v218, a218
    v_accvgpr_read_b32 v219, a219
    v_accvgpr_read_b32 v224, a224
    v_accvgpr_read_b32 v225, a225
    v_accvgpr_read_b32 v226, a226
    v_accvgpr_read_b32 v227, a227
    v_accvgpr_read_b32 v232, a232
    v_accvgpr_read_b32 v233, a233
    v_accvgpr_read_b32 v234, a234
    v_accvgpr_read_b32 v235, a235
    v_accvgpr_read_b32 v240, a240
    v_accvgpr_read_b32 v241, a241
    v_accvgpr_read_b32 v242, a242
    v_accvgpr_read_b32 v243, a243
    v_accvgpr_read_b32 v248, a248
    v_accvgpr_read_b32 v249, a249
    v_accvgpr_read_b32 v250, a250
    v_accvgpr_read_b32 v251, a251
    s_waitcnt lgkmcnt(15)
    v_fma_mix_f32 v128, v128, v30, v40 op_sel:[0,0,0] op_sel_hi:[0,0,1]
    v_fma_mix_f32 v129, v129, v30, v40 op_sel:[0,0,1] op_sel_hi:[0,0,1]
    v_fma_mix_f32 v130, v130, v30, v41 op_sel:[0,0,0] op_sel_hi:[0,0,1]
    v_fma_mix_f32 v131, v131, v30, v41 op_sel:[0,0,1] op_sel_hi:[0,0,1]
    v_fma_mix_f32 v132, v132, v30, v42 op_sel:[0,0,0] op_sel_hi:[0,0,1]
    v_fma_mix_f32 v133, v133, v30, v42 op_sel:[0,0,1] op_sel_hi:[0,0,1]
    v_fma_mix_f32 v134, v134, v30, v43 op_sel:[0,0,0] op_sel_hi:[0,0,1]
    v_fma_mix_f32 v135, v135, v30, v43 op_sel:[0,0,1] op_sel_hi:[0,0,1]
    v_cvt_pk_bf16_f32 v128, v128, v129
    v_cvt_pk_bf16_f32 v129, v130, v131
    v_cvt_pk_bf16_f32 v130, v132, v133
    v_cvt_pk_bf16_f32 v131, v134, v135
    ds_write_b128 v37, v[128:131] offset:0
    v_fma_mix_f32 v136, v136, v30, v44 op_sel:[0,0,0] op_sel_hi:[0,0,1]
    v_fma_mix_f32 v137, v137, v30, v44 op_sel:[0,0,1] op_sel_hi:[0,0,1]
    v_fma_mix_f32 v138, v138, v30, v45 op_sel:[0,0,0] op_sel_hi:[0,0,1]
    v_fma_mix_f32 v139, v139, v30, v45 op_sel:[0,0,1] op_sel_hi:[0,0,1]
    v_fma_mix_f32 v140, v140, v30, v46 op_sel:[0,0,0] op_sel_hi:[0,0,1]
    v_fma_mix_f32 v141, v141, v30, v46 op_sel:[0,0,1] op_sel_hi:[0,0,1]
    v_fma_mix_f32 v142, v142, v30, v47 op_sel:[0,0,0] op_sel_hi:[0,0,1]
    v_fma_mix_f32 v143, v143, v30, v47 op_sel:[0,0,1] op_sel_hi:[0,0,1]
    v_cvt_pk_bf16_f32 v132, v136, v137
    v_cvt_pk_bf16_f32 v133, v138, v139
    v_cvt_pk_bf16_f32 v134, v140, v141
    v_cvt_pk_bf16_f32 v135, v142, v143
    ds_write_b128 v37, v[132:135] offset:1024
    s_waitcnt lgkmcnt(6)
    v_mfma_f32_32x32x16_bf16 v[104:119], v[128:131], a[0:3], 0
    ds_read_b64_tr_b16 a[16:17], v10 offset:16384
    ds_read_b64_tr_b16 a[18:19], v10 offset:17408
    v_fma_mix_f32 v144, v144, v30, v48 op_sel:[0,0,0] op_sel_hi:[0,0,1]
    v_fma_mix_f32 v145, v145, v30, v48 op_sel:[0,0,1] op_sel_hi:[0,0,1]
    v_fma_mix_f32 v146, v146, v30, v49 op_sel:[0,0,0] op_sel_hi:[0,0,1]
    v_fma_mix_f32 v147, v147, v30, v49 op_sel:[0,0,1] op_sel_hi:[0,0,1]
    v_fma_mix_f32 v148, v148, v30, v50 op_sel:[0,0,0] op_sel_hi:[0,0,1]
    v_fma_mix_f32 v149, v149, v30, v50 op_sel:[0,0,1] op_sel_hi:[0,0,1]
    v_fma_mix_f32 v150, v150, v30, v51 op_sel:[0,0,0] op_sel_hi:[0,0,1]
    v_fma_mix_f32 v151, v151, v30, v51 op_sel:[0,0,1] op_sel_hi:[0,0,1]
    v_cvt_pk_bf16_f32 v136, v144, v145
    v_cvt_pk_bf16_f32 v137, v146, v147
    v_cvt_pk_bf16_f32 v138, v148, v149
    v_cvt_pk_bf16_f32 v139, v150, v151
    ds_write_b128 v37, v[136:139] offset:2048
    v_mfma_f32_32x32x16_bf16 v[104:119], v[132:135], a[4:7], v[104:119]
    ds_read_b64_tr_b16 a[20:21], v10 offset:18432
    ds_read_b64_tr_b16 a[22:23], v10 offset:19456
    v_fma_mix_f32 v152, v152, v30, v52 op_sel:[0,0,0] op_sel_hi:[0,0,1]
    v_fma_mix_f32 v153, v153, v30, v52 op_sel:[0,0,1] op_sel_hi:[0,0,1]
    v_fma_mix_f32 v154, v154, v30, v53 op_sel:[0,0,0] op_sel_hi:[0,0,1]
    v_fma_mix_f32 v155, v155, v30, v53 op_sel:[0,0,1] op_sel_hi:[0,0,1]
    v_fma_mix_f32 v156, v156, v30, v54 op_sel:[0,0,0] op_sel_hi:[0,0,1]
    v_fma_mix_f32 v157, v157, v30, v54 op_sel:[0,0,1] op_sel_hi:[0,0,1]
    v_fma_mix_f32 v158, v158, v30, v55 op_sel:[0,0,0] op_sel_hi:[0,0,1]
    v_fma_mix_f32 v159, v159, v30, v55 op_sel:[0,0,1] op_sel_hi:[0,0,1]
    v_cvt_pk_bf16_f32 v140, v152, v153
    v_cvt_pk_bf16_f32 v141, v154, v155
    v_cvt_pk_bf16_f32 v142, v156, v157
    v_cvt_pk_bf16_f32 v143, v158, v159
    ds_write_b128 v37, v[140:143] offset:3072
    s_waitcnt lgkmcnt(8)
    v_mfma_f32_32x32x16_bf16 v[104:119], v[136:139], a[8:11], v[104:119]
    ds_read_b64_tr_b16 a[24:25], v10 offset:20480
    ds_read_b64_tr_b16 a[26:27], v10 offset:21504
    v_fma_mix_f32 v160, v160, v30, v56 op_sel:[0,0,0] op_sel_hi:[0,0,1]
    v_fma_mix_f32 v161, v161, v30, v56 op_sel:[0,0,1] op_sel_hi:[0,0,1]
    v_fma_mix_f32 v162, v162, v30, v57 op_sel:[0,0,0] op_sel_hi:[0,0,1]
    v_fma_mix_f32 v163, v163, v30, v57 op_sel:[0,0,1] op_sel_hi:[0,0,1]
    v_fma_mix_f32 v164, v164, v30, v58 op_sel:[0,0,0] op_sel_hi:[0,0,1]
    v_fma_mix_f32 v165, v165, v30, v58 op_sel:[0,0,1] op_sel_hi:[0,0,1]
    v_fma_mix_f32 v166, v166, v30, v59 op_sel:[0,0,0] op_sel_hi:[0,0,1]
    v_fma_mix_f32 v167, v167, v30, v59 op_sel:[0,0,1] op_sel_hi:[0,0,1]
    v_cvt_pk_bf16_f32 v144, v160, v161
    v_cvt_pk_bf16_f32 v145, v162, v163
    v_cvt_pk_bf16_f32 v146, v164, v165
    v_cvt_pk_bf16_f32 v147, v166, v167
    ds_write_b128 v37, v[144:147] offset:4096
    v_mfma_f32_32x32x16_bf16 v[104:119], v[140:143], a[12:15], v[104:119]
    ds_read_b64_tr_b16 a[28:29], v10 offset:22528
    ds_read_b64_tr_b16 a[30:31], v10 offset:23552
    v_fma_mix_f32 v168, v168, v30, v60 op_sel:[0,0,0] op_sel_hi:[0,0,1]
    v_fma_mix_f32 v169, v169, v30, v60 op_sel:[0,0,1] op_sel_hi:[0,0,1]
    v_fma_mix_f32 v170, v170, v30, v61 op_sel:[0,0,0] op_sel_hi:[0,0,1]
    v_fma_mix_f32 v171, v171, v30, v61 op_sel:[0,0,1] op_sel_hi:[0,0,1]
    v_fma_mix_f32 v172, v172, v30, v62 op_sel:[0,0,0] op_sel_hi:[0,0,1]
    v_fma_mix_f32 v173, v173, v30, v62 op_sel:[0,0,1] op_sel_hi:[0,0,1]
    v_fma_mix_f32 v174, v174, v30, v63 op_sel:[0,0,0] op_sel_hi:[0,0,1]
    v_fma_mix_f32 v175, v175, v30, v63 op_sel:[0,0,1] op_sel_hi:[0,0,1]
    v_cvt_pk_bf16_f32 v148, v168, v169
    v_cvt_pk_bf16_f32 v149, v170, v171
    v_cvt_pk_bf16_f32 v150, v172, v173
    v_cvt_pk_bf16_f32 v151, v174, v175
    ds_write_b128 v37, v[148:151] offset:5120
    s_waitcnt lgkmcnt(7)
    v_mfma_f32_32x32x16_bf16 v[104:119], v[144:147], a[16:19], v[104:119]
    ds_read_b64_tr_b16 a[0:1], v10 offset:32768
    ds_read_b64_tr_b16 a[2:3], v10 offset:33792
    v_fma_mix_f32 v176, v176, v30, v64 op_sel:[0,0,0] op_sel_hi:[0,0,1]
    v_fma_mix_f32 v177, v177, v30, v64 op_sel:[0,0,1] op_sel_hi:[0,0,1]
    v_fma_mix_f32 v178, v178, v30, v65 op_sel:[0,0,0] op_sel_hi:[0,0,1]
    v_fma_mix_f32 v179, v179, v30, v65 op_sel:[0,0,1] op_sel_hi:[0,0,1]
    v_fma_mix_f32 v180, v180, v30, v66 op_sel:[0,0,0] op_sel_hi:[0,0,1]
    v_fma_mix_f32 v181, v181, v30, v66 op_sel:[0,0,1] op_sel_hi:[0,0,1]
    v_fma_mix_f32 v182, v182, v30, v67 op_sel:[0,0,0] op_sel_hi:[0,0,1]
    v_fma_mix_f32 v183, v183, v30, v67 op_sel:[0,0,1] op_sel_hi:[0,0,1]
    v_cvt_pk_bf16_f32 v152, v176, v177
    v_cvt_pk_bf16_f32 v153, v178, v179
    v_cvt_pk_bf16_f32 v154, v180, v181
    v_cvt_pk_bf16_f32 v155, v182, v183
    ds_write_b128 v37, v[152:155] offset:6144
    v_mfma_f32_32x32x16_bf16 v[104:119], v[148:151], a[20:23], v[104:119]
    ds_read_b64_tr_b16 a[4:5], v10 offset:34816
    ds_read_b64_tr_b16 a[6:7], v10 offset:35840
    v_fma_mix_f32 v184, v184, v30, v68 op_sel:[0,0,0] op_sel_hi:[0,0,1]
    v_fma_mix_f32 v185, v185, v30, v68 op_sel:[0,0,1] op_sel_hi:[0,0,1]
    v_fma_mix_f32 v186, v186, v30, v69 op_sel:[0,0,0] op_sel_hi:[0,0,1]
    v_fma_mix_f32 v187, v187, v30, v69 op_sel:[0,0,1] op_sel_hi:[0,0,1]
    v_fma_mix_f32 v188, v188, v30, v70 op_sel:[0,0,0] op_sel_hi:[0,0,1]
    v_fma_mix_f32 v189, v189, v30, v70 op_sel:[0,0,1] op_sel_hi:[0,0,1]
    v_fma_mix_f32 v190, v190, v30, v71 op_sel:[0,0,0] op_sel_hi:[0,0,1]
    v_fma_mix_f32 v191, v191, v30, v71 op_sel:[0,0,1] op_sel_hi:[0,0,1]
    v_cvt_pk_bf16_f32 v156, v184, v185
    v_cvt_pk_bf16_f32 v157, v186, v187
    v_cvt_pk_bf16_f32 v158, v188, v189
    v_cvt_pk_bf16_f32 v159, v190, v191
    ds_write_b128 v37, v[156:159] offset:7168
    s_waitcnt lgkmcnt(7)
    v_mfma_f32_32x32x16_bf16 v[104:119], v[152:155], a[24:27], v[104:119]
    ds_read_b64_tr_b16 a[8:9], v10 offset:36864
    ds_read_b64_tr_b16 a[10:11], v10 offset:37888
    v_fma_mix_f32 v192, v192, v30, v72 op_sel:[0,0,0] op_sel_hi:[0,0,1]
    v_fma_mix_f32 v193, v193, v30, v72 op_sel:[0,0,1] op_sel_hi:[0,0,1]
    v_fma_mix_f32 v194, v194, v30, v73 op_sel:[0,0,0] op_sel_hi:[0,0,1]
    v_fma_mix_f32 v195, v195, v30, v73 op_sel:[0,0,1] op_sel_hi:[0,0,1]
    v_fma_mix_f32 v196, v196, v30, v74 op_sel:[0,0,0] op_sel_hi:[0,0,1]
    v_fma_mix_f32 v197, v197, v30, v74 op_sel:[0,0,1] op_sel_hi:[0,0,1]
    v_fma_mix_f32 v198, v198, v30, v75 op_sel:[0,0,0] op_sel_hi:[0,0,1]
    v_fma_mix_f32 v199, v199, v30, v75 op_sel:[0,0,1] op_sel_hi:[0,0,1]
    v_cvt_pk_bf16_f32 v160, v192, v193
    v_cvt_pk_bf16_f32 v161, v194, v195
    v_cvt_pk_bf16_f32 v162, v196, v197
    v_cvt_pk_bf16_f32 v163, v198, v199
    ds_write_b128 v37, v[160:163] offset:8192
    v_mfma_f32_32x32x16_bf16 v[104:119], v[156:159], a[28:31], v[104:119]
    ds_read_b64_tr_b16 a[12:13], v10 offset:38912
    ds_read_b64_tr_b16 a[14:15], v10 offset:39936
    v_fma_mix_f32 v200, v200, v30, v76 op_sel:[0,0,0] op_sel_hi:[0,0,1]
    v_fma_mix_f32 v201, v201, v30, v76 op_sel:[0,0,1] op_sel_hi:[0,0,1]
    v_fma_mix_f32 v202, v202, v30, v77 op_sel:[0,0,0] op_sel_hi:[0,0,1]
    v_fma_mix_f32 v203, v203, v30, v77 op_sel:[0,0,1] op_sel_hi:[0,0,1]
    v_fma_mix_f32 v204, v204, v30, v78 op_sel:[0,0,0] op_sel_hi:[0,0,1]
    v_fma_mix_f32 v205, v205, v30, v78 op_sel:[0,0,1] op_sel_hi:[0,0,1]
    v_fma_mix_f32 v206, v206, v30, v79 op_sel:[0,0,0] op_sel_hi:[0,0,1]
    v_fma_mix_f32 v207, v207, v30, v79 op_sel:[0,0,1] op_sel_hi:[0,0,1]
    v_cvt_pk_bf16_f32 v164, v200, v201
    v_cvt_pk_bf16_f32 v165, v202, v203
    v_cvt_pk_bf16_f32 v166, v204, v205
    v_cvt_pk_bf16_f32 v167, v206, v207
    ds_write_b128 v37, v[164:167] offset:9216
    s_waitcnt lgkmcnt(7)
    v_mfma_f32_32x32x16_bf16 v[104:119], v[160:163], a[0:3], v[104:119]
    ds_read_b64_tr_b16 a[16:17], v10 offset:49152
    ds_read_b64_tr_b16 a[18:19], v10 offset:50176
    v_fma_mix_f32 v208, v208, v30, v80 op_sel:[0,0,0] op_sel_hi:[0,0,1]
    v_fma_mix_f32 v209, v209, v30, v80 op_sel:[0,0,1] op_sel_hi:[0,0,1]
    v_fma_mix_f32 v210, v210, v30, v81 op_sel:[0,0,0] op_sel_hi:[0,0,1]
    v_fma_mix_f32 v211, v211, v30, v81 op_sel:[0,0,1] op_sel_hi:[0,0,1]
    v_fma_mix_f32 v212, v212, v30, v82 op_sel:[0,0,0] op_sel_hi:[0,0,1]
    v_fma_mix_f32 v213, v213, v30, v82 op_sel:[0,0,1] op_sel_hi:[0,0,1]
    v_fma_mix_f32 v214, v214, v30, v83 op_sel:[0,0,0] op_sel_hi:[0,0,1]
    v_fma_mix_f32 v215, v215, v30, v83 op_sel:[0,0,1] op_sel_hi:[0,0,1]
    v_cvt_pk_bf16_f32 v168, v208, v209
    v_cvt_pk_bf16_f32 v169, v210, v211
    v_cvt_pk_bf16_f32 v170, v212, v213
    v_cvt_pk_bf16_f32 v171, v214, v215
    ds_write_b128 v37, v[168:171] offset:10240
    v_mfma_f32_32x32x16_bf16 v[104:119], v[164:167], a[4:7], v[104:119]
    ds_read_b64_tr_b16 a[20:21], v10 offset:51200
    ds_read_b64_tr_b16 a[22:23], v10 offset:52224
    v_fma_mix_f32 v216, v216, v30, v84 op_sel:[0,0,0] op_sel_hi:[0,0,1]
    v_fma_mix_f32 v217, v217, v30, v84 op_sel:[0,0,1] op_sel_hi:[0,0,1]
    v_fma_mix_f32 v218, v218, v30, v85 op_sel:[0,0,0] op_sel_hi:[0,0,1]
    v_fma_mix_f32 v219, v219, v30, v85 op_sel:[0,0,1] op_sel_hi:[0,0,1]
    v_fma_mix_f32 v220, v220, v30, v86 op_sel:[0,0,0] op_sel_hi:[0,0,1]
    v_fma_mix_f32 v221, v221, v30, v86 op_sel:[0,0,1] op_sel_hi:[0,0,1]
    v_fma_mix_f32 v222, v222, v30, v87 op_sel:[0,0,0] op_sel_hi:[0,0,1]
    v_fma_mix_f32 v223, v223, v30, v87 op_sel:[0,0,1] op_sel_hi:[0,0,1]
    v_cvt_pk_bf16_f32 v172, v216, v217
    v_cvt_pk_bf16_f32 v173, v218, v219
    v_cvt_pk_bf16_f32 v174, v220, v221
    v_cvt_pk_bf16_f32 v175, v222, v223
    ds_write_b128 v37, v[172:175] offset:11264
    s_waitcnt lgkmcnt(7)
    v_mfma_f32_32x32x16_bf16 v[104:119], v[168:171], a[8:11], v[104:119]
    ds_read_b64_tr_b16 a[24:25], v10 offset:53248
    ds_read_b64_tr_b16 a[26:27], v10 offset:54272
    v_fma_mix_f32 v224, v224, v30, v88 op_sel:[0,0,0] op_sel_hi:[0,0,1]
    v_fma_mix_f32 v225, v225, v30, v88 op_sel:[0,0,1] op_sel_hi:[0,0,1]
    v_fma_mix_f32 v226, v226, v30, v89 op_sel:[0,0,0] op_sel_hi:[0,0,1]
    v_fma_mix_f32 v227, v227, v30, v89 op_sel:[0,0,1] op_sel_hi:[0,0,1]
    v_fma_mix_f32 v228, v228, v30, v90 op_sel:[0,0,0] op_sel_hi:[0,0,1]
    v_fma_mix_f32 v229, v229, v30, v90 op_sel:[0,0,1] op_sel_hi:[0,0,1]
    v_fma_mix_f32 v230, v230, v30, v91 op_sel:[0,0,0] op_sel_hi:[0,0,1]
    v_fma_mix_f32 v231, v231, v30, v91 op_sel:[0,0,1] op_sel_hi:[0,0,1]
    v_cvt_pk_bf16_f32 v176, v224, v225
    v_cvt_pk_bf16_f32 v177, v226, v227
    v_cvt_pk_bf16_f32 v178, v228, v229
    v_cvt_pk_bf16_f32 v179, v230, v231
    ds_write_b128 v37, v[176:179] offset:12288
    v_mfma_f32_32x32x16_bf16 v[104:119], v[172:175], a[12:15], v[104:119]
    ds_read_b64_tr_b16 a[28:29], v10 offset:55296
    ds_read_b64_tr_b16 a[30:31], v10 offset:56320
    v_fma_mix_f32 v232, v232, v30, v92 op_sel:[0,0,0] op_sel_hi:[0,0,1]
    v_fma_mix_f32 v233, v233, v30, v92 op_sel:[0,0,1] op_sel_hi:[0,0,1]
    v_fma_mix_f32 v234, v234, v30, v93 op_sel:[0,0,0] op_sel_hi:[0,0,1]
    v_fma_mix_f32 v235, v235, v30, v93 op_sel:[0,0,1] op_sel_hi:[0,0,1]
    v_fma_mix_f32 v236, v236, v30, v94 op_sel:[0,0,0] op_sel_hi:[0,0,1]
    v_fma_mix_f32 v237, v237, v30, v94 op_sel:[0,0,1] op_sel_hi:[0,0,1]
    v_fma_mix_f32 v238, v238, v30, v95 op_sel:[0,0,0] op_sel_hi:[0,0,1]
    v_fma_mix_f32 v239, v239, v30, v95 op_sel:[0,0,1] op_sel_hi:[0,0,1]
    v_cvt_pk_bf16_f32 v180, v232, v233
    v_cvt_pk_bf16_f32 v181, v234, v235
    v_cvt_pk_bf16_f32 v182, v236, v237
    v_cvt_pk_bf16_f32 v183, v238, v239
    ds_write_b128 v37, v[180:183] offset:13312
    s_waitcnt lgkmcnt(7)
    v_mfma_f32_32x32x16_bf16 v[104:119], v[176:179], a[16:19], v[104:119]
    ds_read_b64_tr_b16 a[0:1], v11 offset:0
    ds_read_b64_tr_b16 a[2:3], v11 offset:1024
    v_fma_mix_f32 v240, v240, v30, v96 op_sel:[0,0,0] op_sel_hi:[0,0,1]
    v_fma_mix_f32 v241, v241, v30, v96 op_sel:[0,0,1] op_sel_hi:[0,0,1]
    v_fma_mix_f32 v242, v242, v30, v97 op_sel:[0,0,0] op_sel_hi:[0,0,1]
    v_fma_mix_f32 v243, v243, v30, v97 op_sel:[0,0,1] op_sel_hi:[0,0,1]
    v_fma_mix_f32 v244, v244, v30, v98 op_sel:[0,0,0] op_sel_hi:[0,0,1]
    v_fma_mix_f32 v245, v245, v30, v98 op_sel:[0,0,1] op_sel_hi:[0,0,1]
    v_fma_mix_f32 v246, v246, v30, v99 op_sel:[0,0,0] op_sel_hi:[0,0,1]
    v_fma_mix_f32 v247, v247, v30, v99 op_sel:[0,0,1] op_sel_hi:[0,0,1]
    v_cvt_pk_bf16_f32 v184, v240, v241
    v_cvt_pk_bf16_f32 v185, v242, v243
    v_cvt_pk_bf16_f32 v186, v244, v245
    v_cvt_pk_bf16_f32 v187, v246, v247
    ds_write_b128 v37, v[184:187] offset:14336
    v_mfma_f32_32x32x16_bf16 v[104:119], v[180:183], a[20:23], v[104:119]
    ds_read_b64_tr_b16 a[4:5], v11 offset:2048
    ds_read_b64_tr_b16 a[6:7], v11 offset:3072
    v_fma_mix_f32 v248, v248, v30, v100 op_sel:[0,0,0] op_sel_hi:[0,0,1]
    v_fma_mix_f32 v249, v249, v30, v100 op_sel:[0,0,1] op_sel_hi:[0,0,1]
    v_fma_mix_f32 v250, v250, v30, v101 op_sel:[0,0,0] op_sel_hi:[0,0,1]
    v_fma_mix_f32 v251, v251, v30, v101 op_sel:[0,0,1] op_sel_hi:[0,0,1]
    v_fma_mix_f32 v252, v252, v30, v102 op_sel:[0,0,0] op_sel_hi:[0,0,1]
    v_fma_mix_f32 v253, v253, v30, v102 op_sel:[0,0,1] op_sel_hi:[0,0,1]
    v_fma_mix_f32 v254, v254, v30, v103 op_sel:[0,0,0] op_sel_hi:[0,0,1]
    v_fma_mix_f32 v255, v255, v30, v103 op_sel:[0,0,1] op_sel_hi:[0,0,1]
    v_cvt_pk_bf16_f32 v188, v248, v249
    v_cvt_pk_bf16_f32 v189, v250, v251
    v_cvt_pk_bf16_f32 v190, v252, v253
    v_cvt_pk_bf16_f32 v191, v254, v255
    ds_write_b128 v37, v[188:191] offset:15360
    s_waitcnt lgkmcnt(7)
    v_mfma_f32_32x32x16_bf16 v[104:119], v[184:187], a[24:27], v[104:119]
    ds_read_b64_tr_b16 a[8:9], v11 offset:4096
    ds_read_b64_tr_b16 a[10:11], v11 offset:5120
    s_waitcnt lgkmcnt(2)
    s_barrier
    ds_read_b128 v[192:195], v36 offset:0
    ds_read_b128 v[196:199], v36 offset:1024
    ds_read_b128 v[200:203], v36 offset:2048
    ds_read_b128 v[204:207], v36 offset:3072
    ds_read_b128 v[208:211], v36 offset:4096
    ds_read_b128 v[212:215], v36 offset:5120
    ds_read_b128 v[216:219], v36 offset:6144
    ds_read_b128 v[220:223], v36 offset:7168
    ds_read_b128 v[224:227], v36 offset:8192
    ds_read_b128 v[228:231], v36 offset:9216
    ds_read_b128 v[232:235], v36 offset:10240
    ds_read_b128 v[236:239], v36 offset:11264
    ds_read_b128 v[240:243], v36 offset:12288
    ds_read_b128 v[244:247], v36 offset:13312
    ds_read_b128 v[248:251], v36 offset:14336
    ds_read_b128 v[252:255], v36 offset:15360
    v_mfma_f32_32x32x16_bf16 v[104:119], v[188:191], a[28:31], v[104:119]
    ds_read_b64_tr_b16 a[12:13], v11 offset:6144
    ds_read_b64_tr_b16 a[14:15], v11 offset:7168
    s_waitcnt lgkmcnt(15)
    v_mfma_f32_32x32x16_bf16 v[104:119], v[192:195], a[0:3], v[104:119]
    ds_read_b64_tr_b16 a[16:17], v11 offset:16384
    ds_read_b64_tr_b16 a[18:19], v11 offset:17408
    v_mfma_f32_32x32x16_bf16 v[104:119], v[196:199], a[4:7], v[104:119]
    ds_read_b64_tr_b16 a[20:21], v11 offset:18432
    ds_read_b64_tr_b16 a[22:23], v11 offset:19456
    v_mfma_f32_32x32x16_bf16 v[104:119], v[200:203], a[8:11], v[104:119]
    ds_read_b64_tr_b16 a[24:25], v11 offset:20480
    ds_read_b64_tr_b16 a[26:27], v11 offset:21504
    s_waitcnt lgkmcnt(6)
    v_mfma_f32_32x32x16_bf16 v[104:119], v[204:207], a[12:15], v[104:119]
    ds_read_b64_tr_b16 a[28:29], v11 offset:22528
    ds_read_b64_tr_b16 a[30:31], v11 offset:23552
    s_waitcnt lgkmcnt(4)
    v_mfma_f32_32x32x16_bf16 v[104:119], v[208:211], a[16:19], v[104:119]
    ds_read_b64_tr_b16 a[0:1], v11 offset:32768
    ds_read_b64_tr_b16 a[2:3], v11 offset:33792
    v_mfma_f32_32x32x16_bf16 v[104:119], v[212:215], a[20:23], v[104:119]
    ds_read_b64_tr_b16 a[4:5], v11 offset:34816
    ds_read_b64_tr_b16 a[6:7], v11 offset:35840
    s_barrier
    s_waitcnt lgkmcnt(4)
    v_mfma_f32_32x32x16_bf16 v[104:119], v[216:219], a[24:27], v[104:119]
    ds_read_b64_tr_b16 a[8:9], v11 offset:36864
    ds_read_b64_tr_b16 a[10:11], v11 offset:37888
    s_add_u32 m0, s38, 98304
    s_add_u32 s43, s54, 114816
    buffer_load_dwordx4 v14, s[20:23], s43 offen offset:0 lds
    v_mfma_f32_32x32x16_bf16 v[104:119], v[220:223], a[28:31], v[104:119]
    ds_read_b64_tr_b16 a[12:13], v11 offset:38912
    ds_read_b64_tr_b16 a[14:15], v11 offset:39936
    buffer_load_dwordx4 v15, s[20:23], s43 offen offset:1024 lds
    s_waitcnt lgkmcnt(4)
    v_mfma_f32_32x32x16_bf16 v[104:119], v[224:227], a[0:3], v[104:119]
    ds_read_b64_tr_b16 a[16:17], v11 offset:49152
    ds_read_b64_tr_b16 a[18:19], v11 offset:50176
    buffer_load_dwordx4 v16, s[20:23], s43 offen offset:2048 lds
    v_mfma_f32_32x32x16_bf16 v[104:119], v[228:231], a[4:7], v[104:119]
    ds_read_b64_tr_b16 a[20:21], v11 offset:51200
    ds_read_b64_tr_b16 a[22:23], v11 offset:52224
    buffer_load_dwordx4 v17, s[20:23], s43 offen offset:3072 lds
    s_waitcnt lgkmcnt(4)
    v_mfma_f32_32x32x16_bf16 v[104:119], v[232:235], a[8:11], v[104:119]
    ds_read_b64_tr_b16 a[24:25], v11 offset:53248
    ds_read_b64_tr_b16 a[26:27], v11 offset:54272
    s_add_u32 m0, s38, 114688
    s_add_u32 s43, s54, 172160
    buffer_load_dwordx4 v14, s[20:23], s43 offen offset:0 lds
    v_mfma_f32_32x32x16_bf16 v[104:119], v[236:239], a[12:15], v[104:119]
    ds_read_b64_tr_b16 a[28:29], v11 offset:55296
    ds_read_b64_tr_b16 a[30:31], v11 offset:56320
    buffer_load_dwordx4 v15, s[20:23], s43 offen offset:1024 lds
    s_waitcnt lgkmcnt(4)
    v_mfma_f32_32x32x16_bf16 v[104:119], v[240:243], a[16:19], v[104:119]
    v_xor_b32 v10, 65536, v10
    v_xor_b32 v11, 65536, v11
    ds_read_b64_tr_b16 a[0:1], v10 offset:0
    ds_read_b64_tr_b16 a[2:3], v10 offset:1024
    buffer_load_dwordx4 v16, s[20:23], s43 offen offset:2048 lds
    v_mfma_f32_32x32x16_bf16 v[104:119], v[244:247], a[20:23], v[104:119]
    ds_read_b64_tr_b16 a[4:5], v10 offset:2048
    ds_read_b64_tr_b16 a[6:7], v10 offset:3072
    s_waitcnt lgkmcnt(4)
    v_mfma_f32_32x32x16_bf16 v[104:119], v[248:251], a[24:27], v[104:119]
    ds_read_b64_tr_b16 a[8:9], v10 offset:4096
    ds_read_b64_tr_b16 a[10:11], v10 offset:5120
    buffer_load_dwordx4 v17, s[20:23], s43 offen offset:3072 lds
    v_mfma_f32_32x32x16_bf16 v[104:119], v[252:255], a[28:31], v[104:119]
    ds_read_b64_tr_b16 a[12:13], v10 offset:6144
    ds_read_b64_tr_b16 a[14:15], v10 offset:7168
    s_add_u32 s54, s54, 128
    s_waitcnt vmcnt(63)
    s_barrier
    s_waitcnt lgkmcnt(4)
    v_mfma_f32_32x32x16_bf16 v[40:55], v[128:131], a[0:3], 0
    ds_read_b64_tr_b16 a[16:17], v11 offset:0
    ds_read_b64_tr_b16 a[18:19], v11 offset:1024
    s_add_u32 m0, s38, 0
    s_add_u32 s43, s54, 128
    buffer_load_dwordx4 v14, s[20:23], s43 offen offset:0 lds
    v_mfma_f32_32x32x16_bf16 v[40:55], v[132:135], a[4:7], v[40:55]
    ds_read_b64_tr_b16 a[20:21], v11 offset:2048
    ds_read_b64_tr_b16 a[22:23], v11 offset:3072
    buffer_load_dwordx4 v15, s[20:23], s43 offen offset:1024 lds
    s_waitcnt lgkmcnt(4)
    v_mfma_f32_32x32x16_bf16 v[40:55], v[136:139], a[8:11], v[40:55]
    ds_read_b64_tr_b16 a[24:25], v11 offset:4096
    ds_read_b64_tr_b16 a[26:27], v11 offset:5120
    buffer_load_dwordx4 v16, s[20:23], s43 offen offset:2048 lds
    v_cvt_pk_f16_f32 v72, v104, v105
    v_cvt_pk_f16_f32 v73, v106, v107
    v_mfma_f32_32x32x16_bf16 v[40:55], v[140:143], a[12:15], v[40:55]
    ds_read_b64_tr_b16 a[28:29], v11 offset:6144
    ds_read_b64_tr_b16 a[30:31], v11 offset:7168
    buffer_load_dwordx4 v17, s[20:23], s43 offen offset:3072 lds
    v_cvt_pk_f16_f32 v74, v108, v109
    v_cvt_pk_f16_f32 v75, v110, v111
    s_waitcnt lgkmcnt(4)
    v_mfma_f32_32x32x16_bf16 v[40:55], v[192:195], a[16:19], v[40:55]
    ds_read_b64_tr_b16 a[0:1], v10 offset:16384
    ds_read_b64_tr_b16 a[2:3], v10 offset:17408
    s_add_u32 m0, s38, 16384
    s_add_u32 s43, s54, 57472
    buffer_load_dwordx4 v14, s[20:23], s43 offen offset:0 lds
    v_cvt_pk_f16_f32 v76, v112, v113
    v_cvt_pk_f16_f32 v77, v114, v115
    v_mfma_f32_32x32x16_bf16 v[40:55], v[196:199], a[20:23], v[40:55]
    ds_read_b64_tr_b16 a[4:5], v10 offset:18432
    ds_read_b64_tr_b16 a[6:7], v10 offset:19456
    buffer_load_dwordx4 v15, s[20:23], s43 offen offset:1024 lds
    v_cvt_pk_f16_f32 v78, v116, v117
    v_cvt_pk_f16_f32 v79, v118, v119
    s_waitcnt lgkmcnt(4)
    v_mfma_f32_32x32x16_bf16 v[40:55], v[200:203], a[24:27], v[40:55]
    ds_read_b64_tr_b16 a[8:9], v10 offset:20480
    ds_read_b64_tr_b16 a[10:11], v10 offset:21504
    buffer_load_dwordx4 v16, s[20:23], s43 offen offset:2048 lds
    v_accvgpr_write_b32 a32, v72
    v_mfma_f32_32x32x16_bf16 v[40:55], v[204:207], a[28:31], v[40:55]
    ds_read_b64_tr_b16 a[12:13], v10 offset:22528
    ds_read_b64_tr_b16 a[14:15], v10 offset:23552
    buffer_load_dwordx4 v17, s[20:23], s43 offen offset:3072 lds
    v_accvgpr_write_b32 a33, v73
    s_waitcnt vmcnt(12)
    s_barrier
    s_waitcnt lgkmcnt(4)
    v_mfma_f32_32x32x16_bf16 v[40:55], v[144:147], a[0:3], v[40:55]
    ds_read_b64_tr_b16 a[16:17], v11 offset:16384
    ds_read_b64_tr_b16 a[18:19], v11 offset:17408
    s_add_u32 m0, s38, 32768
    s_add_u32 s43, s54, 114816
    buffer_load_dwordx4 v14, s[20:23], s43 offen offset:0 lds
    v_accvgpr_write_b32 a34, v74
    v_mfma_f32_32x32x16_bf16 v[40:55], v[148:151], a[4:7], v[40:55]
    ds_read_b64_tr_b16 a[20:21], v11 offset:18432
    ds_read_b64_tr_b16 a[22:23], v11 offset:19456
    buffer_load_dwordx4 v15, s[20:23], s43 offen offset:1024 lds
    v_accvgpr_write_b32 a35, v75
    s_waitcnt lgkmcnt(4)
    v_mfma_f32_32x32x16_bf16 v[40:55], v[152:155], a[8:11], v[40:55]
    ds_read_b64_tr_b16 a[24:25], v11 offset:20480
    ds_read_b64_tr_b16 a[26:27], v11 offset:21504
    buffer_load_dwordx4 v16, s[20:23], s43 offen offset:2048 lds
    v_accvgpr_write_b32 a36, v76
    v_mfma_f32_32x32x16_bf16 v[40:55], v[156:159], a[12:15], v[40:55]
    ds_read_b64_tr_b16 a[28:29], v11 offset:22528
    ds_read_b64_tr_b16 a[30:31], v11 offset:23552
    buffer_load_dwordx4 v17, s[20:23], s43 offen offset:3072 lds
    v_accvgpr_write_b32 a37, v77
    s_waitcnt lgkmcnt(4)
    v_mfma_f32_32x32x16_bf16 v[40:55], v[208:211], a[16:19], v[40:55]
    ds_read_b64_tr_b16 a[0:1], v10 offset:32768
    ds_read_b64_tr_b16 a[2:3], v10 offset:33792
    s_add_u32 m0, s38, 49152
    s_add_u32 s43, s54, 172160
    buffer_load_dwordx4 v14, s[20:23], s43 offen offset:0 lds
    v_accvgpr_write_b32 a38, v78
    v_mfma_f32_32x32x16_bf16 v[40:55], v[212:215], a[20:23], v[40:55]
    ds_read_b64_tr_b16 a[4:5], v10 offset:34816
    ds_read_b64_tr_b16 a[6:7], v10 offset:35840
    buffer_load_dwordx4 v15, s[20:23], s43 offen offset:1024 lds
    v_accvgpr_write_b32 a39, v79
    s_waitcnt lgkmcnt(4)
    v_mfma_f32_32x32x16_bf16 v[40:55], v[216:219], a[24:27], v[40:55]
    ds_read_b64_tr_b16 a[8:9], v10 offset:36864
    ds_read_b64_tr_b16 a[10:11], v10 offset:37888
    buffer_load_dwordx4 v16, s[20:23], s43 offen offset:2048 lds
    v_mfma_f32_32x32x16_bf16 v[40:55], v[220:223], a[28:31], v[40:55]
    ds_read_b64_tr_b16 a[12:13], v10 offset:38912
    ds_read_b64_tr_b16 a[14:15], v10 offset:39936
    buffer_load_dwordx4 v17, s[20:23], s43 offen offset:3072 lds
    s_waitcnt vmcnt(16)
    s_barrier
    s_waitcnt lgkmcnt(4)
    v_mfma_f32_32x32x16_bf16 v[40:55], v[160:163], a[0:3], v[40:55]
    ds_read_b64_tr_b16 a[16:17], v11 offset:32768
    ds_read_b64_tr_b16 a[18:19], v11 offset:33792
    s_add_u32 m0, s38, 65536
    s_add_u32 s43, s54, 256
    buffer_load_dwordx4 v14, s[20:23], s43 offen offset:0 lds
    v_mfma_f32_32x32x16_bf16 v[40:55], v[164:167], a[4:7], v[40:55]
    ds_read_b64_tr_b16 a[20:21], v11 offset:34816
    ds_read_b64_tr_b16 a[22:23], v11 offset:35840
    buffer_load_dwordx4 v15, s[20:23], s43 offen offset:1024 lds
    s_waitcnt lgkmcnt(4)
    v_mfma_f32_32x32x16_bf16 v[40:55], v[168:171], a[8:11], v[40:55]
    ds_read_b64_tr_b16 a[24:25], v11 offset:36864
    ds_read_b64_tr_b16 a[26:27], v11 offset:37888
    buffer_load_dwordx4 v16, s[20:23], s43 offen offset:2048 lds
    v_mfma_f32_32x32x16_bf16 v[40:55], v[172:175], a[12:15], v[40:55]
    ds_read_b64_tr_b16 a[28:29], v11 offset:38912
    ds_read_b64_tr_b16 a[30:31], v11 offset:39936
    buffer_load_dwordx4 v17, s[20:23], s43 offen offset:3072 lds
    s_waitcnt lgkmcnt(4)
    v_mfma_f32_32x32x16_bf16 v[40:55], v[224:227], a[16:19], v[40:55]
    ds_read_b64_tr_b16 a[0:1], v10 offset:49152
    ds_read_b64_tr_b16 a[2:3], v10 offset:50176
    s_add_u32 m0, s38, 81920
    s_add_u32 s43, s54, 57600
    buffer_load_dwordx4 v14, s[20:23], s43 offen offset:0 lds
    v_mfma_f32_32x32x16_bf16 v[40:55], v[228:231], a[20:23], v[40:55]
    ds_read_b64_tr_b16 a[4:5], v10 offset:51200
    ds_read_b64_tr_b16 a[6:7], v10 offset:52224
    buffer_load_dwordx4 v15, s[20:23], s43 offen offset:1024 lds
    s_waitcnt lgkmcnt(4)
    v_mfma_f32_32x32x16_bf16 v[40:55], v[232:235], a[24:27], v[40:55]
    ds_read_b64_tr_b16 a[8:9], v10 offset:53248
    ds_read_b64_tr_b16 a[10:11], v10 offset:54272
    buffer_load_dwordx4 v16, s[20:23], s43 offen offset:2048 lds
    v_mfma_f32_32x32x16_bf16 v[40:55], v[236:239], a[28:31], v[40:55]
    ds_read_b64_tr_b16 a[12:13], v10 offset:55296
    ds_read_b64_tr_b16 a[14:15], v10 offset:56320
    buffer_load_dwordx4 v17, s[20:23], s43 offen offset:3072 lds
    s_waitcnt vmcnt(20)
    s_barrier
    s_waitcnt lgkmcnt(4)
    v_mfma_f32_32x32x16_bf16 v[40:55], v[176:179], a[0:3], v[40:55]
    ds_read_b64_tr_b16 a[16:17], v11 offset:49152
    ds_read_b64_tr_b16 a[18:19], v11 offset:50176
    s_add_u32 m0, s38, 98304
    s_add_u32 s43, s54, 114944
    buffer_load_dwordx4 v14, s[20:23], s43 offen offset:0 lds
    v_mfma_f32_32x32x16_bf16 v[40:55], v[180:183], a[4:7], v[40:55]
    ds_read_b64_tr_b16 a[20:21], v11 offset:51200
    ds_read_b64_tr_b16 a[22:23], v11 offset:52224
    s_waitcnt lgkmcnt(4)
    v_mfma_f32_32x32x16_bf16 v[40:55], v[184:187], a[8:11], v[40:55]
    ds_read_b64_tr_b16 a[24:25], v11 offset:53248
    ds_read_b64_tr_b16 a[26:27], v11 offset:54272
    buffer_load_dwordx4 v15, s[20:23], s43 offen offset:1024 lds
    v_mfma_f32_32x32x16_bf16 v[40:55], v[188:191], a[12:15], v[40:55]
    ds_read_b64_tr_b16 a[28:29], v11 offset:55296
    ds_read_b64_tr_b16 a[30:31], v11 offset:56320
    s_waitcnt lgkmcnt(4)
    v_mfma_f32_32x32x16_bf16 v[40:55], v[240:243], a[16:19], v[40:55]
    v_xor_b32 v10, 65536, v10
    v_xor_b32 v11, 65536, v11
    ds_read_b64_tr_b16 a[0:1], v10 offset:0
    ds_read_b64_tr_b16 a[2:3], v10 offset:1024
    buffer_load_dwordx4 v16, s[20:23], s43 offen offset:2048 lds
    v_mfma_f32_32x32x16_bf16 v[40:55], v[244:247], a[20:23], v[40:55]
    ds_read_b64_tr_b16 a[4:5], v10 offset:2048
    ds_read_b64_tr_b16 a[6:7], v10 offset:3072
    s_waitcnt lgkmcnt(4)
    v_mfma_f32_32x32x16_bf16 v[40:55], v[248:251], a[24:27], v[40:55]
    ds_read_b64_tr_b16 a[8:9], v10 offset:4096
    ds_read_b64_tr_b16 a[10:11], v10 offset:5120
    buffer_load_dwordx4 v17, s[20:23], s43 offen offset:3072 lds
    v_mfma_f32_32x32x16_bf16 v[40:55], v[252:255], a[28:31], v[40:55]
    ds_read_b64_tr_b16 a[12:13], v10 offset:6144
    ds_read_b64_tr_b16 a[14:15], v10 offset:7168
    s_add_u32 s57, s57, 256
    s_add_u32 s54, s54, 128
    s_waitcnt vmcnt(20)
    s_barrier
    s_waitcnt lgkmcnt(4)
    v_mfma_f32_32x32x16_bf16 v[104:119], v[128:131], a[0:3], 0
    ds_read_b64_tr_b16 a[16:17], v11 offset:0
    ds_read_b64_tr_b16 a[18:19], v11 offset:1024
    s_add_u32 m0, s38, 114688
    s_add_u32 s43, s54, 172160
    buffer_load_dwordx4 v14, s[20:23], s43 offen offset:0 lds
    v_mfma_f32_32x32x16_bf16 v[104:119], v[132:135], a[4:7], v[104:119]
    ds_read_b64_tr_b16 a[20:21], v11 offset:2048
    ds_read_b64_tr_b16 a[22:23], v11 offset:3072
    s_waitcnt lgkmcnt(4)
    v_mfma_f32_32x32x16_bf16 v[104:119], v[136:139], a[8:11], v[104:119]
    ds_read_b64_tr_b16 a[24:25], v11 offset:4096
    ds_read_b64_tr_b16 a[26:27], v11 offset:5120
    buffer_load_dwordx4 v15, s[20:23], s43 offen offset:1024 lds
    v_cvt_pk_f16_f32 v72, v40, v41
    v_cvt_pk_f16_f32 v73, v42, v43
    v_mfma_f32_32x32x16_bf16 v[104:119], v[140:143], a[12:15], v[104:119]
    ds_read_b64_tr_b16 a[28:29], v11 offset:6144
    ds_read_b64_tr_b16 a[30:31], v11 offset:7168
    v_cvt_pk_f16_f32 v74, v44, v45
    v_cvt_pk_f16_f32 v75, v46, v47
    s_waitcnt lgkmcnt(4)
    v_mfma_f32_32x32x16_bf16 v[104:119], v[192:195], a[16:19], v[104:119]
    ds_read_b64_tr_b16 a[0:1], v10 offset:16384
    ds_read_b64_tr_b16 a[2:3], v10 offset:17408
    buffer_load_dwordx4 v16, s[20:23], s43 offen offset:2048 lds
    v_cvt_pk_f16_f32 v76, v48, v49
    v_cvt_pk_f16_f32 v77, v50, v51
    v_mfma_f32_32x32x16_bf16 v[104:119], v[196:199], a[20:23], v[104:119]
    ds_read_b64_tr_b16 a[4:5], v10 offset:18432
    ds_read_b64_tr_b16 a[6:7], v10 offset:19456
    v_cvt_pk_f16_f32 v78, v52, v53
    v_cvt_pk_f16_f32 v79, v54, v55
    s_waitcnt lgkmcnt(4)
    v_mfma_f32_32x32x16_bf16 v[104:119], v[200:203], a[24:27], v[104:119]
    ds_read_b64_tr_b16 a[8:9], v10 offset:20480
    ds_read_b64_tr_b16 a[10:11], v10 offset:21504
    buffer_load_dwordx4 v17, s[20:23], s43 offen offset:3072 lds
    v_accvgpr_write_b32 a40, v72
    v_mfma_f32_32x32x16_bf16 v[104:119], v[204:207], a[28:31], v[104:119]
    ds_read_b64_tr_b16 a[12:13], v10 offset:22528
    ds_read_b64_tr_b16 a[14:15], v10 offset:23552
    v_accvgpr_write_b32 a41, v73
    s_waitcnt vmcnt(20)
    s_barrier
    s_waitcnt lgkmcnt(4)
    v_mfma_f32_32x32x16_bf16 v[104:119], v[144:147], a[0:3], v[104:119]
    ds_read_b64_tr_b16 a[16:17], v11 offset:16384
    ds_read_b64_tr_b16 a[18:19], v11 offset:17408
    s_add_u32 m0, s38, 0
    s_add_u32 s43, s54, 256
    buffer_load_dwordx4 v14, s[20:23], s43 offen offset:0 lds
    v_accvgpr_write_b32 a42, v74
    v_mfma_f32_32x32x16_bf16 v[104:119], v[148:151], a[4:7], v[104:119]
    ds_read_b64_tr_b16 a[20:21], v11 offset:18432
    ds_read_b64_tr_b16 a[22:23], v11 offset:19456
    v_accvgpr_write_b32 a43, v75
    s_waitcnt lgkmcnt(4)
    v_mfma_f32_32x32x16_bf16 v[104:119], v[152:155], a[8:11], v[104:119]
    ds_read_b64_tr_b16 a[24:25], v11 offset:20480
    ds_read_b64_tr_b16 a[26:27], v11 offset:21504
    buffer_load_dwordx4 v15, s[20:23], s43 offen offset:1024 lds
    v_accvgpr_write_b32 a44, v76
    v_mfma_f32_32x32x16_bf16 v[104:119], v[156:159], a[12:15], v[104:119]
    ds_read_b64_tr_b16 a[28:29], v11 offset:22528
    ds_read_b64_tr_b16 a[30:31], v11 offset:23552
    v_accvgpr_write_b32 a45, v77
    s_waitcnt lgkmcnt(4)
    v_mfma_f32_32x32x16_bf16 v[104:119], v[208:211], a[16:19], v[104:119]
    ds_read_b64_tr_b16 a[0:1], v10 offset:32768
    ds_read_b64_tr_b16 a[2:3], v10 offset:33792
    buffer_load_dwordx4 v16, s[20:23], s43 offen offset:2048 lds
    v_accvgpr_write_b32 a46, v78
    v_mfma_f32_32x32x16_bf16 v[104:119], v[212:215], a[20:23], v[104:119]
    ds_read_b64_tr_b16 a[4:5], v10 offset:34816
    ds_read_b64_tr_b16 a[6:7], v10 offset:35840
    v_accvgpr_write_b32 a47, v79
    s_waitcnt lgkmcnt(4)
    v_mfma_f32_32x32x16_bf16 v[104:119], v[216:219], a[24:27], v[104:119]
    ds_read_b64_tr_b16 a[8:9], v10 offset:36864
    ds_read_b64_tr_b16 a[10:11], v10 offset:37888
    buffer_load_dwordx4 v17, s[20:23], s43 offen offset:3072 lds
    v_mfma_f32_32x32x16_bf16 v[104:119], v[220:223], a[28:31], v[104:119]
    ds_read_b64_tr_b16 a[12:13], v10 offset:38912
    ds_read_b64_tr_b16 a[14:15], v10 offset:39936
    s_waitcnt vmcnt(20)
    s_barrier
    s_waitcnt lgkmcnt(4)
    v_mfma_f32_32x32x16_bf16 v[104:119], v[160:163], a[0:3], v[104:119]
    ds_read_b64_tr_b16 a[16:17], v11 offset:32768
    ds_read_b64_tr_b16 a[18:19], v11 offset:33792
    s_add_u32 m0, s38, 16384
    s_add_u32 s43, s54, 57600
    buffer_load_dwordx4 v14, s[20:23], s43 offen offset:0 lds
    v_mfma_f32_32x32x16_bf16 v[104:119], v[164:167], a[4:7], v[104:119]
    ds_read_b64_tr_b16 a[20:21], v11 offset:34816
    ds_read_b64_tr_b16 a[22:23], v11 offset:35840
    s_waitcnt lgkmcnt(4)
    v_mfma_f32_32x32x16_bf16 v[104:119], v[168:171], a[8:11], v[104:119]
    ds_read_b64_tr_b16 a[24:25], v11 offset:36864
    ds_read_b64_tr_b16 a[26:27], v11 offset:37888
    buffer_load_dwordx4 v15, s[20:23], s43 offen offset:1024 lds
    v_mfma_f32_32x32x16_bf16 v[104:119], v[172:175], a[12:15], v[104:119]
    ds_read_b64_tr_b16 a[28:29], v11 offset:38912
    ds_read_b64_tr_b16 a[30:31], v11 offset:39936
    s_waitcnt lgkmcnt(4)
    v_mfma_f32_32x32x16_bf16 v[104:119], v[224:227], a[16:19], v[104:119]
    ds_read_b64_tr_b16 a[0:1], v10 offset:49152
    ds_read_b64_tr_b16 a[2:3], v10 offset:50176
    buffer_load_dwordx4 v16, s[20:23], s43 offen offset:2048 lds
    v_mfma_f32_32x32x16_bf16 v[104:119], v[228:231], a[20:23], v[104:119]
    ds_read_b64_tr_b16 a[4:5], v10 offset:51200
    ds_read_b64_tr_b16 a[6:7], v10 offset:52224
    s_waitcnt lgkmcnt(4)
    v_mfma_f32_32x32x16_bf16 v[104:119], v[232:235], a[24:27], v[104:119]
    ds_read_b64_tr_b16 a[8:9], v10 offset:53248
    ds_read_b64_tr_b16 a[10:11], v10 offset:54272
    buffer_load_dwordx4 v17, s[20:23], s43 offen offset:3072 lds
    v_mfma_f32_32x32x16_bf16 v[104:119], v[236:239], a[28:31], v[104:119]
    ds_read_b64_tr_b16 a[12:13], v10 offset:55296
    ds_read_b64_tr_b16 a[14:15], v10 offset:56320
    s_waitcnt vmcnt(20)
    s_barrier
    s_waitcnt lgkmcnt(4)
    v_mfma_f32_32x32x16_bf16 v[104:119], v[176:179], a[0:3], v[104:119]
    ds_read_b64_tr_b16 a[16:17], v11 offset:49152
    ds_read_b64_tr_b16 a[18:19], v11 offset:50176
    s_add_u32 m0, s38, 32768
    s_add_u32 s43, s54, 114944
    buffer_load_dwordx4 v14, s[20:23], s43 offen offset:0 lds
    v_mfma_f32_32x32x16_bf16 v[104:119], v[180:183], a[4:7], v[104:119]
    ds_read_b64_tr_b16 a[20:21], v11 offset:51200
    ds_read_b64_tr_b16 a[22:23], v11 offset:52224
    s_waitcnt lgkmcnt(4)
    v_mfma_f32_32x32x16_bf16 v[104:119], v[184:187], a[8:11], v[104:119]
    ds_read_b64_tr_b16 a[24:25], v11 offset:53248
    ds_read_b64_tr_b16 a[26:27], v11 offset:54272
    buffer_load_dwordx4 v15, s[20:23], s43 offen offset:1024 lds
    v_mfma_f32_32x32x16_bf16 v[104:119], v[188:191], a[12:15], v[104:119]
    ds_read_b64_tr_b16 a[28:29], v11 offset:55296
    ds_read_b64_tr_b16 a[30:31], v11 offset:56320
    s_waitcnt lgkmcnt(4)
    v_mfma_f32_32x32x16_bf16 v[104:119], v[240:243], a[16:19], v[104:119]
    v_xor_b32 v10, 65536, v10
    v_xor_b32 v11, 65536, v11
    ds_read_b64_tr_b16 a[0:1], v10 offset:0
    ds_read_b64_tr_b16 a[2:3], v10 offset:1024
    buffer_load_dwordx4 v16, s[20:23], s43 offen offset:2048 lds
    v_mfma_f32_32x32x16_bf16 v[104:119], v[244:247], a[20:23], v[104:119]
    ds_read_b64_tr_b16 a[4:5], v10 offset:2048
    ds_read_b64_tr_b16 a[6:7], v10 offset:3072
    s_waitcnt lgkmcnt(4)
    v_mfma_f32_32x32x16_bf16 v[104:119], v[248:251], a[24:27], v[104:119]
    ds_read_b64_tr_b16 a[8:9], v10 offset:4096
    ds_read_b64_tr_b16 a[10:11], v10 offset:5120
    buffer_load_dwordx4 v17, s[20:23], s43 offen offset:3072 lds
    v_mfma_f32_32x32x16_bf16 v[104:119], v[252:255], a[28:31], v[104:119]
    ds_read_b64_tr_b16 a[12:13], v10 offset:6144
    ds_read_b64_tr_b16 a[14:15], v10 offset:7168
    s_add_u32 s57, s57, 256
    s_add_u32 s54, s54, 128
    s_waitcnt vmcnt(20)
    s_barrier
    s_waitcnt lgkmcnt(4)
    v_mfma_f32_32x32x16_bf16 v[40:55], v[128:131], a[0:3], 0
    ds_read_b64_tr_b16 a[16:17], v11 offset:0
    ds_read_b64_tr_b16 a[18:19], v11 offset:1024
    s_add_u32 m0, s38, 49152
    s_add_u32 s43, s54, 172160
    buffer_load_dwordx4 v14, s[20:23], s43 offen offset:0 lds
    v_mfma_f32_32x32x16_bf16 v[40:55], v[132:135], a[4:7], v[40:55]
    ds_read_b64_tr_b16 a[20:21], v11 offset:2048
    ds_read_b64_tr_b16 a[22:23], v11 offset:3072
    s_waitcnt lgkmcnt(4)
    v_mfma_f32_32x32x16_bf16 v[40:55], v[136:139], a[8:11], v[40:55]
    ds_read_b64_tr_b16 a[24:25], v11 offset:4096
    ds_read_b64_tr_b16 a[26:27], v11 offset:5120
    buffer_load_dwordx4 v15, s[20:23], s43 offen offset:1024 lds
    v_cvt_pk_f16_f32 v72, v104, v105
    v_cvt_pk_f16_f32 v73, v106, v107
    v_mfma_f32_32x32x16_bf16 v[40:55], v[140:143], a[12:15], v[40:55]
    ds_read_b64_tr_b16 a[28:29], v11 offset:6144
    ds_read_b64_tr_b16 a[30:31], v11 offset:7168
    v_cvt_pk_f16_f32 v74, v108, v109
    v_cvt_pk_f16_f32 v75, v110, v111
    s_waitcnt lgkmcnt(4)
    v_mfma_f32_32x32x16_bf16 v[40:55], v[192:195], a[16:19], v[40:55]
    ds_read_b64_tr_b16 a[0:1], v10 offset:16384
    ds_read_b64_tr_b16 a[2:3], v10 offset:17408
    buffer_load_dwordx4 v16, s[20:23], s43 offen offset:2048 lds
    v_cvt_pk_f16_f32 v76, v112, v113
    v_cvt_pk_f16_f32 v77, v114, v115
    v_mfma_f32_32x32x16_bf16 v[40:55], v[196:199], a[20:23], v[40:55]
    ds_read_b64_tr_b16 a[4:5], v10 offset:18432
    ds_read_b64_tr_b16 a[6:7], v10 offset:19456
    v_cvt_pk_f16_f32 v78, v116, v117
    v_cvt_pk_f16_f32 v79, v118, v119
    s_waitcnt lgkmcnt(4)
    v_mfma_f32_32x32x16_bf16 v[40:55], v[200:203], a[24:27], v[40:55]
    ds_read_b64_tr_b16 a[8:9], v10 offset:20480
    ds_read_b64_tr_b16 a[10:11], v10 offset:21504
    buffer_load_dwordx4 v17, s[20:23], s43 offen offset:3072 lds
    v_accvgpr_write_b32 a48, v72
    v_mfma_f32_32x32x16_bf16 v[40:55], v[204:207], a[28:31], v[40:55]
    ds_read_b64_tr_b16 a[12:13], v10 offset:22528
    ds_read_b64_tr_b16 a[14:15], v10 offset:23552
    v_accvgpr_write_b32 a49, v73
    s_waitcnt vmcnt(20)
    s_barrier
    s_waitcnt lgkmcnt(4)
    v_mfma_f32_32x32x16_bf16 v[40:55], v[144:147], a[0:3], v[40:55]
    ds_read_b64_tr_b16 a[16:17], v11 offset:16384
    ds_read_b64_tr_b16 a[18:19], v11 offset:17408
    s_add_u32 m0, s38, 65536
    s_add_u32 s43, s54, 256
    buffer_load_dwordx4 v14, s[20:23], s43 offen offset:0 lds
    v_accvgpr_write_b32 a50, v74
    v_mfma_f32_32x32x16_bf16 v[40:55], v[148:151], a[4:7], v[40:55]
    ds_read_b64_tr_b16 a[20:21], v11 offset:18432
    ds_read_b64_tr_b16 a[22:23], v11 offset:19456
    v_accvgpr_write_b32 a51, v75
    s_waitcnt lgkmcnt(4)
    v_mfma_f32_32x32x16_bf16 v[40:55], v[152:155], a[8:11], v[40:55]
    ds_read_b64_tr_b16 a[24:25], v11 offset:20480
    ds_read_b64_tr_b16 a[26:27], v11 offset:21504
    buffer_load_dwordx4 v15, s[20:23], s43 offen offset:1024 lds
    v_accvgpr_write_b32 a52, v76
    v_mfma_f32_32x32x16_bf16 v[40:55], v[156:159], a[12:15], v[40:55]
    ds_read_b64_tr_b16 a[28:29], v11 offset:22528
    ds_read_b64_tr_b16 a[30:31], v11 offset:23552
    v_accvgpr_write_b32 a53, v77
    s_waitcnt lgkmcnt(4)
    v_mfma_f32_32x32x16_bf16 v[40:55], v[208:211], a[16:19], v[40:55]
    ds_read_b64_tr_b16 a[0:1], v10 offset:32768
    ds_read_b64_tr_b16 a[2:3], v10 offset:33792
    buffer_load_dwordx4 v16, s[20:23], s43 offen offset:2048 lds
    v_accvgpr_write_b32 a54, v78
    v_mfma_f32_32x32x16_bf16 v[40:55], v[212:215], a[20:23], v[40:55]
    ds_read_b64_tr_b16 a[4:5], v10 offset:34816
    ds_read_b64_tr_b16 a[6:7], v10 offset:35840
    v_accvgpr_write_b32 a55, v79
    s_waitcnt lgkmcnt(4)
    v_mfma_f32_32x32x16_bf16 v[40:55], v[216:219], a[24:27], v[40:55]
    ds_read_b64_tr_b16 a[8:9], v10 offset:36864
    ds_read_b64_tr_b16 a[10:11], v10 offset:37888
    buffer_load_dwordx4 v17, s[20:23], s43 offen offset:3072 lds
    v_mfma_f32_32x32x16_bf16 v[40:55], v[220:223], a[28:31], v[40:55]
    ds_read_b64_tr_b16 a[12:13], v10 offset:38912
    ds_read_b64_tr_b16 a[14:15], v10 offset:39936
    s_waitcnt vmcnt(20)
    s_barrier
    s_waitcnt lgkmcnt(4)
    v_mfma_f32_32x32x16_bf16 v[40:55], v[160:163], a[0:3], v[40:55]
    ds_read_b64_tr_b16 a[16:17], v11 offset:32768
    ds_read_b64_tr_b16 a[18:19], v11 offset:33792
    s_add_u32 m0, s38, 81920
    s_add_u32 s43, s54, 57600
    buffer_load_dwordx4 v14, s[20:23], s43 offen offset:0 lds
    v_mfma_f32_32x32x16_bf16 v[40:55], v[164:167], a[4:7], v[40:55]
    ds_read_b64_tr_b16 a[20:21], v11 offset:34816
    ds_read_b64_tr_b16 a[22:23], v11 offset:35840
    s_waitcnt lgkmcnt(4)
    v_mfma_f32_32x32x16_bf16 v[40:55], v[168:171], a[8:11], v[40:55]
    ds_read_b64_tr_b16 a[24:25], v11 offset:36864
    ds_read_b64_tr_b16 a[26:27], v11 offset:37888
    buffer_load_dwordx4 v15, s[20:23], s43 offen offset:1024 lds
    v_mfma_f32_32x32x16_bf16 v[40:55], v[172:175], a[12:15], v[40:55]
    ds_read_b64_tr_b16 a[28:29], v11 offset:38912
    ds_read_b64_tr_b16 a[30:31], v11 offset:39936
    s_waitcnt lgkmcnt(4)
    v_mfma_f32_32x32x16_bf16 v[40:55], v[224:227], a[16:19], v[40:55]
    ds_read_b64_tr_b16 a[0:1], v10 offset:49152
    ds_read_b64_tr_b16 a[2:3], v10 offset:50176
    buffer_load_dwordx4 v16, s[20:23], s43 offen offset:2048 lds
    v_mfma_f32_32x32x16_bf16 v[40:55], v[228:231], a[20:23], v[40:55]
    ds_read_b64_tr_b16 a[4:5], v10 offset:51200
    ds_read_b64_tr_b16 a[6:7], v10 offset:52224
    s_waitcnt lgkmcnt(4)
    v_mfma_f32_32x32x16_bf16 v[40:55], v[232:235], a[24:27], v[40:55]
    ds_read_b64_tr_b16 a[8:9], v10 offset:53248
    ds_read_b64_tr_b16 a[10:11], v10 offset:54272
    buffer_load_dwordx4 v17, s[20:23], s43 offen offset:3072 lds
    v_mfma_f32_32x32x16_bf16 v[40:55], v[236:239], a[28:31], v[40:55]
    ds_read_b64_tr_b16 a[12:13], v10 offset:55296
    ds_read_b64_tr_b16 a[14:15], v10 offset:56320
    s_waitcnt vmcnt(20)
    s_barrier
    s_waitcnt lgkmcnt(4)
    v_mfma_f32_32x32x16_bf16 v[40:55], v[176:179], a[0:3], v[40:55]
    ds_read_b64_tr_b16 a[16:17], v11 offset:49152
    ds_read_b64_tr_b16 a[18:19], v11 offset:50176
    s_add_u32 m0, s38, 98304
    s_add_u32 s43, s54, 114944
    buffer_load_dwordx4 v14, s[20:23], s43 offen offset:0 lds
    v_mfma_f32_32x32x16_bf16 v[40:55], v[180:183], a[4:7], v[40:55]
    ds_read_b64_tr_b16 a[20:21], v11 offset:51200
    ds_read_b64_tr_b16 a[22:23], v11 offset:52224
    s_waitcnt lgkmcnt(4)
    v_mfma_f32_32x32x16_bf16 v[40:55], v[184:187], a[8:11], v[40:55]
    ds_read_b64_tr_b16 a[24:25], v11 offset:53248
    ds_read_b64_tr_b16 a[26:27], v11 offset:54272
    buffer_load_dwordx4 v15, s[20:23], s43 offen offset:1024 lds
    v_mfma_f32_32x32x16_bf16 v[40:55], v[188:191], a[12:15], v[40:55]
    ds_read_b64_tr_b16 a[28:29], v11 offset:55296
    ds_read_b64_tr_b16 a[30:31], v11 offset:56320
    s_waitcnt lgkmcnt(4)
    v_mfma_f32_32x32x16_bf16 v[40:55], v[240:243], a[16:19], v[40:55]
    v_xor_b32 v10, 65536, v10
    v_xor_b32 v11, 65536, v11
    ds_read_b64_tr_b16 a[0:1], v10 offset:0
    ds_read_b64_tr_b16 a[2:3], v10 offset:1024
    buffer_load_dwordx4 v16, s[20:23], s43 offen offset:2048 lds
    v_mfma_f32_32x32x16_bf16 v[40:55], v[244:247], a[20:23], v[40:55]
    ds_read_b64_tr_b16 a[4:5], v10 offset:2048
    ds_read_b64_tr_b16 a[6:7], v10 offset:3072
    s_waitcnt lgkmcnt(4)
    v_mfma_f32_32x32x16_bf16 v[40:55], v[248:251], a[24:27], v[40:55]
    ds_read_b64_tr_b16 a[8:9], v10 offset:4096
    ds_read_b64_tr_b16 a[10:11], v10 offset:5120
    buffer_load_dwordx4 v17, s[20:23], s43 offen offset:3072 lds
    v_mfma_f32_32x32x16_bf16 v[40:55], v[252:255], a[28:31], v[40:55]
    ds_read_b64_tr_b16 a[12:13], v10 offset:6144
    ds_read_b64_tr_b16 a[14:15], v10 offset:7168
    s_add_u32 s57, s57, 256
    s_add_u32 s54, s54, 128
    s_waitcnt vmcnt(20)
    s_barrier
    s_waitcnt lgkmcnt(4)
    v_mfma_f32_32x32x16_bf16 v[104:119], v[128:131], a[0:3], 0
    ds_read_b64_tr_b16 a[16:17], v11 offset:0
    ds_read_b64_tr_b16 a[18:19], v11 offset:1024
    s_add_u32 m0, s38, 114688
    s_add_u32 s43, s54, 172160
    buffer_load_dwordx4 v14, s[20:23], s43 offen offset:0 lds
    v_mfma_f32_32x32x16_bf16 v[104:119], v[132:135], a[4:7], v[104:119]
    ds_read_b64_tr_b16 a[20:21], v11 offset:2048
    ds_read_b64_tr_b16 a[22:23], v11 offset:3072
    s_waitcnt lgkmcnt(4)
    v_mfma_f32_32x32x16_bf16 v[104:119], v[136:139], a[8:11], v[104:119]
    ds_read_b64_tr_b16 a[24:25], v11 offset:4096
    ds_read_b64_tr_b16 a[26:27], v11 offset:5120
    buffer_load_dwordx4 v15, s[20:23], s43 offen offset:1024 lds
    v_cvt_pk_f16_f32 v72, v40, v41
    v_cvt_pk_f16_f32 v73, v42, v43
    v_mfma_f32_32x32x16_bf16 v[104:119], v[140:143], a[12:15], v[104:119]
    ds_read_b64_tr_b16 a[28:29], v11 offset:6144
    ds_read_b64_tr_b16 a[30:31], v11 offset:7168
    v_cvt_pk_f16_f32 v74, v44, v45
    v_cvt_pk_f16_f32 v75, v46, v47
    s_waitcnt lgkmcnt(4)
    v_mfma_f32_32x32x16_bf16 v[104:119], v[192:195], a[16:19], v[104:119]
    ds_read_b64_tr_b16 a[0:1], v10 offset:16384
    ds_read_b64_tr_b16 a[2:3], v10 offset:17408
    buffer_load_dwordx4 v16, s[20:23], s43 offen offset:2048 lds
    v_cvt_pk_f16_f32 v76, v48, v49
    v_cvt_pk_f16_f32 v77, v50, v51
    v_mfma_f32_32x32x16_bf16 v[104:119], v[196:199], a[20:23], v[104:119]
    ds_read_b64_tr_b16 a[4:5], v10 offset:18432
    ds_read_b64_tr_b16 a[6:7], v10 offset:19456
    v_cvt_pk_f16_f32 v78, v52, v53
    v_cvt_pk_f16_f32 v79, v54, v55
    s_waitcnt lgkmcnt(4)
    v_mfma_f32_32x32x16_bf16 v[104:119], v[200:203], a[24:27], v[104:119]
    ds_read_b64_tr_b16 a[8:9], v10 offset:20480
    ds_read_b64_tr_b16 a[10:11], v10 offset:21504
    buffer_load_dwordx4 v17, s[20:23], s43 offen offset:3072 lds
    v_accvgpr_write_b32 a56, v72
    v_mfma_f32_32x32x16_bf16 v[104:119], v[204:207], a[28:31], v[104:119]
    ds_read_b64_tr_b16 a[12:13], v10 offset:22528
    ds_read_b64_tr_b16 a[14:15], v10 offset:23552
    v_accvgpr_write_b32 a57, v73
    s_waitcnt vmcnt(20)
    s_barrier
    s_waitcnt lgkmcnt(4)
    v_mfma_f32_32x32x16_bf16 v[104:119], v[144:147], a[0:3], v[104:119]
    ds_read_b64_tr_b16 a[16:17], v11 offset:16384
    ds_read_b64_tr_b16 a[18:19], v11 offset:17408
    s_add_u32 m0, s38, 0
    s_add_u32 s43, s54, 256
    buffer_load_dwordx4 v14, s[20:23], s43 offen offset:0 lds
    v_accvgpr_write_b32 a58, v74
    v_mfma_f32_32x32x16_bf16 v[104:119], v[148:151], a[4:7], v[104:119]
    ds_read_b64_tr_b16 a[20:21], v11 offset:18432
    ds_read_b64_tr_b16 a[22:23], v11 offset:19456
    v_accvgpr_write_b32 a59, v75
    s_waitcnt lgkmcnt(4)
    v_mfma_f32_32x32x16_bf16 v[104:119], v[152:155], a[8:11], v[104:119]
    ds_read_b64_tr_b16 a[24:25], v11 offset:20480
    ds_read_b64_tr_b16 a[26:27], v11 offset:21504
    buffer_load_dwordx4 v15, s[20:23], s43 offen offset:1024 lds
    v_accvgpr_write_b32 a60, v76
    v_mfma_f32_32x32x16_bf16 v[104:119], v[156:159], a[12:15], v[104:119]
    ds_read_b64_tr_b16 a[28:29], v11 offset:22528
    ds_read_b64_tr_b16 a[30:31], v11 offset:23552
    v_accvgpr_write_b32 a61, v77
    s_waitcnt lgkmcnt(4)
    v_mfma_f32_32x32x16_bf16 v[104:119], v[208:211], a[16:19], v[104:119]
    ds_read_b64_tr_b16 a[0:1], v10 offset:32768
    ds_read_b64_tr_b16 a[2:3], v10 offset:33792
    buffer_load_dwordx4 v16, s[20:23], s43 offen offset:2048 lds
    v_accvgpr_write_b32 a62, v78
    v_mfma_f32_32x32x16_bf16 v[104:119], v[212:215], a[20:23], v[104:119]
    ds_read_b64_tr_b16 a[4:5], v10 offset:34816
    ds_read_b64_tr_b16 a[6:7], v10 offset:35840
    v_accvgpr_write_b32 a63, v79
    s_waitcnt lgkmcnt(4)
    v_mfma_f32_32x32x16_bf16 v[104:119], v[216:219], a[24:27], v[104:119]
    ds_read_b64_tr_b16 a[8:9], v10 offset:36864
    ds_read_b64_tr_b16 a[10:11], v10 offset:37888
    buffer_load_dwordx4 v17, s[20:23], s43 offen offset:3072 lds
    v_mfma_f32_32x32x16_bf16 v[104:119], v[220:223], a[28:31], v[104:119]
    ds_read_b64_tr_b16 a[12:13], v10 offset:38912
    ds_read_b64_tr_b16 a[14:15], v10 offset:39936
    s_waitcnt vmcnt(20)
    s_barrier
    s_waitcnt lgkmcnt(4)
    v_mfma_f32_32x32x16_bf16 v[104:119], v[160:163], a[0:3], v[104:119]
    ds_read_b64_tr_b16 a[16:17], v11 offset:32768
    ds_read_b64_tr_b16 a[18:19], v11 offset:33792
    s_add_u32 m0, s38, 16384
    s_add_u32 s43, s54, 57600
    buffer_load_dwordx4 v14, s[20:23], s43 offen offset:0 lds
    v_mfma_f32_32x32x16_bf16 v[104:119], v[164:167], a[4:7], v[104:119]
    ds_read_b64_tr_b16 a[20:21], v11 offset:34816
    ds_read_b64_tr_b16 a[22:23], v11 offset:35840
    s_waitcnt lgkmcnt(4)
    v_mfma_f32_32x32x16_bf16 v[104:119], v[168:171], a[8:11], v[104:119]
    ds_read_b64_tr_b16 a[24:25], v11 offset:36864
    ds_read_b64_tr_b16 a[26:27], v11 offset:37888
    buffer_load_dwordx4 v15, s[20:23], s43 offen offset:1024 lds
    v_mfma_f32_32x32x16_bf16 v[104:119], v[172:175], a[12:15], v[104:119]
    ds_read_b64_tr_b16 a[28:29], v11 offset:38912
    ds_read_b64_tr_b16 a[30:31], v11 offset:39936
    s_waitcnt lgkmcnt(4)
    v_mfma_f32_32x32x16_bf16 v[104:119], v[224:227], a[16:19], v[104:119]
    ds_read_b64_tr_b16 a[0:1], v10 offset:49152
    ds_read_b64_tr_b16 a[2:3], v10 offset:50176
    buffer_load_dwordx4 v16, s[20:23], s43 offen offset:2048 lds
    v_mfma_f32_32x32x16_bf16 v[104:119], v[228:231], a[20:23], v[104:119]
    ds_read_b64_tr_b16 a[4:5], v10 offset:51200
    ds_read_b64_tr_b16 a[6:7], v10 offset:52224
    s_waitcnt lgkmcnt(4)
    v_mfma_f32_32x32x16_bf16 v[104:119], v[232:235], a[24:27], v[104:119]
    ds_read_b64_tr_b16 a[8:9], v10 offset:53248
    ds_read_b64_tr_b16 a[10:11], v10 offset:54272
    buffer_load_dwordx4 v17, s[20:23], s43 offen offset:3072 lds
    v_mfma_f32_32x32x16_bf16 v[104:119], v[236:239], a[28:31], v[104:119]
    ds_read_b64_tr_b16 a[12:13], v10 offset:55296
    ds_read_b64_tr_b16 a[14:15], v10 offset:56320
    s_waitcnt vmcnt(20)
    s_barrier
    s_waitcnt lgkmcnt(4)
    v_mfma_f32_32x32x16_bf16 v[104:119], v[176:179], a[0:3], v[104:119]
    ds_read_b64_tr_b16 a[16:17], v11 offset:49152
    ds_read_b64_tr_b16 a[18:19], v11 offset:50176
    s_add_u32 m0, s38, 32768
    s_add_u32 s43, s54, 114944
    buffer_load_dwordx4 v14, s[20:23], s43 offen offset:0 lds
    v_mfma_f32_32x32x16_bf16 v[104:119], v[180:183], a[4:7], v[104:119]
    ds_read_b64_tr_b16 a[20:21], v11 offset:51200
    ds_read_b64_tr_b16 a[22:23], v11 offset:52224
    s_waitcnt lgkmcnt(4)
    v_mfma_f32_32x32x16_bf16 v[104:119], v[184:187], a[8:11], v[104:119]
    ds_read_b64_tr_b16 a[24:25], v11 offset:53248
    ds_read_b64_tr_b16 a[26:27], v11 offset:54272
    buffer_load_dwordx4 v15, s[20:23], s43 offen offset:1024 lds
    v_mfma_f32_32x32x16_bf16 v[104:119], v[188:191], a[12:15], v[104:119]
    ds_read_b64_tr_b16 a[28:29], v11 offset:55296
    ds_read_b64_tr_b16 a[30:31], v11 offset:56320
    s_waitcnt lgkmcnt(4)
    v_mfma_f32_32x32x16_bf16 v[104:119], v[240:243], a[16:19], v[104:119]
    v_xor_b32 v10, 65536, v10
    v_xor_b32 v11, 65536, v11
    ds_read_b64_tr_b16 a[0:1], v10 offset:0
    ds_read_b64_tr_b16 a[2:3], v10 offset:1024
    buffer_load_dwordx4 v16, s[20:23], s43 offen offset:2048 lds
    v_mfma_f32_32x32x16_bf16 v[104:119], v[244:247], a[20:23], v[104:119]
    ds_read_b64_tr_b16 a[4:5], v10 offset:2048
    ds_read_b64_tr_b16 a[6:7], v10 offset:3072
    s_waitcnt lgkmcnt(4)
    v_mfma_f32_32x32x16_bf16 v[104:119], v[248:251], a[24:27], v[104:119]
    ds_read_b64_tr_b16 a[8:9], v10 offset:4096
    ds_read_b64_tr_b16 a[10:11], v10 offset:5120
    buffer_load_dwordx4 v17, s[20:23], s43 offen offset:3072 lds
    v_mfma_f32_32x32x16_bf16 v[104:119], v[252:255], a[28:31], v[104:119]
    ds_read_b64_tr_b16 a[12:13], v10 offset:6144
    ds_read_b64_tr_b16 a[14:15], v10 offset:7168
    s_add_u32 s57, s57, 256
    s_add_u32 s54, s54, 128
    s_waitcnt vmcnt(20)
    s_barrier
    s_waitcnt lgkmcnt(4)
    v_mfma_f32_32x32x16_bf16 v[40:55], v[128:131], a[0:3], 0
    ds_read_b64_tr_b16 a[16:17], v11 offset:0
    ds_read_b64_tr_b16 a[18:19], v11 offset:1024
    s_add_u32 m0, s38, 49152
    s_add_u32 s43, s54, 172160
    buffer_load_dwordx4 v14, s[20:23], s43 offen offset:0 lds
    v_mfma_f32_32x32x16_bf16 v[40:55], v[132:135], a[4:7], v[40:55]
    ds_read_b64_tr_b16 a[20:21], v11 offset:2048
    ds_read_b64_tr_b16 a[22:23], v11 offset:3072
    s_waitcnt lgkmcnt(4)
    v_mfma_f32_32x32x16_bf16 v[40:55], v[136:139], a[8:11], v[40:55]
    ds_read_b64_tr_b16 a[24:25], v11 offset:4096
    ds_read_b64_tr_b16 a[26:27], v11 offset:5120
    buffer_load_dwordx4 v15, s[20:23], s43 offen offset:1024 lds
    v_cvt_pk_f16_f32 v72, v104, v105
    v_cvt_pk_f16_f32 v73, v106, v107
    v_mfma_f32_32x32x16_bf16 v[40:55], v[140:143], a[12:15], v[40:55]
    ds_read_b64_tr_b16 a[28:29], v11 offset:6144
    ds_read_b64_tr_b16 a[30:31], v11 offset:7168
    v_cvt_pk_f16_f32 v74, v108, v109
    v_cvt_pk_f16_f32 v75, v110, v111
    s_waitcnt lgkmcnt(4)
    v_mfma_f32_32x32x16_bf16 v[40:55], v[192:195], a[16:19], v[40:55]
    ds_read_b64_tr_b16 a[0:1], v10 offset:16384
    ds_read_b64_tr_b16 a[2:3], v10 offset:17408
    buffer_load_dwordx4 v16, s[20:23], s43 offen offset:2048 lds
    v_cvt_pk_f16_f32 v76, v112, v113
    v_cvt_pk_f16_f32 v77, v114, v115
    v_mfma_f32_32x32x16_bf16 v[40:55], v[196:199], a[20:23], v[40:55]
    ds_read_b64_tr_b16 a[4:5], v10 offset:18432
    ds_read_b64_tr_b16 a[6:7], v10 offset:19456
    v_cvt_pk_f16_f32 v78, v116, v117
    v_cvt_pk_f16_f32 v79, v118, v119
    s_waitcnt lgkmcnt(4)
    v_mfma_f32_32x32x16_bf16 v[40:55], v[200:203], a[24:27], v[40:55]
    ds_read_b64_tr_b16 a[8:9], v10 offset:20480
    ds_read_b64_tr_b16 a[10:11], v10 offset:21504
    buffer_load_dwordx4 v17, s[20:23], s43 offen offset:3072 lds
    v_mfma_f32_32x32x16_bf16 v[40:55], v[204:207], a[28:31], v[40:55]
    ds_read_b64_tr_b16 a[12:13], v10 offset:22528
    ds_read_b64_tr_b16 a[14:15], v10 offset:23552
    s_waitcnt vmcnt(20)
    s_barrier
    s_waitcnt lgkmcnt(4)
    v_mfma_f32_32x32x16_bf16 v[40:55], v[144:147], a[0:3], v[40:55]
    ds_read_b64_tr_b16 a[16:17], v11 offset:16384
    ds_read_b64_tr_b16 a[18:19], v11 offset:17408
    buffer_store_dword v72, v2, s[24:27], s57 offen offset:0 sc1
    v_mfma_f32_32x32x16_bf16 v[40:55], v[148:151], a[4:7], v[40:55]
    ds_read_b64_tr_b16 a[20:21], v11 offset:18432
    ds_read_b64_tr_b16 a[22:23], v11 offset:19456
    buffer_store_dword v73, v2, s[24:27], s57 offen offset:1792 sc1
    s_waitcnt lgkmcnt(4)
    v_mfma_f32_32x32x16_bf16 v[40:55], v[152:155], a[8:11], v[40:55]
    ds_read_b64_tr_b16 a[24:25], v11 offset:20480
    ds_read_b64_tr_b16 a[26:27], v11 offset:21504
    buffer_store_dword v74, v3, s[24:27], s57 offen offset:0 sc1
    v_mfma_f32_32x32x16_bf16 v[40:55], v[156:159], a[12:15], v[40:55]
    ds_read_b64_tr_b16 a[28:29], v11 offset:22528
    ds_read_b64_tr_b16 a[30:31], v11 offset:23552
    buffer_store_dword v75, v3, s[24:27], s57 offen offset:1792 sc1
    s_waitcnt lgkmcnt(4)
    v_mfma_f32_32x32x16_bf16 v[40:55], v[208:211], a[16:19], v[40:55]
    ds_read_b64_tr_b16 a[0:1], v10 offset:32768
    ds_read_b64_tr_b16 a[2:3], v10 offset:33792
    buffer_store_dword v76, v4, s[24:27], s57 offen offset:0 sc1
    v_mfma_f32_32x32x16_bf16 v[40:55], v[212:215], a[20:23], v[40:55]
    ds_read_b64_tr_b16 a[4:5], v10 offset:34816
    ds_read_b64_tr_b16 a[6:7], v10 offset:35840
    buffer_store_dword v77, v4, s[24:27], s57 offen offset:1792 sc1
    s_waitcnt lgkmcnt(4)
    v_mfma_f32_32x32x16_bf16 v[40:55], v[216:219], a[24:27], v[40:55]
    ds_read_b64_tr_b16 a[8:9], v10 offset:36864
    ds_read_b64_tr_b16 a[10:11], v10 offset:37888
    buffer_store_dword v78, v5, s[24:27], s57 offen offset:0 sc1
    v_mfma_f32_32x32x16_bf16 v[40:55], v[220:223], a[28:31], v[40:55]
    ds_read_b64_tr_b16 a[12:13], v10 offset:38912
    ds_read_b64_tr_b16 a[14:15], v10 offset:39936
    buffer_store_dword v79, v5, s[24:27], s57 offen offset:1792 sc1
    s_waitcnt vmcnt(24)
    s_barrier
    s_waitcnt lgkmcnt(4)
    v_mfma_f32_32x32x16_bf16 v[40:55], v[160:163], a[0:3], v[40:55]
    ds_read_b64_tr_b16 a[16:17], v11 offset:32768
    ds_read_b64_tr_b16 a[18:19], v11 offset:33792
    buffer_store_dword a32, v2, s[24:27], s90 offen offset:0 sc1
    v_mfma_f32_32x32x16_bf16 v[40:55], v[164:167], a[4:7], v[40:55]
    ds_read_b64_tr_b16 a[20:21], v11 offset:34816
    ds_read_b64_tr_b16 a[22:23], v11 offset:35840
    buffer_store_dword a33, v2, s[24:27], s90 offen offset:1792 sc1
    s_waitcnt lgkmcnt(4)
    v_mfma_f32_32x32x16_bf16 v[40:55], v[168:171], a[8:11], v[40:55]
    ds_read_b64_tr_b16 a[24:25], v11 offset:36864
    ds_read_b64_tr_b16 a[26:27], v11 offset:37888
    buffer_store_dword a34, v3, s[24:27], s90 offen offset:0 sc1
    v_mfma_f32_32x32x16_bf16 v[40:55], v[172:175], a[12:15], v[40:55]
    ds_read_b64_tr_b16 a[28:29], v11 offset:38912
    ds_read_b64_tr_b16 a[30:31], v11 offset:39936
    buffer_store_dword a35, v3, s[24:27], s90 offen offset:1792 sc1
    s_waitcnt lgkmcnt(4)
    v_mfma_f32_32x32x16_bf16 v[40:55], v[224:227], a[16:19], v[40:55]
    ds_read_b64_tr_b16 a[0:1], v10 offset:49152
    ds_read_b64_tr_b16 a[2:3], v10 offset:50176
    buffer_store_dword a36, v4, s[24:27], s90 offen offset:0 sc1
    v_mfma_f32_32x32x16_bf16 v[40:55], v[228:231], a[20:23], v[40:55]
    ds_read_b64_tr_b16 a[4:5], v10 offset:51200
    ds_read_b64_tr_b16 a[6:7], v10 offset:52224
    buffer_store_dword a37, v4, s[24:27], s90 offen offset:1792 sc1
    s_waitcnt lgkmcnt(4)
    v_mfma_f32_32x32x16_bf16 v[40:55], v[232:235], a[24:27], v[40:55]
    ds_read_b64_tr_b16 a[8:9], v10 offset:53248
    ds_read_b64_tr_b16 a[10:11], v10 offset:54272
    buffer_store_dword a38, v5, s[24:27], s90 offen offset:0 sc1
    v_mfma_f32_32x32x16_bf16 v[40:55], v[236:239], a[28:31], v[40:55]
    ds_read_b64_tr_b16 a[12:13], v10 offset:55296
    ds_read_b64_tr_b16 a[14:15], v10 offset:56320
    buffer_store_dword a39, v5, s[24:27], s90 offen offset:1792 sc1
    s_waitcnt vmcnt(28)
    s_barrier
    s_waitcnt lgkmcnt(4)
    v_mfma_f32_32x32x16_bf16 v[40:55], v[176:179], a[0:3], v[40:55]
    ds_read_b64_tr_b16 a[16:17], v11 offset:49152
    ds_read_b64_tr_b16 a[18:19], v11 offset:50176
    buffer_store_dword a40, v2, s[24:27], s91 offen offset:0 sc1
    v_mfma_f32_32x32x16_bf16 v[40:55], v[180:183], a[4:7], v[40:55]
    ds_read_b64_tr_b16 a[20:21], v11 offset:51200
    ds_read_b64_tr_b16 a[22:23], v11 offset:52224
    buffer_store_dword a41, v2, s[24:27], s91 offen offset:1792 sc1
    s_waitcnt lgkmcnt(4)
    v_mfma_f32_32x32x16_bf16 v[40:55], v[184:187], a[8:11], v[40:55]
    ds_read_b64_tr_b16 a[24:25], v11 offset:53248
    ds_read_b64_tr_b16 a[26:27], v11 offset:54272
    buffer_store_dword a42, v3, s[24:27], s91 offen offset:0 sc1
    v_mfma_f32_32x32x16_bf16 v[40:55], v[188:191], a[12:15], v[40:55]
    ds_read_b64_tr_b16 a[28:29], v11 offset:55296
    ds_read_b64_tr_b16 a[30:31], v11 offset:56320
    buffer_store_dword a43, v3, s[24:27], s91 offen offset:1792 sc1
    s_waitcnt lgkmcnt(4)
    v_mfma_f32_32x32x16_bf16 v[40:55], v[240:243], a[16:19], v[40:55]
    v_xor_b32 v10, 65536, v10
    v_xor_b32 v11, 65536, v11
    ds_read_b64_tr_b16 a[0:1], v10 offset:0
    ds_read_b64_tr_b16 a[2:3], v10 offset:1024
    buffer_store_dword a44, v4, s[24:27], s91 offen offset:0 sc1
    v_mfma_f32_32x32x16_bf16 v[40:55], v[244:247], a[20:23], v[40:55]
    ds_read_b64_tr_b16 a[4:5], v10 offset:2048
    ds_read_b64_tr_b16 a[6:7], v10 offset:3072
    buffer_store_dword a45, v4, s[24:27], s91 offen offset:1792 sc1
    s_waitcnt lgkmcnt(4)
    v_mfma_f32_32x32x16_bf16 v[40:55], v[248:251], a[24:27], v[40:55]
    ds_read_b64_tr_b16 a[8:9], v10 offset:4096
    ds_read_b64_tr_b16 a[10:11], v10 offset:5120
    buffer_store_dword a46, v5, s[24:27], s91 offen offset:0 sc1
    v_mfma_f32_32x32x16_bf16 v[40:55], v[252:255], a[28:31], v[40:55]
    ds_read_b64_tr_b16 a[12:13], v10 offset:6144
    ds_read_b64_tr_b16 a[14:15], v10 offset:7168
    buffer_store_dword a47, v5, s[24:27], s91 offen offset:1792 sc1
    s_add_u32 s57, s57, 256
    s_add_u32 s54, s54, 128
    s_waitcnt vmcnt(32)
    s_barrier
    s_waitcnt lgkmcnt(4)
    v_mfma_f32_32x32x16_bf16 v[104:119], v[128:131], a[0:3], 0
    ds_read_b64_tr_b16 a[16:17], v11 offset:0
    ds_read_b64_tr_b16 a[18:19], v11 offset:1024
    v_mfma_f32_32x32x16_bf16 v[104:119], v[132:135], a[4:7], v[104:119]
    ds_read_b64_tr_b16 a[20:21], v11 offset:2048
    ds_read_b64_tr_b16 a[22:23], v11 offset:3072
    s_waitcnt lgkmcnt(4)
    v_mfma_f32_32x32x16_bf16 v[104:119], v[136:139], a[8:11], v[104:119]
    ds_read_b64_tr_b16 a[24:25], v11 offset:4096
    ds_read_b64_tr_b16 a[26:27], v11 offset:5120
    v_cvt_pk_f16_f32 v72, v40, v41
    v_cvt_pk_f16_f32 v73, v42, v43
    v_mfma_f32_32x32x16_bf16 v[104:119], v[140:143], a[12:15], v[104:119]
    ds_read_b64_tr_b16 a[28:29], v11 offset:6144
    ds_read_b64_tr_b16 a[30:31], v11 offset:7168
    v_cvt_pk_f16_f32 v74, v44, v45
    v_cvt_pk_f16_f32 v75, v46, v47
    s_waitcnt lgkmcnt(4)
    v_mfma_f32_32x32x16_bf16 v[104:119], v[192:195], a[16:19], v[104:119]
    ds_read_b64_tr_b16 a[0:1], v10 offset:16384
    ds_read_b64_tr_b16 a[2:3], v10 offset:17408
    v_cvt_pk_f16_f32 v76, v48, v49
    v_cvt_pk_f16_f32 v77, v50, v51
    v_mfma_f32_32x32x16_bf16 v[104:119], v[196:199], a[20:23], v[104:119]
    ds_read_b64_tr_b16 a[4:5], v10 offset:18432
    ds_read_b64_tr_b16 a[6:7], v10 offset:19456
    v_cvt_pk_f16_f32 v78, v52, v53
    v_cvt_pk_f16_f32 v79, v54, v55
    s_waitcnt lgkmcnt(4)
    v_mfma_f32_32x32x16_bf16 v[104:119], v[200:203], a[24:27], v[104:119]
    ds_read_b64_tr_b16 a[8:9], v10 offset:20480
    ds_read_b64_tr_b16 a[10:11], v10 offset:21504
    buffer_store_dword v72, v2, s[24:27], s57 offen offset:0 sc1
    v_mfma_f32_32x32x16_bf16 v[104:119], v[204:207], a[28:31], v[104:119]
    ds_read_b64_tr_b16 a[12:13], v10 offset:22528
    ds_read_b64_tr_b16 a[14:15], v10 offset:23552
    buffer_store_dword v73, v2, s[24:27], s57 offen offset:1792 sc1
    s_waitcnt vmcnt(30)
    s_barrier
    s_waitcnt lgkmcnt(4)
    v_mfma_f32_32x32x16_bf16 v[104:119], v[144:147], a[0:3], v[104:119]
    ds_read_b64_tr_b16 a[16:17], v11 offset:16384
    ds_read_b64_tr_b16 a[18:19], v11 offset:17408
    buffer_store_dword v74, v3, s[24:27], s57 offen offset:0 sc1
    v_mfma_f32_32x32x16_bf16 v[104:119], v[148:151], a[4:7], v[104:119]
    ds_read_b64_tr_b16 a[20:21], v11 offset:18432
    ds_read_b64_tr_b16 a[22:23], v11 offset:19456
    buffer_store_dword v75, v3, s[24:27], s57 offen offset:1792 sc1
    s_waitcnt lgkmcnt(4)
    v_mfma_f32_32x32x16_bf16 v[104:119], v[152:155], a[8:11], v[104:119]
    ds_read_b64_tr_b16 a[24:25], v11 offset:20480
    ds_read_b64_tr_b16 a[26:27], v11 offset:21504
    buffer_store_dword v76, v4, s[24:27], s57 offen offset:0 sc1
    v_mfma_f32_32x32x16_bf16 v[104:119], v[156:159], a[12:15], v[104:119]
    ds_read_b64_tr_b16 a[28:29], v11 offset:22528
    ds_read_b64_tr_b16 a[30:31], v11 offset:23552
    buffer_store_dword v77, v4, s[24:27], s57 offen offset:1792 sc1
    s_waitcnt lgkmcnt(4)
    v_mfma_f32_32x32x16_bf16 v[104:119], v[208:211], a[16:19], v[104:119]
    ds_read_b64_tr_b16 a[0:1], v10 offset:32768
    ds_read_b64_tr_b16 a[2:3], v10 offset:33792
    buffer_store_dword v78, v5, s[24:27], s57 offen offset:0 sc1
    v_mfma_f32_32x32x16_bf16 v[104:119], v[212:215], a[20:23], v[104:119]
    ds_read_b64_tr_b16 a[4:5], v10 offset:34816
    ds_read_b64_tr_b16 a[6:7], v10 offset:35840
    buffer_store_dword v79, v5, s[24:27], s57 offen offset:1792 sc1
    s_waitcnt lgkmcnt(4)
    v_mfma_f32_32x32x16_bf16 v[104:119], v[216:219], a[24:27], v[104:119]
    ds_read_b64_tr_b16 a[8:9], v10 offset:36864
    ds_read_b64_tr_b16 a[10:11], v10 offset:37888
    buffer_store_dword a48, v2, s[24:27], s92 offen offset:0 sc1
    v_mfma_f32_32x32x16_bf16 v[104:119], v[220:223], a[28:31], v[104:119]
    ds_read_b64_tr_b16 a[12:13], v10 offset:38912
    ds_read_b64_tr_b16 a[14:15], v10 offset:39936
    buffer_store_dword a49, v2, s[24:27], s92 offen offset:1792 sc1
    s_waitcnt vmcnt(34)
    s_barrier
    s_waitcnt lgkmcnt(4)
    v_mfma_f32_32x32x16_bf16 v[104:119], v[160:163], a[0:3], v[104:119]
    ds_read_b64_tr_b16 a[16:17], v11 offset:32768
    ds_read_b64_tr_b16 a[18:19], v11 offset:33792
    buffer_store_dword a50, v3, s[24:27], s92 offen offset:0 sc1
    v_mfma_f32_32x32x16_bf16 v[104:119], v[164:167], a[4:7], v[104:119]
    ds_read_b64_tr_b16 a[20:21], v11 offset:34816
    ds_read_b64_tr_b16 a[22:23], v11 offset:35840
    buffer_store_dword a51, v3, s[24:27], s92 offen offset:1792 sc1
    s_waitcnt lgkmcnt(4)
    v_mfma_f32_32x32x16_bf16 v[104:119], v[168:171], a[8:11], v[104:119]
    ds_read_b64_tr_b16 a[24:25], v11 offset:36864
    ds_read_b64_tr_b16 a[26:27], v11 offset:37888
    buffer_store_dword a52, v4, s[24:27], s92 offen offset:0 sc1
    v_mfma_f32_32x32x16_bf16 v[104:119], v[172:175], a[12:15], v[104:119]
    ds_read_b64_tr_b16 a[28:29], v11 offset:38912
    ds_read_b64_tr_b16 a[30:31], v11 offset:39936
    buffer_store_dword a53, v4, s[24:27], s92 offen offset:1792 sc1
    s_waitcnt lgkmcnt(4)
    v_mfma_f32_32x32x16_bf16 v[104:119], v[224:227], a[16:19], v[104:119]
    ds_read_b64_tr_b16 a[0:1], v10 offset:49152
    ds_read_b64_tr_b16 a[2:3], v10 offset:50176
    buffer_store_dword a54, v5, s[24:27], s92 offen offset:0 sc1
    v_mfma_f32_32x32x16_bf16 v[104:119], v[228:231], a[20:23], v[104:119]
    ds_read_b64_tr_b16 a[4:5], v10 offset:51200
    ds_read_b64_tr_b16 a[6:7], v10 offset:52224
    buffer_store_dword a55, v5, s[24:27], s92 offen offset:1792 sc1
    s_waitcnt lgkmcnt(4)
    v_mfma_f32_32x32x16_bf16 v[104:119], v[232:235], a[24:27], v[104:119]
    ds_read_b64_tr_b16 a[8:9], v10 offset:53248
    ds_read_b64_tr_b16 a[10:11], v10 offset:54272
    buffer_store_dword a56, v2, s[24:27], s93 offen offset:0 sc1
    v_mfma_f32_32x32x16_bf16 v[104:119], v[236:239], a[28:31], v[104:119]
    ds_read_b64_tr_b16 a[12:13], v10 offset:55296
    ds_read_b64_tr_b16 a[14:15], v10 offset:56320
    buffer_store_dword a57, v2, s[24:27], s93 offen offset:1792 sc1
    s_waitcnt lgkmcnt(4)
    v_mfma_f32_32x32x16_bf16 v[104:119], v[176:179], a[0:3], v[104:119]
    ds_read_b64_tr_b16 a[16:17], v11 offset:49152
    ds_read_b64_tr_b16 a[18:19], v11 offset:50176
    buffer_store_dword a58, v3, s[24:27], s93 offen offset:0 sc1
    v_mfma_f32_32x32x16_bf16 v[104:119], v[180:183], a[4:7], v[104:119]
    ds_read_b64_tr_b16 a[20:21], v11 offset:51200
    ds_read_b64_tr_b16 a[22:23], v11 offset:52224
    buffer_store_dword a59, v3, s[24:27], s93 offen offset:1792 sc1
    s_waitcnt lgkmcnt(4)
    v_mfma_f32_32x32x16_bf16 v[104:119], v[184:187], a[8:11], v[104:119]
    ds_read_b64_tr_b16 a[24:25], v11 offset:53248
    ds_read_b64_tr_b16 a[26:27], v11 offset:54272
    buffer_store_dword a60, v4, s[24:27], s93 offen offset:0 sc1
    v_mfma_f32_32x32x16_bf16 v[104:119], v[188:191], a[12:15], v[104:119]
    ds_read_b64_tr_b16 a[28:29], v11 offset:55296
    ds_read_b64_tr_b16 a[30:31], v11 offset:56320
    buffer_store_dword a61, v4, s[24:27], s93 offen offset:1792 sc1
    s_waitcnt lgkmcnt(4)
    v_mfma_f32_32x32x16_bf16 v[104:119], v[240:243], a[16:19], v[104:119]
    buffer_store_dword a62, v5, s[24:27], s93 offen offset:0 sc1
    v_mfma_f32_32x32x16_bf16 v[104:119], v[244:247], a[20:23], v[104:119]
    buffer_store_dword a63, v5, s[24:27], s93 offen offset:1792 sc1
    s_waitcnt lgkmcnt(0)
    v_mfma_f32_32x32x16_bf16 v[104:119], v[248:251], a[24:27], v[104:119]
    v_mfma_f32_32x32x16_bf16 v[104:119], v[252:255], a[28:31], v[104:119]
    s_add_u32 s57, s57, 256
    s_add_u32 s54, s54, 128
    s_nop 7
    s_nop 7
    v_cvt_pk_f16_f32 v72, v104, v105
    buffer_store_dword v72, v2, s[24:27], s57 offen offset:0 sc1
    v_cvt_pk_f16_f32 v73, v106, v107
    buffer_store_dword v73, v2, s[24:27], s57 offen offset:1792 sc1
    v_cvt_pk_f16_f32 v74, v108, v109
    buffer_store_dword v74, v3, s[24:27], s57 offen offset:0 sc1
    v_cvt_pk_f16_f32 v75, v110, v111
    buffer_store_dword v75, v3, s[24:27], s57 offen offset:1792 sc1
    v_cvt_pk_f16_f32 v76, v112, v113
    buffer_store_dword v76, v4, s[24:27], s57 offen offset:0 sc1
    v_cvt_pk_f16_f32 v77, v114, v115
    buffer_store_dword v77, v4, s[24:27], s57 offen offset:1792 sc1
    v_cvt_pk_f16_f32 v78, v116, v117
    buffer_store_dword v78, v5, s[24:27], s57 offen offset:0 sc1
    v_cvt_pk_f16_f32 v79, v118, v119
    buffer_store_dword v79, v5, s[24:27], s57 offen offset:1792 sc1
    s_lshl_b32 s38, s30, 10
    s_add_u32 s38, s38, 524288
    s_waitcnt lgkmcnt(0)
    s_barrier
    s_cmp_lg_u32 s28, 0
    s_cbranch_scc1 Lhi_30
    v_mov_b32 v126, 1
    v_mov_b32 v127, 0
    s_lshl_b32 s40, s29, 7
    s_add_u32 s40, s40, s38
    s_mov_b64 exec, 1
    buffer_store_dword v126, v127, s[24:27], s40 offen offset:4 sc1
    s_mov_b64 exec, -1
Lhi_30:
    s_load_dwordx4 s[44:47], s[0:1], 48
    s_load_dwordx2 s[48:49], s[0:1], 64
    s_load_dwordx2 s[50:51], s[0:1], 0
    s_load_dwordx2 s[52:53], s[0:1], 104
    s_load_dwordx2 s[54:55], s[0:1], 88
    v_and_b32 v1, 63, v0
    v_lshrrev_b32 v120, 5, v1
    v_bfe_u32 v121, v1, 2, 2
    v_and_b32 v122, 3, v1
    v_bfe_u32 v123, v1, 4, 1
    v_and_b32 v124, 31, v1
    v_lshrrev_b32 v126, 3, v1
    v_bfe_u32 v127, v126, 1, 1
    v_lshlrev_b32 v127, 2, v127
    v_and_b32 v125, 7, v1
    v_xor_b32 v125, v125, v127
    v_lshlrev_b32 v125, 4, v125
    v_mul_u32_u24 v127, 3584, v126
    v_add_u32 v112, v125, v127
    v_add_u32 v113, 27648, v112
    v_mul_u32_u24 v127, 896, v126
    v_add_u32 v116, v125, v127
    s_mul_i32 s79, s29, 448
    s_and_b32 s42, s29, 1
    s_lshl_b32 s41, s42, 6
    s_add_u32 s35, s79, s41
    s_mul_i32 s43, s28, 57344
    s_add_u32 s34, s35, s43
    s_mul_i32 s41, s42, 448
    s_add_u32 s77, s34, 384
    s_sub_u32 s77, s77, s41
    s_lshl_b32 s33, s28, 11
    s_lshl_b32 s37, s28, 10
    s_mul_i32 s36, s29, 224
    s_lshl_b32 s43, s28, 3
    s_add_u32 s36, s36, s43
    s_mul_i32 s36, s36, 896
    s_mul_i32 s41, s42, 172032
    s_add_u32 s78, s36, 172032
    s_sub_u32 s78, s78, s41
    s_mul_i32 s41, s42, 28672
    s_add_u32 s36, s36, s41
    s_mov_b32 s56, 0
    s_mov_b32 s72, 0xf0f00f0f
    s_mov_b32 s73, 0xf0f00f0f
    v_lshrrev_b32 v2, 6, v0
    s_lshl_b32 s3, s2, 2
    v_add_u32 v2, s3, v2
    v_mul_u32_u24 v3, 1792, v2
    v_lshlrev_b32 v4, 4, v1
    v_lshl_add_u32 v5, v4, 1, v3
    v_add_u32 v3, v3, v4
    s_waitcnt lgkmcnt(0)
    s_mov_b32 s8, s44
    s_mov_b32 s9, s45
    s_mov_b32 s10, 1605632
    s_mov_b32 s11, 0x00020000
    s_mov_b32 s12, s46
    s_mov_b32 s13, s47
    s_mov_b32 s14, 1605632
    s_mov_b32 s15, 0x00020000
    s_mov_b32 s16, s48
    s_mov_b32 s17, s49
    s_mov_b32 s18, 1605632
    s_mov_b32 s19, 0x00020000
    s_mov_b32 s20, s50
    s_mov_b32 s21, s51
    s_mov_b32 s22, 1835008
    s_mov_b32 s23, 0x00020000
    s_mov_b32 s24, s52
    s_mov_b32 s25, s53
    s_mov_b32 s26, 67108864
    s_mov_b32 s27, 0x00020000
    s_mov_b32 s64, s54
    s_mov_b32 s65, s55
    s_mov_b32 s66, 1835008
    s_mov_b32 s67, 0x00020000
    s_mov_b32 s76, 557056
    v_lshrrev_b32 v36, 4, v2
    v_mul_u32_u24 v36, 28, v36
    v_lshrrev_b32 v37, 1, v1
    v_add_u32 v36, v36, v37
    v_lshlrev_b32 v36, 6, v36
    v_and_b32 v37, 1, v1
    v_lshlrev_b32 v37, 5, v37
    v_and_b32 v38, 15, v2
    v_lshlrev_b32 v38, 1, v38
    v_add3_u32 v60, v36, v37, v38
    v_lshlrev_b32 v60, 4, v60
    s_cmp_eq_u32 s28, 0
    s_cbranch_scc1 Lw0_33
    v_lshrrev_b32 v126, 2, v1
    v_mul_u32_u24 v126, 3584, v126
    v_and_b32 v127, 3, v1
    v_lshl_add_u32 v126, v127, 7, v126
    s_mul_i32 s40, s30, 50176
    s_and_b32 s41, s79, 0xffffff80
    s_add_u32 s40, s40, s41
    v_lshlrev_b32 v127, 7, v1
    s_mul_i32 s41, s29, 200704
    s_mul_i32 s42, s30, 6272
    s_add_u32 s41, s41, s42
    s_mov_b32 exec_hi, 0x00ffffff
    s_cmp_eq_u32 s28, 2
    s_cbranch_scc1 Lq2_34
    s_cmp_eq_u32 s28, 3
    s_cbranch_scc1 Lq3_35
    buffer_load_dword v61, v126, s[8:11], s40 offen
    s_branch Lqj_36
Lq2_34:
    buffer_load_dword v61, v126, s[12:15], s40 offen
    s_branch Lqj_36
Lq3_35:
    s_mov_b32 exec_hi, 0x0001ffff
    buffer_load_dword v61, v127, s[16:19], s41 offen
Lqj_36:
    s_mov_b64 exec, -1
    s_add_u32 s43, s34, 0
    s_add_u32 m0, s33, 0
    s_nop 0
    buffer_load_dwordx4 v112, s[8:11], s43 offen offset:0 lds
    buffer_load_dwordx4 v113, s[8:11], s43 offen offset:1024 lds
    s_add_u32 m0, s33, 8192
    s_nop 0
    buffer_load_dwordx4 v112, s[12:15], s43 offen offset:0 lds
    buffer_load_dwordx4 v113, s[12:15], s43 offen offset:1024 lds
    s_add_u32 s43, s34, 128
    s_add_u32 m0, s33, 16384
    s_nop 0
    buffer_load_dwordx4 v112, s[8:11], s43 offen offset:0 lds
    buffer_load_dwordx4 v113, s[8:11], s43 offen offset:1024 lds
    s_add_u32 m0, s33, 24576
    s_nop 0
    buffer_load_dwordx4 v112, s[12:15], s43 offen offset:0 lds
    buffer_load_dwordx4 v113, s[12:15], s43 offen offset:1024 lds
    s_add_u32 s43, s34, 229376
    s_add_u32 m0, s33, 32768
    s_nop 0
    buffer_load_dwordx4 v112, s[8:11], s43 offen offset:0 lds
    buffer_load_dwordx4 v113, s[8:11], s43 offen offset:1024 lds
    s_add_u32 m0, s33, 40960
    s_nop 0
    buffer_load_dwordx4 v112, s[12:15], s43 offen offset:0 lds
    buffer_load_dwordx4 v113, s[12:15], s43 offen offset:1024 lds
    s_add_u32 s43, s34, 229504
    s_add_u32 m0, s33, 49152
    s_nop 0
    buffer_load_dwordx4 v112, s[8:11], s43 offen offset:0 lds
    buffer_load_dwordx4 v113, s[8:11], s43 offen offset:1024 lds
    s_add_u32 m0, s33, 57344
    s_nop 0
    buffer_load_dwordx4 v112, s[12:15], s43 offen offset:0 lds
    buffer_load_dwordx4 v113, s[12:15], s43 offen offset:1024 lds
    s_cmp_eq_u32 s28, 2
    s_cbranch_scc1 Lw2_37
    s_cmp_eq_u32 s28, 3
    s_cbranch_scc1 Lw3_38
    s_add_u32 s43, s35, 0
    s_add_u32 m0, s56, 0
    s_nop 0
    buffer_load_dwordx4 v112, s[8:11], s43 offen offset:0 lds
    buffer_load_dwordx4 v113, s[8:11], s43 offen offset:1024 lds
    s_add_u32 m0, s56, 8192
    s_nop 0
    buffer_load_dwordx4 v112, s[12:15], s43 offen offset:0 lds
    buffer_load_dwordx4 v113, s[12:15], s43 offen offset:1024 lds
    s_add_u32 s43, s35, 128
    s_add_u32 m0, s56, 16384
    s_nop 0
    buffer_load_dwordx4 v112, s[8:11], s43 offen offset:0 lds
    buffer_load_dwordx4 v113, s[8:11], s43 offen offset:1024 lds
    s_add_u32 m0, s56, 24576
    s_nop 0
    buffer_load_dwordx4 v112, s[12:15], s43 offen offset:0 lds
    buffer_load_dwordx4 v113, s[12:15], s43 offen offset:1024 lds
    s_add_u32 s43, s35, 688128
    s_add_u32 m0, s56, 98304
    s_nop 0
    buffer_load_dwordx4 v112, s[8:11], s43 offen offset:0 lds
    buffer_load_dwordx4 v113, s[8:11], s43 offen offset:1024 lds
    s_add_u32 m0, s56, 106496
    s_nop 0
    buffer_load_dwordx4 v112, s[12:15], s43 offen offset:0 lds
    buffer_load_dwordx4 v113, s[12:15], s43 offen offset:1024 lds
    s_add_u32 s43, s35, 688256
    s_add_u32 m0, s56, 114688
    s_nop 0
    buffer_load_dwordx4 v112, s[8:11], s43 offen offset:0 lds
    buffer_load_dwordx4 v113, s[8:11], s43 offen offset:1024 lds
    s_add_u32 m0, s56, 122880
    s_nop 0
    buffer_load_dwordx4 v112, s[12:15], s43 offen offset:0 lds
    buffer_load_dwordx4 v113, s[12:15], s43 offen offset:1024 lds
    s_branch Lwj_39
Lw2_37:
    s_add_u32 s43, s35, 229376
    s_add_u32 m0, s56, 32768
    s_nop 0
    buffer_load_dwordx4 v112, s[8:11], s43 offen offset:0 lds
    buffer_load_dwordx4 v113, s[8:11], s43 offen offset:1024 lds
    s_add_u32 m0, s56, 40960
    s_nop 0
    buffer_load_dwordx4 v112, s[12:15], s43 offen offset:0 lds
    buffer_load_dwordx4 v113, s[12:15], s43 offen offset:1024 lds
    s_add_u32 s43, s35, 229504
    s_add_u32 m0, s56, 49152
    s_nop 0
    buffer_load_dwordx4 v112, s[8:11], s43 offen offset:0 lds
    buffer_load_dwordx4 v113, s[8:11], s43 offen offset:1024 lds
    s_add_u32 m0, s56, 57344
    s_nop 0
    buffer_load_dwordx4 v112, s[12:15], s43 offen offset:0 lds
    buffer_load_dwordx4 v113, s[12:15], s43 offen offset:1024 lds
    s_add_u32 s43, s35, 917504
    s_add_u32 m0, s56, 131072
    s_nop 0
    buffer_load_dwordx4 v112, s[8:11], s43 offen offset:0 lds
    buffer_load_dwordx4 v113, s[8:11], s43 offen offset:1024 lds
    s_add_u32 m0, s56, 139264
    s_nop 0
    buffer_load_dwordx4 v112, s[12:15], s43 offen offset:0 lds
    buffer_load_dwordx4 v113, s[12:15], s43 offen offset:1024 lds
    s_add_u32 s43, s35, 917632
    s_add_u32 m0, s56, 147456
    s_nop 0
    buffer_load_dwordx4 v112, s[8:11], s43 offen offset:0 lds
    buffer_load_dwordx4 v113, s[8:11], s43 offen offset:1024 lds
    s_branch Lwj_39
Lw3_38:
    s_add_u32 s43, s35, 458752
    s_add_u32 m0, s56, 65536
    s_nop 0
    buffer_load_dwordx4 v112, s[8:11], s43 offen offset:0 lds
    buffer_load_dwordx4 v113, s[8:11], s43 offen offset:1024 lds
    s_add_u32 m0, s56, 73728
    s_nop 0
    buffer_load_dwordx4 v112, s[12:15], s43 offen offset:0 lds
    buffer_load_dwordx4 v113, s[12:15], s43 offen offset:1024 lds
    s_add_u32 s43, s35, 458880
    s_add_u32 m0, s56, 81920
    s_nop 0
    buffer_load_dwordx4 v112, s[8:11], s43 offen offset:0 lds
    buffer_load_dwordx4 v113, s[8:11], s43 offen offset:1024 lds
    s_add_u32 m0, s56, 90112
    s_nop 0
    buffer_load_dwordx4 v112, s[12:15], s43 offen offset:0 lds
    buffer_load_dwordx4 v113, s[12:15], s43 offen offset:1024 lds
Lwj_39:
    s_add_u32 s43, s34, 458752
    s_add_u32 m0, s33, 65536
    s_nop 0
    buffer_load_dwordx4 v112, s[8:11], s43 offen offset:0 lds
    buffer_load_dwordx4 v113, s[8:11], s43 offen offset:1024 lds
    s_add_u32 m0, s33, 73728
    s_nop 0
    buffer_load_dwordx4 v112, s[12:15], s43 offen offset:0 lds
    buffer_load_dwordx4 v113, s[12:15], s43 offen offset:1024 lds
    s_add_u32 s43, s34, 458880
    s_add_u32 m0, s33, 81920
    s_nop 0
    buffer_load_dwordx4 v112, s[8:11], s43 offen offset:0 lds
    buffer_load_dwordx4 v113, s[8:11], s43 offen offset:1024 lds
    s_add_u32 m0, s33, 90112
    s_nop 0
    buffer_load_dwordx4 v112, s[12:15], s43 offen offset:0 lds
    buffer_load_dwordx4 v113, s[12:15], s43 offen offset:1024 lds
    s_add_u32 s43, s34, 688128
    s_add_u32 m0, s33, 98304
    s_nop 0
    buffer_load_dwordx4 v112, s[8:11], s43 offen offset:0 lds
    buffer_load_dwordx4 v113, s[8:11], s43 offen offset:1024 lds
    s_add_u32 m0, s33, 106496
    s_nop 0
    buffer_load_dwordx4 v112, s[12:15], s43 offen offset:0 lds
    buffer_load_dwordx4 v113, s[12:15], s43 offen offset:1024 lds
    s_add_u32 s43, s34, 688256
    s_add_u32 m0, s33, 114688
    s_nop 0
    buffer_load_dwordx4 v112, s[8:11], s43 offen offset:0 lds
    buffer_load_dwordx4 v113, s[8:11], s43 offen offset:1024 lds
    s_add_u32 m0, s33, 122880
    s_nop 0
    buffer_load_dwordx4 v112, s[12:15], s43 offen offset:0 lds
    buffer_load_dwordx4 v113, s[12:15], s43 offen offset:1024 lds
    s_add_u32 s43, s34, 917504
    s_add_u32 m0, s33, 131072
    s_nop 0
    buffer_load_dwordx4 v112, s[8:11], s43 offen offset:0 lds
    buffer_load_dwordx4 v113, s[8:11], s43 offen offset:1024 lds
    s_add_u32 m0, s33, 139264
    s_nop 0
    buffer_load_dwordx4 v112, s[12:15], s43 offen offset:0 lds
    buffer_load_dwordx4 v113, s[12:15], s43 offen offset:1024 lds
    s_add_u32 s43, s34, 917632
    s_add_u32 m0, s33, 147456
    s_nop 0
    buffer_load_dwordx4 v112, s[8:11], s43 offen offset:0 lds
    buffer_load_dwordx4 v113, s[8:11], s43 offen offset:1024 lds
Lw0_33:
    v_mov_b32 v10, 0
    v_mov_b32 v11, 0
    v_mov_b32 v12, 0
    v_mov_b32 v13, 0
    v_mov_b32 v14, 0
    v_mov_b32 v15, 0
    v_mov_b32 v16, 0
    v_mov_b32 v17, 0
    v_mov_b32 v144, 0
    v_mov_b32 v145, 0
    v_mov_b32 v146, 0
    v_mov_b32 v147, 0
    v_mov_b32 v148, 0
    v_mov_b32 v149, 0
    v_mov_b32 v150, 0
    v_mov_b32 v151, 0
    v_cmp_gt_u32 vcc, 56, v1
    s_and_saveexec_b64 s[58:59], vcc
    buffer_load_dwordx4 v[20:23], v3, s[20:23], 0 offen
    buffer_load_dwordx4 v[52:55], v3, s[20:23], 0 offen offset:896
    s_mov_b64 exec, -1
    s_cmp_lg_u32 s28, 0
    s_cbranch_scc1 Lsy_31
    v_mov_b32 v126, 1
    v_and_b32 v127, 7, v1
    v_lshlrev_b32 v127, 7, v127
    v_bfe_u32 v125, v1, 3, 1
    v_xor_b32 v125, 1, v125
    v_lshl_add_u32 v127, v125, 2, v127
    s_mov_b32 exec_hi, 0xffffff
    s_mov_b32 s40, 0
    v_lshlrev_b32 v66, 3, v1
    buffer_load_dwordx2 v[68:69], v66, s[24:27], s76 offen sc1
    s_mov_b64 exec, 0xffff
    buffer_load_dword v125, v127, s[24:27], s38 offen sc1
    s_sleep 4
Lsp_32:
    buffer_load_dword v118, v127, s[24:27], s38 offen sc1
    s_waitcnt vmcnt(1)
    v_cmp_gt_u32 vcc, v126, v125
    s_nop 1
    s_and_b64 vcc, vcc, exec
    s_cbranch_scc0 Lsd_41
    buffer_load_dword v125, v127, s[24:27], s38 offen sc1
    s_waitcnt vmcnt(1)
    v_cmp_gt_u32 vcc, v126, v118
    s_nop 1
    s_and_b64 vcc, vcc, exec
    s_cbranch_scc0 Lsd_41
    s_add_u32 s40, s40, 1
    s_cmp_lt_u32 s40, 65536
    s_cbranch_scc1 Lsp_32
Lsd_41:
    s_mov_b32 exec_lo, -1
    s_mov_b32 exec_hi, 0xffffff
    v_min_u32 v68, v68, v69
    v_cmp_eq_u32 vcc, 0, v68
    s_nop 1
    s_cbranch_vccz Lsd2_42
Lsd3_43:
    buffer_load_dwordx2 v[68:69], v66, s[24:27], s76 offen sc1
    s_waitcnt vmcnt(0)
    v_min_u32 v68, v68, v69
    v_cmp_eq_u32 vcc, 0, v68
    s_add_u32 s40, s40, 1
    s_cmp_ge_u32 s40, 131072
    s_cbranch_scc1 Lsy_31
    s_cbranch_vccnz Lsd3_43
Lsd2_42:
Lsy_31:
    s_mov_b64 exec, -1
    s_barrier
    v_cmp_gt_u32 vcc, 56, v1
    s_and_saveexec_b64 s[58:59], vcc
    s_mov_b32 s40, 16777216
    buffer_load_dwordx4 v[160:163], v5, s[24:27], s40 offen
    buffer_load_dwordx4 v[164:167], v5, s[24:27], s40 offen offset:16
    s_mov_b32 s40, 18612224
    buffer_load_dwordx4 v[168:171], v5, s[24:27], s40 offen
    buffer_load_dwordx4 v[172:175], v5, s[24:27], s40 offen offset:16
    s_mov_b32 s40, 20447232
    buffer_load_dwordx4 v[176:179], v5, s[24:27], s40 offen
    buffer_load_dwordx4 v[180:183], v5, s[24:27], s40 offen offset:16
    s_mov_b32 s40, 22282240
    buffer_load_dwordx4 v[184:187], v5, s[24:27], s40 offen
    buffer_load_dwordx4 v[188:191], v5, s[24:27], s40 offen offset:16
    s_mov_b32 s40, 24117248
    buffer_load_dwordx4 v[192:195], v5, s[24:27], s40 offen
    buffer_load_dwordx4 v[196:199], v5, s[24:27], s40 offen offset:16
    s_mov_b32 s40, 25952256
    buffer_load_dwordx4 v[200:203], v5, s[24:27], s40 offen
    buffer_load_dwordx4 v[204:207], v5, s[24:27], s40 offen offset:16
    s_mov_b32 s40, 27787264
    buffer_load_dwordx4 v[208:211], v5, s[24:27], s40 offen
    buffer_load_dwordx4 v[212:215], v5, s[24:27], s40 offen offset:16
    s_mov_b32 s40, 29622272
    buffer_load_dwordx4 v[216:219], v5, s[24:27], s40 offen
    buffer_load_dwordx4 v[220:223], v5, s[24:27], s40 offen offset:16
    buffer_load_dwordx4 v[48:51], v4, s[24:27], 0 offen offset:1792 sc1
    buffer_load_dwordx4 v[40:43], v4, s[24:27], 0 offen offset:2688 sc1
    buffer_load_dwordx4 v[44:47], v4, s[24:27], 0 offen offset:3584 sc1
    s_mov_b32 s40, 4480
    buffer_load_dwordx4 a[244:247], v4, s[24:27], s40 offen sc1
    s_mov_b32 s57, 0
Llr_44:
    s_waitcnt vmcnt(18)
    v_fma_mix_f32 v128, v160, 1.0, 0 op_sel:[0,0,0] op_sel_hi:[1,0,0]
    v_fma_mix_f32 v136, v160, 1.0, 0 op_sel:[1,0,0] op_sel_hi:[1,0,0]
    v_fma_mix_f32 v129, v161, 1.0, 0 op_sel:[0,0,0] op_sel_hi:[1,0,0]
    v_fma_mix_f32 v137, v161, 1.0, 0 op_sel:[1,0,0] op_sel_hi:[1,0,0]
    v_fma_mix_f32 v130, v162, 1.0, 0 op_sel:[0,0,0] op_sel_hi:[1,0,0]
    v_fma_mix_f32 v138, v162, 1.0, 0 op_sel:[1,0,0] op_sel_hi:[1,0,0]
    v_fma_mix_f32 v131, v163, 1.0, 0 op_sel:[0,0,0] op_sel_hi:[1,0,0]
    v_fma_mix_f32 v139, v163, 1.0, 0 op_sel:[1,0,0] op_sel_hi:[1,0,0]
    v_fma_mix_f32 v132, v164, 1.0, 0 op_sel:[0,0,0] op_sel_hi:[1,0,0]
    v_fma_mix_f32 v140, v164, 1.0, 0 op_sel:[1,0,0] op_sel_hi:[1,0,0]
    v_fma_mix_f32 v133, v165, 1.0, 0 op_sel:[0,0,0] op_sel_hi:[1,0,0]
    v_fma_mix_f32 v141, v165, 1.0, 0 op_sel:[1,0,0] op_sel_hi:[1,0,0]
    v_fma_mix_f32 v134, v166, 1.0, 0 op_sel:[0,0,0] op_sel_hi:[1,0,0]
    v_fma_mix_f32 v142, v166, 1.0, 0 op_sel:[1,0,0] op_sel_hi:[1,0,0]
    v_fma_mix_f32 v135, v167, 1.0, 0 op_sel:[0,0,0] op_sel_hi:[1,0,0]
    v_fma_mix_f32 v143, v167, 1.0, 0 op_sel:[1,0,0] op_sel_hi:[1,0,0]
    s_waitcnt vmcnt(16)
    v_fma_mix_f32 v128, v168, 1.0, v128 op_sel:[0,0,0] op_sel_hi:[1,0,0]
    v_fma_mix_f32 v136, v168, 1.0, v136 op_sel:[1,0,0] op_sel_hi:[1,0,0]
    v_fma_mix_f32 v129, v169, 1.0, v129 op_sel:[0,0,0] op_sel_hi:[1,0,0]
    v_fma_mix_f32 v137, v169, 1.0, v137 op_sel:[1,0,0] op_sel_hi:[1,0,0]
    v_fma_mix_f32 v130, v170, 1.0, v130 op_sel:[0,0,0] op_sel_hi:[1,0,0]
    v_fma_mix_f32 v138, v170, 1.0, v138 op_sel:[1,0,0] op_sel_hi:[1,0,0]
    v_fma_mix_f32 v131, v171, 1.0, v131 op_sel:[0,0,0] op_sel_hi:[1,0,0]
    v_fma_mix_f32 v139, v171, 1.0, v139 op_sel:[1,0,0] op_sel_hi:[1,0,0]
    v_fma_mix_f32 v132, v172, 1.0, v132 op_sel:[0,0,0] op_sel_hi:[1,0,0]
    v_fma_mix_f32 v140, v172, 1.0, v140 op_sel:[1,0,0] op_sel_hi:[1,0,0]
    v_fma_mix_f32 v133, v173, 1.0, v133 op_sel:[0,0,0] op_sel_hi:[1,0,0]
    v_fma_mix_f32 v141, v173, 1.0, v141 op_sel:[1,0,0] op_sel_hi:[1,0,0]
    v_fma_mix_f32 v134, v174, 1.0, v134 op_sel:[0,0,0] op_sel_hi:[1,0,0]
    v_fma_mix_f32 v142, v174, 1.0, v142 op_sel:[1,0,0] op_sel_hi:[1,0,0]
    v_fma_mix_f32 v135, v175, 1.0, v135 op_sel:[0,0,0] op_sel_hi:[1,0,0]
    v_fma_mix_f32 v143, v175, 1.0, v143 op_sel:[1,0,0] op_sel_hi:[1,0,0]
    s_waitcnt vmcnt(14)
    v_fma_mix_f32 v128, v176, 1.0, v128 op_sel:[0,0,0] op_sel_hi:[1,0,0]
    v_fma_mix_f32 v136, v176, 1.0, v136 op_sel:[1,0,0] op_sel_hi:[1,0,0]
    v_fma_mix_f32 v129, v177, 1.0, v129 op_sel:[0,0,0] op_sel_hi:[1,0,0]
    v_fma_mix_f32 v137, v177, 1.0, v137 op_sel:[1,0,0] op_sel_hi:[1,0,0]
    v_fma_mix_f32 v130, v178, 1.0, v130 op_sel:[0,0,0] op_sel_hi:[1,0,0]
    v_fma_mix_f32 v138, v178, 1.0, v138 op_sel:[1,0,0] op_sel_hi:[1,0,0]
    v_fma_mix_f32 v131, v179, 1.0, v131 op_sel:[0,0,0] op_sel_hi:[1,0,0]
    v_fma_mix_f32 v139, v179, 1.0, v139 op_sel:[1,0,0] op_sel_hi:[1,0,0]
    v_fma_mix_f32 v132, v180, 1.0, v132 op_sel:[0,0,0] op_sel_hi:[1,0,0]
    v_fma_mix_f32 v140, v180, 1.0, v140 op_sel:[1,0,0] op_sel_hi:[1,0,0]
    v_fma_mix_f32 v133, v181, 1.0, v133 op_sel:[0,0,0] op_sel_hi:[1,0,0]
    v_fma_mix_f32 v141, v181, 1.0, v141 op_sel:[1,0,0] op_sel_hi:[1,0,0]
    v_fma_mix_f32 v134, v182, 1.0, v134 op_sel:[0,0,0] op_sel_hi:[1,0,0]
    v_fma_mix_f32 v142, v182, 1.0, v142 op_sel:[1,0,0] op_sel_hi:[1,0,0]
    v_fma_mix_f32 v135, v183, 1.0, v135 op_sel:[0,0,0] op_sel_hi:[1,0,0]
    v_fma_mix_f32 v143, v183, 1.0, v143 op_sel:[1,0,0] op_sel_hi:[1,0,0]
    s_waitcnt vmcnt(12)
    v_fma_mix_f32 v128, v184, 1.0, v128 op_sel:[0,0,0] op_sel_hi:[1,0,0]
    v_fma_mix_f32 v136, v184, 1.0, v136 op_sel:[1,0,0] op_sel_hi:[1,0,0]
    v_fma_mix_f32 v129, v185, 1.0, v129 op_sel:[0,0,0] op_sel_hi:[1,0,0]
    v_fma_mix_f32 v137, v185, 1.0, v137 op_sel:[1,0,0] op_sel_hi:[1,0,0]
    v_fma_mix_f32 v130, v186, 1.0, v130 op_sel:[0,0,0] op_sel_hi:[1,0,0]
    v_fma_mix_f32 v138, v186, 1.0, v138 op_sel:[1,0,0] op_sel_hi:[1,0,0]
    v_fma_mix_f32 v131, v187, 1.0, v131 op_sel:[0,0,0] op_sel_hi:[1,0,0]
    v_fma_mix_f32 v139, v187, 1.0, v139 op_sel:[1,0,0] op_sel_hi:[1,0,0]
    v_fma_mix_f32 v132, v188, 1.0, v132 op_sel:[0,0,0] op_sel_hi:[1,0,0]
    v_fma_mix_f32 v140, v188, 1.0, v140 op_sel:[1,0,0] op_sel_hi:[1,0,0]
    v_fma_mix_f32 v133, v189, 1.0, v133 op_sel:[0,0,0] op_sel_hi:[1,0,0]
    v_fma_mix_f32 v141, v189, 1.0, v141 op_sel:[1,0,0] op_sel_hi:[1,0,0]
    v_fma_mix_f32 v134, v190, 1.0, v134 op_sel:[0,0,0] op_sel_hi:[1,0,0]
    v_fma_mix_f32 v142, v190, 1.0, v142 op_sel:[1,0,0] op_sel_hi:[1,0,0]
    v_fma_mix_f32 v135, v191, 1.0, v135 op_sel:[0,0,0] op_sel_hi:[1,0,0]
    v_fma_mix_f32 v143, v191, 1.0, v143 op_sel:[1,0,0] op_sel_hi:[1,0,0]
    s_waitcnt vmcnt(10)
    v_fma_mix_f32 v128, v192, 1.0, v128 op_sel:[0,0,0] op_sel_hi:[1,0,0]
    v_fma_mix_f32 v136, v192, 1.0, v136 op_sel:[1,0,0] op_sel_hi:[1,0,0]
    v_fma_mix_f32 v129, v193, 1.0, v129 op_sel:[0,0,0] op_sel_hi:[1,0,0]
    v_fma_mix_f32 v137, v193, 1.0, v137 op_sel:[1,0,0] op_sel_hi:[1,0,0]
    v_fma_mix_f32 v130, v194, 1.0, v130 op_sel:[0,0,0] op_sel_hi:[1,0,0]
    v_fma_mix_f32 v138, v194, 1.0, v138 op_sel:[1,0,0] op_sel_hi:[1,0,0]
    v_fma_mix_f32 v131, v195, 1.0, v131 op_sel:[0,0,0] op_sel_hi:[1,0,0]
    v_fma_mix_f32 v139, v195, 1.0, v139 op_sel:[1,0,0] op_sel_hi:[1,0,0]
    v_fma_mix_f32 v132, v196, 1.0, v132 op_sel:[0,0,0] op_sel_hi:[1,0,0]
    v_fma_mix_f32 v140, v196, 1.0, v140 op_sel:[1,0,0] op_sel_hi:[1,0,0]
    v_fma_mix_f32 v133, v197, 1.0, v133 op_sel:[0,0,0] op_sel_hi:[1,0,0]
    v_fma_mix_f32 v141, v197, 1.0, v141 op_sel:[1,0,0] op_sel_hi:[1,0,0]
    v_fma_mix_f32 v134, v198, 1.0, v134 op_sel:[0,0,0] op_sel_hi:[1,0,0]
    v_fma_mix_f32 v142, v198, 1.0, v142 op_sel:[1,0,0] op_sel_hi:[1,0,0]
    v_fma_mix_f32 v135, v199, 1.0, v135 op_sel:[0,0,0] op_sel_hi:[1,0,0]
    v_fma_mix_f32 v143, v199, 1.0, v143 op_sel:[1,0,0] op_sel_hi:[1,0,0]
    s_waitcnt vmcnt(8)
    v_fma_mix_f32 v128, v200, 1.0, v128 op_sel:[0,0,0] op_sel_hi:[1,0,0]
    v_fma_mix_f32 v136, v200, 1.0, v136 op_sel:[1,0,0] op_sel_hi:[1,0,0]
    v_fma_mix_f32 v129, v201, 1.0, v129 op_sel:[0,0,0] op_sel_hi:[1,0,0]
    v_fma_mix_f32 v137, v201, 1.0, v137 op_sel:[1,0,0] op_sel_hi:[1,0,0]
    v_fma_mix_f32 v130, v202, 1.0, v130 op_sel:[0,0,0] op_sel_hi:[1,0,0]
    v_fma_mix_f32 v138, v202, 1.0, v138 op_sel:[1,0,0] op_sel_hi:[1,0,0]
    v_fma_mix_f32 v131, v203, 1.0, v131 op_sel:[0,0,0] op_sel_hi:[1,0,0]
    v_fma_mix_f32 v139, v203, 1.0, v139 op_sel:[1,0,0] op_sel_hi:[1,0,0]
    v_fma_mix_f32 v132, v204, 1.0, v132 op_sel:[0,0,0] op_sel_hi:[1,0,0]
    v_fma_mix_f32 v140, v204, 1.0, v140 op_sel:[1,0,0] op_sel_hi:[1,0,0]
    v_fma_mix_f32 v133, v205, 1.0, v133 op_sel:[0,0,0] op_sel_hi:[1,0,0]
    v_fma_mix_f32 v141, v205, 1.0, v141 op_sel:[1,0,0] op_sel_hi:[1,0,0]
    v_fma_mix_f32 v134, v206, 1.0, v134 op_sel:[0,0,0] op_sel_hi:[1,0,0]
    v_fma_mix_f32 v142, v206, 1.0, v142 op_sel:[1,0,0] op_sel_hi:[1,0,0]
    v_fma_mix_f32 v135, v207, 1.0, v135 op_sel:[0,0,0] op_sel_hi:[1,0,0]
    v_fma_mix_f32 v143, v207, 1.0, v143 op_sel:[1,0,0] op_sel_hi:[1,0,0]
    s_waitcnt vmcnt(6)
    v_fma_mix_f32 v128, v208, 1.0, v128 op_sel:[0,0,0] op_sel_hi:[1,0,0]
    v_fma_mix_f32 v136, v208, 1.0, v136 op_sel:[1,0,0] op_sel_hi:[1,0,0]
    v_fma_mix_f32 v129, v209, 1.0, v129 op_sel:[0,0,0] op_sel_hi:[1,0,0]
    v_fma_mix_f32 v137, v209, 1.0, v137 op_sel:[1,0,0] op_sel_hi:[1,0,0]
    v_fma_mix_f32 v130, v210, 1.0, v130 op_sel:[0,0,0] op_sel_hi:[1,0,0]
    v_fma_mix_f32 v138, v210, 1.0, v138 op_sel:[1,0,0] op_sel_hi:[1,0,0]
    v_fma_mix_f32 v131, v211, 1.0, v131 op_sel:[0,0,0] op_sel_hi:[1,0,0]
    v_fma_mix_f32 v139, v211, 1.0, v139 op_sel:[1,0,0] op_sel_hi:[1,0,0]
    v_fma_mix_f32 v132, v212, 1.0, v132 op_sel:[0,0,0] op_sel_hi:[1,0,0]
    v_fma_mix_f32 v140, v212, 1.0, v140 op_sel:[1,0,0] op_sel_hi:[1,0,0]
    v_fma_mix_f32 v133, v213, 1.0, v133 op_sel:[0,0,0] op_sel_hi:[1,0,0]
    v_fma_mix_f32 v141, v213, 1.0, v141 op_sel:[1,0,0] op_sel_hi:[1,0,0]
    v_fma_mix_f32 v134, v214, 1.0, v134 op_sel:[0,0,0] op_sel_hi:[1,0,0]
    v_fma_mix_f32 v142, v214, 1.0, v142 op_sel:[1,0,0] op_sel_hi:[1,0,0]
    v_fma_mix_f32 v135, v215, 1.0, v135 op_sel:[0,0,0] op_sel_hi:[1,0,0]
    v_fma_mix_f32 v143, v215, 1.0, v143 op_sel:[1,0,0] op_sel_hi:[1,0,0]
    s_waitcnt vmcnt(4)
    v_fma_mix_f32 v128, v216, 1.0, v128 op_sel:[0,0,0] op_sel_hi:[1,0,0]
    v_fma_mix_f32 v136, v216, 1.0, v136 op_sel:[1,0,0] op_sel_hi:[1,0,0]
    v_fma_mix_f32 v129, v217, 1.0, v129 op_sel:[0,0,0] op_sel_hi:[1,0,0]
    v_fma_mix_f32 v137, v217, 1.0, v137 op_sel:[1,0,0] op_sel_hi:[1,0,0]
    v_fma_mix_f32 v130, v218, 1.0, v130 op_sel:[0,0,0] op_sel_hi:[1,0,0]
    v_fma_mix_f32 v138, v218, 1.0, v138 op_sel:[1,0,0] op_sel_hi:[1,0,0]
    v_fma_mix_f32 v131, v219, 1.0, v131 op_sel:[0,0,0] op_sel_hi:[1,0,0]
    v_fma_mix_f32 v139, v219, 1.0, v139 op_sel:[1,0,0] op_sel_hi:[1,0,0]
    v_fma_mix_f32 v132, v220, 1.0, v132 op_sel:[0,0,0] op_sel_hi:[1,0,0]
    v_fma_mix_f32 v140, v220, 1.0, v140 op_sel:[1,0,0] op_sel_hi:[1,0,0]
    v_fma_mix_f32 v133, v221, 1.0, v133 op_sel:[0,0,0] op_sel_hi:[1,0,0]
    v_fma_mix_f32 v141, v221, 1.0, v141 op_sel:[1,0,0] op_sel_hi:[1,0,0]
    v_fma_mix_f32 v134, v222, 1.0, v134 op_sel:[0,0,0] op_sel_hi:[1,0,0]
    v_fma_mix_f32 v142, v222, 1.0, v142 op_sel:[1,0,0] op_sel_hi:[1,0,0]
    v_fma_mix_f32 v135, v223, 1.0, v135 op_sel:[0,0,0] op_sel_hi:[1,0,0]
    v_fma_mix_f32 v143, v223, 1.0, v143 op_sel:[1,0,0] op_sel_hi:[1,0,0]
    v_add_f32 v24, v128, v129
    v_add_f32 v28, v136, v137
    v_add_f32 v25, v130, v131
    v_add_f32 v29, v138, v139
    v_add_f32 v26, v132, v133
    v_add_f32 v30, v140, v141
    v_add_f32 v27, v134, v135
    v_add_f32 v31, v142, v143
    v_add_f32 v24, v24, v28
    v_add_f32 v25, v25, v29
    v_add_f32 v26, v26, v30
    v_add_f32 v27, v27, v31
    v_add_f32 v24, v24, v25
    v_add_f32 v26, v26, v27
    v_cmp_u_f32 vcc, v24, v26
    s_nop 1
    s_cbranch_vccnz Lls_45
Llc_46:
    s_waitcnt vmcnt(3)
    v_lshlrev_b32 v10, 16, v20
    v_and_b32 v11, 0xffff0000, v20
    v_lshlrev_b32 v12, 16, v21
    v_and_b32 v13, 0xffff0000, v21
    v_lshlrev_b32 v14, 16, v22
    v_and_b32 v15, 0xffff0000, v22
    v_lshlrev_b32 v16, 16, v23
    v_and_b32 v17, 0xffff0000, v23
    v_lshlrev_b32 v144, 16, v52
    v_and_b32 v145, 0xffff0000, v52
    v_lshlrev_b32 v146, 16, v53
    v_and_b32 v147, 0xffff0000, v53
    v_lshlrev_b32 v148, 16, v54
    v_and_b32 v149, 0xffff0000, v54
    v_lshlrev_b32 v150, 16, v55
    v_and_b32 v151, 0xffff0000, v55
    v_lshlrev_b32 v34, 16, v48
    v_and_b32 v35, 0xffff0000, v48
    v_cvt_pk_bf16_f32 v128, 0, v128
    v_cvt_pk_bf16_f32 v129, 0, v129
    v_mul_f32 v128, v128, v34
    v_mul_f32 v129, v129, v35
    v_cvt_pk_bf16_f32 v128, 0, v128
    v_cvt_pk_bf16_f32 v129, 0, v129
    v_add_f32 v10, v10, v128
    v_add_f32 v11, v11, v129
    v_cvt_pk_bf16_f32 v20, v10, v11
    v_lshlrev_b32 v10, 16, v20
    v_and_b32 v11, 0xffff0000, v20
    v_cvt_pk_bf16_f32 v136, 0, v136
    v_cvt_pk_bf16_f32 v137, 0, v137
    v_mul_f32 v136, v136, v34
    v_mul_f32 v137, v137, v35
    v_cvt_pk_bf16_f32 v136, 0, v136
    v_cvt_pk_bf16_f32 v137, 0, v137
    v_add_f32 v144, v144, v136
    v_add_f32 v145, v145, v137
    v_cvt_pk_bf16_f32 v52, v144, v145
    v_lshlrev_b32 v144, 16, v52
    v_and_b32 v145, 0xffff0000, v52
    v_lshlrev_b32 v34, 16, v49
    v_and_b32 v35, 0xffff0000, v49
    v_cvt_pk_bf16_f32 v130, 0, v130
    v_cvt_pk_bf16_f32 v131, 0, v131
    v_mul_f32 v130, v130, v34
    v_mul_f32 v131, v131, v35
    v_cvt_pk_bf16_f32 v130, 0, v130
    v_cvt_pk_bf16_f32 v131, 0, v131
    v_add_f32 v12, v12, v130
    v_add_f32 v13, v13, v131
    v_cvt_pk_bf16_f32 v21, v12, v13
    v_lshlrev_b32 v12, 16, v21
    v_and_b32 v13, 0xffff0000, v21
    v_cvt_pk_bf16_f32 v138, 0, v138
    v_cvt_pk_bf16_f32 v139, 0, v139
    v_mul_f32 v138, v138, v34
    v_mul_f32 v139, v139, v35
    v_cvt_pk_bf16_f32 v138, 0, v138
    v_cvt_pk_bf16_f32 v139, 0, v139
    v_add_f32 v146, v146, v138
    v_add_f32 v147, v147, v139
    v_cvt_pk_bf16_f32 v53, v146, v147
    v_lshlrev_b32 v146, 16, v53
    v_and_b32 v147, 0xffff0000, v53
    v_lshlrev_b32 v34, 16, v50
    v_and_b32 v35, 0xffff0000, v50
    v_cvt_pk_bf16_f32 v132, 0, v132
    v_cvt_pk_bf16_f32 v133, 0, v133
    v_mul_f32 v132, v132, v34
    v_mul_f32 v133, v133, v35
    v_cvt_pk_bf16_f32 v132, 0, v132
    v_cvt_pk_bf16_f32 v133, 0, v133
    v_add_f32 v14, v14, v132
    v_add_f32 v15, v15, v133
    v_cvt_pk_bf16_f32 v22, v14, v15
    v_lshlrev_b32 v14, 16, v22
    v_and_b32 v15, 0xffff0000, v22
    v_cvt_pk_bf16_f32 v140, 0, v140
    v_cvt_pk_bf16_f32 v141, 0, v141
    v_mul_f32 v140, v140, v34
    v_mul_f32 v141, v141, v35
    v_cvt_pk_bf16_f32 v140, 0, v140
    v_cvt_pk_bf16_f32 v141, 0, v141
    v_add_f32 v148, v148, v140
    v_add_f32 v149, v149, v141
    v_cvt_pk_bf16_f32 v54, v148, v149
    v_lshlrev_b32 v148, 16, v54
    v_and_b32 v149, 0xffff0000, v54
    v_lshlrev_b32 v34, 16, v51
    v_and_b32 v35, 0xffff0000, v51
    v_cvt_pk_bf16_f32 v134, 0, v134
    v_cvt_pk_bf16_f32 v135, 0, v135
    v_mul_f32 v134, v134, v34
    v_mul_f32 v135, v135, v35
    v_cvt_pk_bf16_f32 v134, 0, v134
    v_cvt_pk_bf16_f32 v135, 0, v135
    v_add_f32 v16, v16, v134
    v_add_f32 v17, v17, v135
    v_cvt_pk_bf16_f32 v23, v16, v17
    v_lshlrev_b32 v16, 16, v23
    v_and_b32 v17, 0xffff0000, v23
    v_cvt_pk_bf16_f32 v142, 0, v142
    v_cvt_pk_bf16_f32 v143, 0, v143
    v_mul_f32 v142, v142, v34
    v_mul_f32 v143, v143, v35
    v_cvt_pk_bf16_f32 v142, 0, v142
    v_cvt_pk_bf16_f32 v143, 0, v143
    v_add_f32 v150, v150, v142
    v_add_f32 v151, v151, v143
    v_cvt_pk_bf16_f32 v55, v150, v151
    v_lshlrev_b32 v150, 16, v55
    v_and_b32 v151, 0xffff0000, v55
    v_accvgpr_write_b32 a248, v20
    v_accvgpr_write_b32 a252, v52
    v_accvgpr_write_b32 a249, v21
    v_accvgpr_write_b32 a253, v53
    v_accvgpr_write_b32 a250, v22
    v_accvgpr_write_b32 a254, v54
    v_accvgpr_write_b32 a251, v23
    v_accvgpr_write_b32 a255, v55
    s_mov_b64 exec, -1
    v_add_f32 v26, v10, v11
    v_add_f32 v152, v144, v145
    v_add_f32 v26, v26, v12
    v_add_f32 v152, v152, v146
    v_add_f32 v26, v26, v13
    v_add_f32 v152, v152, v147
    v_add_f32 v26, v26, v14
    v_add_f32 v152, v152, v148
    v_add_f32 v26, v26, v15
    v_add_f32 v152, v152, v149
    v_add_f32 v26, v26, v16
    v_add_f32 v152, v152, v150
    v_add_f32 v26, v26, v17
    v_add_f32 v152, v152, v151
    s_nop 1
    v_add_f32_dpp v26, v26, v26 row_shr:1 row_mask:0xf bank_mask:0xf bound_ctrl:0
    v_add_f32_dpp v152, v152, v152 row_shr:1 row_mask:0xf bank_mask:0xf bound_ctrl:0
    s_nop 1
    v_add_f32_dpp v26, v26, v26 row_shr:2 row_mask:0xf bank_mask:0xf bound_ctrl:0
    v_add_f32_dpp v152, v152, v152 row_shr:2 row_mask:0xf bank_mask:0xf bound_ctrl:0
    s_nop 1
    v_add_f32_dpp v26, v26, v26 row_shr:4 row_mask:0xf bank_mask:0xf bound_ctrl:0
    v_add_f32_dpp v152, v152, v152 row_shr:4 row_mask:0xf bank_mask:0xf bound_ctrl:0
    s_nop 1
    v_add_f32_dpp v26, v26, v26 row_shr:8 row_mask:0xf bank_mask:0xf bound_ctrl:0
    v_add_f32_dpp v152, v152, v152 row_shr:8 row_mask:0xf bank_mask:0xf bound_ctrl:0
    s_nop 1
    v_add_f32_dpp v26, v26, v26 row_bcast:15 row_mask:0xa bank_mask:0xf bound_ctrl:0
    v_add_f32_dpp v152, v152, v152 row_bcast:15 row_mask:0xa bank_mask:0xf bound_ctrl:0
    s_nop 1
    v_add_f32_dpp v26, v26, v26 row_bcast:31 row_mask:0xc bank_mask:0xf bound_ctrl:0
    v_add_f32_dpp v152, v152, v152 row_bcast:31 row_mask:0xc bank_mask:0xf bound_ctrl:0
    s_nop 1
    v_readlane_b32 s60, v26, 63
    v_readlane_b32 s61, v152, 63
    s_nop 3
    v_mov_b32 v33, 0x3b124925
    v_mul_f32 v26, s60, v33
    v_mov_b32 v28, 0
    v_mul_f32 v152, s61, v33
    v_mov_b32 v153, 0
    v_sub_f32 v29, v10, v26
    v_fmac_f32 v28, v29, v29
    v_sub_f32 v155, v144, v152
    v_fmac_f32 v153, v155, v155
    v_sub_f32 v29, v11, v26
    v_fmac_f32 v28, v29, v29
    v_sub_f32 v155, v145, v152
    v_fmac_f32 v153, v155, v155
    v_sub_f32 v29, v12, v26
    v_fmac_f32 v28, v29, v29
    v_sub_f32 v155, v146, v152
    v_fmac_f32 v153, v155, v155
    v_sub_f32 v29, v13, v26
    v_fmac_f32 v28, v29, v29
    v_sub_f32 v155, v147, v152
    v_fmac_f32 v153, v155, v155
    v_sub_f32 v29, v14, v26
    v_fmac_f32 v28, v29, v29
    v_sub_f32 v155, v148, v152
    v_fmac_f32 v153, v155, v155
    v_sub_f32 v29, v15, v26
    v_fmac_f32 v28, v29, v29
    v_sub_f32 v155, v149, v152
    v_fmac_f32 v153, v155, v155
    v_sub_f32 v29, v16, v26
    v_fmac_f32 v28, v29, v29
    v_sub_f32 v155, v150, v152
    v_fmac_f32 v153, v155, v155
    v_sub_f32 v29, v17, v26
    v_fmac_f32 v28, v29, v29
    v_sub_f32 v155, v151, v152
    v_fmac_f32 v153, v155, v155
    v_cmp_gt_u32 vcc, 56, v1
    s_nop 1
    v_cndmask_b32 v28, 0, v28, vcc
    v_cndmask_b32 v153, 0, v153, vcc
    s_nop 1
    v_add_f32_dpp v28, v28, v28 row_shr:1 row_mask:0xf bank_mask:0xf bound_ctrl:0
    v_add_f32_dpp v153, v153, v153 row_shr:1 row_mask:0xf bank_mask:0xf bound_ctrl:0
    s_nop 1
    v_add_f32_dpp v28, v28, v28 row_shr:2 row_mask:0xf bank_mask:0xf bound_ctrl:0
    v_add_f32_dpp v153, v153, v153 row_shr:2 row_mask:0xf bank_mask:0xf bound_ctrl:0
    s_nop 1
    v_add_f32_dpp v28, v28, v28 row_shr:4 row_mask:0xf bank_mask:0xf bound_ctrl:0
    v_add_f32_dpp v153, v153, v153 row_shr:4 row_mask:0xf bank_mask:0xf bound_ctrl:0
    s_nop 1
    v_add_f32_dpp v28, v28, v28 row_shr:8 row_mask:0xf bank_mask:0xf bound_ctrl:0
    v_add_f32_dpp v153, v153, v153 row_shr:8 row_mask:0xf bank_mask:0xf bound_ctrl:0
    s_nop 1
    v_add_f32_dpp v28, v28, v28 row_bcast:15 row_mask:0xa bank_mask:0xf bound_ctrl:0
    v_add_f32_dpp v153, v153, v153 row_bcast:15 row_mask:0xa bank_mask:0xf bound_ctrl:0
    s_nop 1
    v_add_f32_dpp v28, v28, v28 row_bcast:31 row_mask:0xc bank_mask:0xf bound_ctrl:0
    v_add_f32_dpp v153, v153, v153 row_bcast:31 row_mask:0xc bank_mask:0xf bound_ctrl:0
    s_nop 1
    v_readlane_b32 s60, v28, 63
    v_readlane_b32 s61, v153, 63
    s_nop 3
    v_mul_f32 v28, s60, v33
    v_cvt_pk_bf16_f32 v26, 0, v26
    v_cvt_pk_bf16_f32 v28, 0, v28
    v_add_f32 v28, 0x3727c5ac, v28
    v_cvt_pk_bf16_f32 v28, 0, v28
    v_sqrt_f32 v28, v28
    v_mul_f32 v153, s61, v33
    v_cvt_pk_bf16_f32 v152, 0, v152
    v_cvt_pk_bf16_f32 v153, 0, v153
    v_add_f32 v153, 0x3727c5ac, v153
    v_cvt_pk_bf16_f32 v153, 0, v153
    v_sqrt_f32 v153, v153
    s_nop 0
    v_cvt_pk_bf16_f32 v28, 0, v28
    v_cvt_pk_bf16_f32 v153, 0, v153
    v_rcp_f32 v28, v28
    v_rcp_f32 v153, v153
    s_waitcnt vmcnt(0)
    v_lshlrev_b32 v34, 16, v44
    v_and_b32 v35, 0xffff0000, v44
    v_add_f32 v34, 1.0, v34
    v_add_f32 v35, 1.0, v35
    v_cvt_pk_bf16_f32 v34, 0, v34
    v_cvt_pk_bf16_f32 v35, 0, v35
    v_lshlrev_b32 v36, 16, v40
    v_and_b32 v37, 0xffff0000, v40
    v_sub_f32 v10, v10, v26
    v_sub_f32 v11, v11, v26
    v_cvt_pk_bf16_f32 v10, 0, v10
    v_cvt_pk_bf16_f32 v11, 0, v11
    v_mul_f32 v10, v10, v28
    v_mul_f32 v11, v11, v28
    v_cvt_pk_bf16_f32 v10, 0, v10
    v_cvt_pk_bf16_f32 v11, 0, v11
    v_mul_f32 v10, v10, v34
    v_mul_f32 v11, v11, v35
    v_cvt_pk_bf16_f32 v10, 0, v10
    v_cvt_pk_bf16_f32 v11, 0, v11
    v_add_f32 v10, v10, v36
    v_add_f32 v11, v11, v37
    v_cvt_pk_bf16_f32 v128, v10, v11
    v_sub_f32 v144, v144, v152
    v_sub_f32 v145, v145, v152
    v_cvt_pk_bf16_f32 v144, 0, v144
    v_cvt_pk_bf16_f32 v145, 0, v145
    v_mul_f32 v144, v144, v153
    v_mul_f32 v145, v145, v153
    v_cvt_pk_bf16_f32 v144, 0, v144
    v_cvt_pk_bf16_f32 v145, 0, v145
    v_mul_f32 v144, v144, v34
    v_mul_f32 v145, v145, v35
    v_cvt_pk_bf16_f32 v144, 0, v144
    v_cvt_pk_bf16_f32 v145, 0, v145
    v_add_f32 v144, v144, v36
    v_add_f32 v145, v145, v37
    v_cvt_pk_bf16_f32 v136, v144, v145
    v_lshlrev_b32 v34, 16, v45
    v_and_b32 v35, 0xffff0000, v45
    v_add_f32 v34, 1.0, v34
    v_add_f32 v35, 1.0, v35
    v_cvt_pk_bf16_f32 v34, 0, v34
    v_cvt_pk_bf16_f32 v35, 0, v35
    v_lshlrev_b32 v36, 16, v41
    v_and_b32 v37, 0xffff0000, v41
    v_sub_f32 v12, v12, v26
    v_sub_f32 v13, v13, v26
    v_cvt_pk_bf16_f32 v12, 0, v12
    v_cvt_pk_bf16_f32 v13, 0, v13
    v_mul_f32 v12, v12, v28
    v_mul_f32 v13, v13, v28
    v_cvt_pk_bf16_f32 v12, 0, v12
    v_cvt_pk_bf16_f32 v13, 0, v13
    v_mul_f32 v12, v12, v34
    v_mul_f32 v13, v13, v35
    v_cvt_pk_bf16_f32 v12, 0, v12
    v_cvt_pk_bf16_f32 v13, 0, v13
    v_add_f32 v12, v12, v36
    v_add_f32 v13, v13, v37
    v_cvt_pk_bf16_f32 v129, v12, v13
    v_sub_f32 v146, v146, v152
    v_sub_f32 v147, v147, v152
    v_cvt_pk_bf16_f32 v146, 0, v146
    v_cvt_pk_bf16_f32 v147, 0, v147
    v_mul_f32 v146, v146, v153
    v_mul_f32 v147, v147, v153
    v_cvt_pk_bf16_f32 v146, 0, v146
    v_cvt_pk_bf16_f32 v147, 0, v147
    v_mul_f32 v146, v146, v34
    v_mul_f32 v147, v147, v35
    v_cvt_pk_bf16_f32 v146, 0, v146
    v_cvt_pk_bf16_f32 v147, 0, v147
    v_add_f32 v146, v146, v36
    v_add_f32 v147, v147, v37
    v_cvt_pk_bf16_f32 v137, v146, v147
    v_lshlrev_b32 v34, 16, v46
    v_and_b32 v35, 0xffff0000, v46
    v_add_f32 v34, 1.0, v34
    v_add_f32 v35, 1.0, v35
    v_cvt_pk_bf16_f32 v34, 0, v34
    v_cvt_pk_bf16_f32 v35, 0, v35
    v_lshlrev_b32 v36, 16, v42
    v_and_b32 v37, 0xffff0000, v42
    v_sub_f32 v14, v14, v26
    v_sub_f32 v15, v15, v26
    v_cvt_pk_bf16_f32 v14, 0, v14
    v_cvt_pk_bf16_f32 v15, 0, v15
    v_mul_f32 v14, v14, v28
    v_mul_f32 v15, v15, v28
    v_cvt_pk_bf16_f32 v14, 0, v14
    v_cvt_pk_bf16_f32 v15, 0, v15
    v_mul_f32 v14, v14, v34
    v_mul_f32 v15, v15, v35
    v_cvt_pk_bf16_f32 v14, 0, v14
    v_cvt_pk_bf16_f32 v15, 0, v15
    v_add_f32 v14, v14, v36
    v_add_f32 v15, v15, v37
    v_cvt_pk_bf16_f32 v130, v14, v15
    v_sub_f32 v148, v148, v152
    v_sub_f32 v149, v149, v152
    v_cvt_pk_bf16_f32 v148, 0, v148
    v_cvt_pk_bf16_f32 v149, 0, v149
    v_mul_f32 v148, v148, v153
    v_mul_f32 v149, v149, v153
    v_cvt_pk_bf16_f32 v148, 0, v148
    v_cvt_pk_bf16_f32 v149, 0, v149
    v_mul_f32 v148, v148, v34
    v_mul_f32 v149, v149, v35
    v_cvt_pk_bf16_f32 v148, 0, v148
    v_cvt_pk_bf16_f32 v149, 0, v149
    v_add_f32 v148, v148, v36
    v_add_f32 v149, v149, v37
    v_cvt_pk_bf16_f32 v138, v148, v149
    v_lshlrev_b32 v34, 16, v47
    v_and_b32 v35, 0xffff0000, v47
    v_add_f32 v34, 1.0, v34
    v_add_f32 v35, 1.0, v35
    v_cvt_pk_bf16_f32 v34, 0, v34
    v_cvt_pk_bf16_f32 v35, 0, v35
    v_lshlrev_b32 v36, 16, v43
    v_and_b32 v37, 0xffff0000, v43
    v_sub_f32 v16, v16, v26
    v_sub_f32 v17, v17, v26
    v_cvt_pk_bf16_f32 v16, 0, v16
    v_cvt_pk_bf16_f32 v17, 0, v17
    v_mul_f32 v16, v16, v28
    v_mul_f32 v17, v17, v28
    v_cvt_pk_bf16_f32 v16, 0, v16
    v_cvt_pk_bf16_f32 v17, 0, v17
    v_mul_f32 v16, v16, v34
    v_mul_f32 v17, v17, v35
    v_cvt_pk_bf16_f32 v16, 0, v16
    v_cvt_pk_bf16_f32 v17, 0, v17
    v_add_f32 v16, v16, v36
    v_add_f32 v17, v17, v37
    v_cvt_pk_bf16_f32 v131, v16, v17
    v_sub_f32 v150, v150, v152
    v_sub_f32 v151, v151, v152
    v_cvt_pk_bf16_f32 v150, 0, v150
    v_cvt_pk_bf16_f32 v151, 0, v151
    v_mul_f32 v150, v150, v153
    v_mul_f32 v151, v151, v153
    v_cvt_pk_bf16_f32 v150, 0, v150
    v_cvt_pk_bf16_f32 v151, 0, v151
    v_mul_f32 v150, v150, v34
    v_mul_f32 v151, v151, v35
    v_cvt_pk_bf16_f32 v150, 0, v150
    v_cvt_pk_bf16_f32 v151, 0, v151
    v_add_f32 v150, v150, v36
    v_add_f32 v151, v151, v37
    v_cvt_pk_bf16_f32 v139, v150, v151
    v_cmp_gt_u32 vcc, 56, v1
    s_and_saveexec_b64 s[58:59], vcc
    s_mov_b32 s40, 5242880
    v_and_b32 v36, 7, v1
    s_lshl_b32 s41, s28, 1
    v_xor_b32 v36, s41, v36
    v_lshlrev_b32 v36, 4, v36
    v_lshl_add_u32 v36, v1, 7, v36
    v_add_u32 v36, 155648, v36
    v_xor_b32 v37, 16, v36
    ds_write_b128 v36, v[128:131]
    ds_write_b128 v37, v[136:139]
    s_mov_b64 exec, -1
    s_mul_i32 s41, s28, 14
    v_lshrrev_b32 v36, 3, v1
    v_add_u32 v36, s41, v36
    v_and_b32 v37, 7, v1
    v_xor_b32 v38, v36, v37
    v_and_b32 v38, 7, v38
    v_lshlrev_b32 v38, 4, v38
    v_lshl_add_u32 v38, v36, 7, v38
    v_add_u32 v38, 155648, v38
    v_lshlrev_b32 v39, 4, v37
    v_lshl_add_u32 v39, v36, 9, v39
    s_lshl_b32 s41, s30, 1
    s_lshr_b32 s42, s29, 2
    s_add_u32 s41, s41, s42
    s_mul_i32 s41, s41, 28672
    s_and_b32 s42, s29, 3
    s_lshl_b32 s42, s42, 7
    s_add_u32 s41, s41, s42
    s_add_u32 s40, s40, s41
    s_add_u32 s41, s40, 4096
    s_waitcnt lgkmcnt(0)
    s_barrier
    ds_read_b128 v[128:131], v38
    s_mov_b32 exec_hi, 0xffff
    ds_read_b128 v[136:139], v38 offset:1024
    s_mov_b64 exec, -1
    s_waitcnt lgkmcnt(1)
    buffer_store_dwordx4 v[128:131], v39, s[24:27], s40 offen sc1
    s_mov_b32 exec_hi, 0xffff
    s_waitcnt lgkmcnt(0)
    buffer_store_dwordx4 v[136:139], v39, s[24:27], s41 offen sc1
    s_mov_b64 exec, -1
    s_barrier
    s_cmp_lg_u32 s28, 0
    s_cbranch_scc1 Lhi_47
    v_mov_b32 v126, 2
    v_mov_b32 v127, 0
    s_lshl_b32 s40, s29, 7
    s_add_u32 s40, s40, s38
    s_mov_b64 exec, 1
    buffer_store_dword v126, v127, s[24:27], s40 offen offset:4 sc1
    s_mov_b64 exec, -1
Lhi_47:
    v_lshl_add_u32 v126, v120, 3, v121
    v_lshlrev_b32 v126, 7, v126
    v_bfe_u32 v127, v121, 1, 1
    v_lshl_add_u32 v126, v127, 6, v126
    v_lshl_add_u32 v126, v123, 5, v126
    v_lshl_add_u32 v126, v122, 3, v126
    v_xor_b32 v127, 64, v126
    s_lshl_b32 s40, s31, 14
    v_add_u32 v114, s40, v126
    v_add_u32 v115, s40, v127
    s_lshl_b32 s40, s31, 6
    s_mul_i32 s41, s31, 12288
    s_lshl_b32 s42, s31, 14
    v_xor_b32 v104, s40, v126
    v_add_u32 v104, s41, v104
    v_xor_b32 v105, s40, v127
    v_add_u32 v105, s42, v105
    v_lshlrev_b32 v111, 4, v1
    s_lshl_b32 s40, s32, 14
    s_add_u32 s40, s40, 131072
    v_add_u32 v107, s40, v111
    s_lshl_b32 s40, s31, 12
    v_add_u32 v106, s40, v107
    s_lshl_b32 s41, s30, 1
    s_add_u32 s41, s41, s32
    s_mul_i32 s41, s41, 28672
    s_add_u32 s41, s41, 5242880
    s_lshl_b32 s40, s30, 5
    s_lshl_b32 s42, s32, 4
    s_add_u32 s40, s40, s42
    s_lshl_b32 s42, s29, 10
    s_add_u32 s40, s40, s42
    s_mul_i32 s40, s40, 1792
    s_mul_i32 s42, s31, 896
    s_add_u32 s40, s40, s42
    s_add_u32 s39, s40, 33554432
    s_mov_b32 s68, 0xbfb8aa3b
    s_mov_b32 s69, 0xbfb8aa3b
    s_mov_b32 s70, 1.0
    s_mov_b32 s71, 1.0
    v_add_u32 v108, 65536, v114
    v_add_u32 v109, 65536, v115
    v_add_u32 v110, 65536, v104
    v_add_u32 v117, 65536, v105
    v_add_u32 v100, 131072, v114
    v_add_u32 v101, 131072, v115
    ds_read_b64_tr_b16 a[112:113], v114 offset:0
    ds_read_b64_tr_b16 a[114:115], v114 offset:512
    ds_read_b64_tr_b16 a[116:117], v115 offset:0
    ds_read_b64_tr_b16 a[118:119], v115 offset:512
    ds_read_b64_tr_b16 a[120:121], v114 offset:8192
    ds_read_b64_tr_b16 a[122:123], v114 offset:8704
    ds_read_b64_tr_b16 a[124:125], v115 offset:8192
    ds_read_b64_tr_b16 a[126:127], v115 offset:8704
    ds_read_b64_tr_b16 a[128:129], v114 offset:2048
    ds_read_b64_tr_b16 a[130:131], v114 offset:2560
    ds_read_b64_tr_b16 a[132:133], v115 offset:2048
    ds_read_b64_tr_b16 a[134:135], v115 offset:2560
    ds_read_b64_tr_b16 a[136:137], v114 offset:10240
    ds_read_b64_tr_b16 a[138:139], v114 offset:10752
    ds_read_b64_tr_b16 a[140:141], v115 offset:10240
    ds_read_b64_tr_b16 a[142:143], v115 offset:10752
    ds_read_b64_tr_b16 a[144:145], v114 offset:4096
    ds_read_b64_tr_b16 a[146:147], v114 offset:4608
    ds_read_b64_tr_b16 a[148:149], v115 offset:4096
    ds_read_b64_tr_b16 a[150:151], v115 offset:4608
    ds_read_b64_tr_b16 a[152:153], v114 offset:12288
    ds_read_b64_tr_b16 a[154:155], v114 offset:12800
    ds_read_b64_tr_b16 a[156:157], v115 offset:12288
    ds_read_b64_tr_b16 a[158:159], v115 offset:12800
    ds_read_b64_tr_b16 a[160:161], v114 offset:6144
    ds_read_b64_tr_b16 a[162:163], v114 offset:6656
    ds_read_b64_tr_b16 a[164:165], v115 offset:6144
    ds_read_b64_tr_b16 a[166:167], v115 offset:6656
    ds_read_b64_tr_b16 a[168:169], v114 offset:14336
    ds_read_b64_tr_b16 a[170:171], v114 offset:14848
    ds_read_b64_tr_b16 a[172:173], v115 offset:14336
    ds_read_b64_tr_b16 a[174:175], v115 offset:14848
    ds_read_b64_tr_b16 a[176:177], v114 offset:32768
    ds_read_b64_tr_b16 a[178:179], v114 offset:33280
    ds_read_b64_tr_b16 a[180:181], v115 offset:32768
    ds_read_b64_tr_b16 a[182:183], v115 offset:33280
    ds_read_b64_tr_b16 a[184:185], v114 offset:40960
    ds_read_b64_tr_b16 a[186:187], v114 offset:41472
    ds_read_b64_tr_b16 a[188:189], v115 offset:40960
    ds_read_b64_tr_b16 a[190:191], v115 offset:41472
    ds_read_b64_tr_b16 a[192:193], v114 offset:34816
    ds_read_b64_tr_b16 a[194:195], v114 offset:35328
    ds_read_b64_tr_b16 a[196:197], v115 offset:34816
    ds_read_b64_tr_b16 a[198:199], v115 offset:35328
    ds_read_b64_tr_b16 a[200:201], v114 offset:43008
    ds_read_b64_tr_b16 a[202:203], v114 offset:43520
    ds_read_b64_tr_b16 a[204:205], v115 offset:43008
    ds_read_b64_tr_b16 a[206:207], v115 offset:43520
    ds_read_b64_tr_b16 a[208:209], v114 offset:36864
    ds_read_b64_tr_b16 a[210:211], v114 offset:37376
    ds_read_b64_tr_b16 a[212:213], v115 offset:36864
    ds_read_b64_tr_b16 a[214:215], v115 offset:37376
    ds_read_b64_tr_b16 a[216:217], v114 offset:45056
    ds_read_b64_tr_b16 a[218:219], v114 offset:45568
    ds_read_b64_tr_b16 a[220:221], v115 offset:45056
    ds_read_b64_tr_b16 a[222:223], v115 offset:45568
    ds_read_b64_tr_b16 a[224:225], v114 offset:38912
    ds_read_b64_tr_b16 a[226:227], v114 offset:39424
    ds_read_b64_tr_b16 a[228:229], v115 offset:38912
    ds_read_b64_tr_b16 a[230:231], v115 offset:39424
    ds_read_b64_tr_b16 a[232:233], v114 offset:47104
    ds_read_b64_tr_b16 a[234:235], v114 offset:47616
    ds_read_b64_tr_b16 a[236:237], v115 offset:47104
    ds_read_b64_tr_b16 a[238:239], v115 offset:47616
    ds_read_b64_tr_b16 v[192:193], v108 offset:0
    ds_read_b64_tr_b16 v[194:195], v108 offset:512
    ds_read_b64_tr_b16 v[196:197], v109 offset:0
    ds_read_b64_tr_b16 v[198:199], v109 offset:512
    ds_read_b64_tr_b16 v[200:201], v108 offset:8192
    ds_read_b64_tr_b16 v[202:203], v108 offset:8704
    ds_read_b64_tr_b16 v[204:205], v109 offset:8192
    ds_read_b64_tr_b16 v[206:207], v109 offset:8704
    ds_read_b64_tr_b16 v[208:209], v108 offset:2048
    ds_read_b64_tr_b16 v[210:211], v108 offset:2560
    ds_read_b64_tr_b16 v[212:213], v109 offset:2048
    ds_read_b64_tr_b16 v[214:215], v109 offset:2560
    ds_read_b64_tr_b16 v[216:217], v108 offset:10240
    ds_read_b64_tr_b16 v[218:219], v108 offset:10752
    ds_read_b64_tr_b16 v[220:221], v109 offset:10240
    ds_read_b64_tr_b16 v[222:223], v109 offset:10752
    ds_read_b64_tr_b16 v[224:225], v108 offset:4096
    ds_read_b64_tr_b16 v[226:227], v108 offset:4608
    ds_read_b64_tr_b16 v[228:229], v109 offset:4096
    ds_read_b64_tr_b16 v[230:231], v109 offset:4608
    ds_read_b64_tr_b16 v[232:233], v108 offset:12288
    ds_read_b64_tr_b16 v[234:235], v108 offset:12800
    ds_read_b64_tr_b16 v[236:237], v109 offset:12288
    ds_read_b64_tr_b16 v[238:239], v109 offset:12800
    ds_read_b64_tr_b16 v[240:241], v108 offset:6144
    ds_read_b64_tr_b16 v[242:243], v108 offset:6656
    ds_read_b64_tr_b16 v[244:245], v109 offset:6144
    ds_read_b64_tr_b16 v[246:247], v109 offset:6656
    ds_read_b64_tr_b16 v[248:249], v108 offset:14336
    ds_read_b64_tr_b16 v[250:251], v108 offset:14848
    ds_read_b64_tr_b16 v[252:253], v109 offset:14336
    ds_read_b64_tr_b16 v[254:255], v109 offset:14848
    s_waitcnt lgkmcnt(0)
    s_barrier
    s_cmp_lg_u32 s28, 0
    s_cbranch_scc1 Lso_50
    v_mov_b32 v126, 2
    v_and_b32 v127, 7, v1
    v_lshlrev_b32 v127, 7, v127
    v_bfe_u32 v125, v1, 3, 1
    v_xor_b32 v125, 1, v125
    v_lshl_add_u32 v127, v125, 2, v127
    s_mov_b64 exec, 0xff
    s_mov_b32 s40, 0
    buffer_load_dword v125, v127, s[24:27], s38 offen sc1
    s_sleep 4
Lsp_49:
    buffer_load_dword v118, v127, s[24:27], s38 offen sc1
    s_waitcnt vmcnt(1)
    v_cmp_gt_u32 vcc, v126, v125
    s_nop 1
    s_and_b64 vcc, vcc, exec
    s_cbranch_scc0 Lsy_48
    buffer_load_dword v125, v127, s[24:27], s38 offen sc1
    s_waitcnt vmcnt(1)
    v_cmp_gt_u32 vcc, v126, v118
    s_nop 1
    s_and_b64 vcc, vcc, exec
    s_cbranch_scc0 Lsy_48
    s_add_u32 s40, s40, 1
    s_cmp_lt_u32 s40, 65536
    s_cbranch_scc1 Lsp_49
    s_branch Lsy_48
Lso_50:
    s_add_u32 s43, s34, 1146880
    s_add_u32 m0, s33, 0
    s_nop 0
    buffer_load_dwordx4 v112, s[8:11], s43 offen offset:0 lds
    buffer_load_dwordx4 v113, s[8:11], s43 offen offset:1024 lds
    s_add_u32 m0, s33, 8192
    s_nop 0
    buffer_load_dwordx4 v112, s[12:15], s43 offen offset:0 lds
    buffer_load_dwordx4 v113, s[12:15], s43 offen offset:1024 lds
    s_add_u32 s43, s34, 1147008
    s_add_u32 m0, s33, 16384
    s_nop 0
    buffer_load_dwordx4 v112, s[8:11], s43 offen offset:0 lds
    buffer_load_dwordx4 v113, s[8:11], s43 offen offset:1024 lds
    s_add_u32 m0, s33, 24576
    s_nop 0
    buffer_load_dwordx4 v112, s[12:15], s43 offen offset:0 lds
    buffer_load_dwordx4 v113, s[12:15], s43 offen offset:1024 lds
    s_cmp_eq_u32 s28, 2
    s_cbranch_scc1 Lw2_51
    s_cmp_eq_u32 s28, 3
    s_cbranch_scc1 Lw3_52
    s_add_u32 s43, s35, 1146880
    s_add_u32 m0, s56, 0
    s_nop 0
    buffer_load_dwordx4 v112, s[8:11], s43 offen offset:0 lds
    buffer_load_dwordx4 v113, s[8:11], s43 offen offset:1024 lds
    s_add_u32 m0, s56, 8192
    s_nop 0
    buffer_load_dwordx4 v112, s[12:15], s43 offen offset:0 lds
    buffer_load_dwordx4 v113, s[12:15], s43 offen offset:1024 lds
    s_add_u32 s43, s35, 1147008
    s_add_u32 m0, s56, 16384
    s_nop 0
    buffer_load_dwordx4 v112, s[8:11], s43 offen offset:0 lds
    buffer_load_dwordx4 v113, s[8:11], s43 offen offset:1024 lds
    s_add_u32 m0, s56, 24576
    s_nop 0
    buffer_load_dwordx4 v112, s[12:15], s43 offen offset:0 lds
    buffer_load_dwordx4 v113, s[12:15], s43 offen offset:1024 lds
    s_branch Lwj_53
Lw2_51:
    s_branch Lwj_53
Lw3_52:
Lwj_53:
Lsy_48:
    s_mov_b64 exec, -1
    s_barrier
    s_mov_b32 s57, 0
    s_mov_b32 s74, s41
    buffer_load_dwordx4 a[0:3], v111, s[24:27], s41 offen offset:0
    buffer_load_dwordx4 a[4:7], v111, s[24:27], s41 offen offset:1024
    buffer_load_dwordx4 a[8:11], v111, s[24:27], s41 offen offset:2048
    buffer_load_dwordx4 a[12:15], v111, s[24:27], s41 offen offset:3072
    s_add_u32 s41, s41, 4096
    buffer_load_dwordx4 a[16:19], v111, s[24:27], s41 offen offset:0
    buffer_load_dwordx4 a[20:23], v111, s[24:27], s41 offen offset:1024
    buffer_load_dwordx4 a[24:27], v111, s[24:27], s41 offen offset:2048
    buffer_load_dwordx4 a[28:31], v111, s[24:27], s41 offen offset:3072
    s_add_u32 s41, s41, 4096
    buffer_load_dwordx4 a[32:35], v111, s[24:27], s41 offen offset:0
    buffer_load_dwordx4 a[36:39], v111, s[24:27], s41 offen offset:1024
    buffer_load_dwordx4 a[40:43], v111, s[24:27], s41 offen offset:2048
    buffer_load_dwordx4 a[44:47], v111, s[24:27], s41 offen offset:3072
    s_add_u32 s41, s41, 4096
    buffer_load_dwordx4 a[48:51], v111, s[24:27], s41 offen offset:0
    buffer_load_dwordx4 a[52:55], v111, s[24:27], s41 offen offset:1024
    buffer_load_dwordx4 a[56:59], v111, s[24:27], s41 offen offset:2048
    buffer_load_dwordx4 a[60:63], v111, s[24:27], s41 offen offset:3072
    s_add_u32 s41, s41, 4096
    buffer_load_dwordx4 a[64:67], v111, s[24:27], s41 offen offset:0
    buffer_load_dwordx4 a[68:71], v111, s[24:27], s41 offen offset:1024
    buffer_load_dwordx4 a[72:75], v111, s[24:27], s41 offen offset:2048
    buffer_load_dwordx4 a[76:79], v111, s[24:27], s41 offen offset:3072
    s_add_u32 s41, s41, 4096
    buffer_load_dwordx4 a[80:83], v111, s[24:27], s41 offen offset:0
    buffer_load_dwordx4 a[84:87], v111, s[24:27], s41 offen offset:1024
    buffer_load_dwordx4 a[88:91], v111, s[24:27], s41 offen offset:2048
    buffer_load_dwordx4 a[92:95], v111, s[24:27], s41 offen offset:3072
    s_add_u32 s41, s41, 4096
    buffer_load_dwordx4 a[96:99], v111, s[24:27], s41 offen offset:0
    buffer_load_dwordx4 a[100:103], v111, s[24:27], s41 offen offset:1024
    buffer_load_dwordx4 a[104:107], v111, s[24:27], s41 offen offset:2048
    buffer_load_dwordx4 a[108:111], v111, s[24:27], s41 offen offset:3072
    s_waitcnt vmcnt(27)
    s_waitcnt vmcnt(24)
Lhr_54:
    v_accvgpr_read_b32 v24, a0
    v_accvgpr_read_b32 v25, a4
    v_accvgpr_read_b32 v26, a8
    v_accvgpr_read_b32 v27, a12
    v_max3_u32 v24, v24, v25, v26
    v_max_u32 v24, v24, v27
    v_cmp_eq_u32 vcc, -1, v24
    s_nop 1
    s_cbranch_vccnz Lhs_55
Lhc_56:
    v_mfma_f32_32x32x16_bf16 v[128:143], a[112:115], a[0:3], 0
    s_add_u32 s43, s34, 1376256
    s_add_u32 m0, s33, 32768
    s_nop 0
    buffer_load_dwordx4 v112, s[8:11], s43 offen offset:0 lds
    v_mfma_f32_32x32x16_bf16 v[144:159], a[116:119], a[0:3], 0
    v_mfma_f32_32x32x16_bf16 v[160:175], a[120:123], a[0:3], 0
    buffer_load_dwordx4 v113, s[8:11], s43 offen offset:1024 lds
    v_mfma_f32_32x32x16_bf16 v[176:191], a[124:127], a[0:3], 0
    v_mfma_f32_32x32x16_bf16 v[128:143], a[128:131], a[4:7], v[128:143]
    s_add_u32 m0, s33, 40960
    s_nop 0
    buffer_load_dwordx4 v112, s[12:15], s43 offen offset:0 lds
    v_mfma_f32_32x32x16_bf16 v[144:159], a[132:135], a[4:7], v[144:159]
    v_mfma_f32_32x32x16_bf16 v[160:175], a[136:139], a[4:7], v[160:175]
    buffer_load_dwordx4 v113, s[12:15], s43 offen offset:1024 lds
    v_mfma_f32_32x32x16_bf16 v[176:191], a[140:143], a[4:7], v[176:191]
    v_mfma_f32_32x32x16_bf16 v[128:143], a[144:147], a[8:11], v[128:143]
    s_add_u32 s43, s34, 1376384
    s_add_u32 m0, s33, 49152
    s_nop 0
    buffer_load_dwordx4 v112, s[8:11], s43 offen offset:0 lds
    v_mfma_f32_32x32x16_bf16 v[144:159], a[148:151], a[8:11], v[144:159]
    v_mfma_f32_32x32x16_bf16 v[160:175], a[152:155], a[8:11], v[160:175]
    buffer_load_dwordx4 v113, s[8:11], s43 offen offset:1024 lds
    v_mfma_f32_32x32x16_bf16 v[176:191], a[156:159], a[8:11], v[176:191]
    v_mfma_f32_32x32x16_bf16 v[128:143], a[160:163], a[12:15], v[128:143]
    s_add_u32 m0, s33, 57344
    s_nop 0
    buffer_load_dwordx4 v112, s[12:15], s43 offen offset:0 lds
    v_mfma_f32_32x32x16_bf16 v[144:159], a[164:167], a[12:15], v[144:159]
    v_mfma_f32_32x32x16_bf16 v[160:175], a[168:171], a[12:15], v[160:175]
    buffer_load_dwordx4 v113, s[12:15], s43 offen offset:1024 lds
    v_mfma_f32_32x32x16_bf16 v[176:191], a[172:175], a[12:15], v[176:191]
    s_waitcnt vmcnt(31)
    s_waitcnt vmcnt(28)
Lhr_57:
    v_accvgpr_read_b32 v24, a16
    v_accvgpr_read_b32 v25, a20
    v_accvgpr_read_b32 v26, a24
    v_accvgpr_read_b32 v27, a28
    v_max3_u32 v24, v24, v25, v26
    v_max_u32 v24, v24, v27
    v_cmp_eq_u32 vcc, -1, v24
    s_nop 1
    s_cbranch_vccnz Lhs_58
Lhc_59:
    v_mfma_f32_32x32x16_bf16 v[128:143], a[176:179], a[16:19], v[128:143]
    s_add_u32 s43, s34, 256
    s_add_u32 m0, s33, 65536
    s_nop 0
    buffer_load_dwordx4 v112, s[8:11], s43 offen offset:0 lds
    v_mfma_f32_32x32x16_bf16 v[144:159], a[180:183], a[16:19], v[144:159]
    v_mfma_f32_32x32x16_bf16 v[160:175], a[184:187], a[16:19], v[160:175]
    buffer_load_dwordx4 v113, s[8:11], s43 offen offset:1024 lds
    v_mfma_f32_32x32x16_bf16 v[176:191], a[188:191], a[16:19], v[176:191]
    v_mfma_f32_32x32x16_bf16 v[128:143], a[192:195], a[20:23], v[128:143]
    s_add_u32 m0, s33, 73728
    s_nop 0
    buffer_load_dwordx4 v112, s[12:15], s43 offen offset:0 lds
    v_mfma_f32_32x32x16_bf16 v[144:159], a[196:199], a[20:23], v[144:159]
    v_mfma_f32_32x32x16_bf16 v[160:175], a[200:203], a[20:23], v[160:175]
    buffer_load_dwordx4 v113, s[12:15], s43 offen offset:1024 lds
    v_mfma_f32_32x32x16_bf16 v[176:191], a[204:207], a[20:23], v[176:191]
    v_mfma_f32_32x32x16_bf16 v[128:143], a[208:211], a[24:27], v[128:143]
    s_add_u32 s43, s77, 0
    s_add_u32 m0, s33, 81920
    s_mov_b64 exec, s[72:73]
    buffer_load_dwordx4 v112, s[8:11], s43 offen offset:0 lds
    s_mov_b64 exec, -1
    v_mfma_f32_32x32x16_bf16 v[144:159], a[212:215], a[24:27], v[144:159]
    v_mfma_f32_32x32x16_bf16 v[160:175], a[216:219], a[24:27], v[160:175]
    s_mov_b64 exec, s[72:73]
    buffer_load_dwordx4 v113, s[8:11], s43 offen offset:1024 lds
    s_mov_b64 exec, -1
    v_mfma_f32_32x32x16_bf16 v[176:191], a[220:223], a[24:27], v[176:191]
    v_mfma_f32_32x32x16_bf16 v[128:143], a[224:227], a[28:31], v[128:143]
    s_add_u32 m0, s33, 90112
    s_mov_b64 exec, s[72:73]
    buffer_load_dwordx4 v112, s[12:15], s43 offen offset:0 lds
    s_mov_b64 exec, -1
    v_mfma_f32_32x32x16_bf16 v[144:159], a[228:231], a[28:31], v[144:159]
    v_mfma_f32_32x32x16_bf16 v[160:175], a[232:235], a[28:31], v[160:175]
    s_mov_b64 exec, s[72:73]
    buffer_load_dwordx4 v113, s[12:15], s43 offen offset:1024 lds
    s_mov_b64 exec, -1
    v_mfma_f32_32x32x16_bf16 v[176:191], a[236:239], a[28:31], v[176:191]
    s_waitcnt vmcnt(35)
    s_waitcnt vmcnt(32)
Lhr_60:
    v_accvgpr_read_b32 v24, a32
    v_accvgpr_read_b32 v25, a36
    v_accvgpr_read_b32 v26, a40
    v_accvgpr_read_b32 v27, a44
    v_max3_u32 v24, v24, v25, v26
    v_max_u32 v24, v24, v27
    v_cmp_eq_u32 vcc, -1, v24
    s_nop 1
    s_cbranch_vccnz Lhs_61
Lhc_62:
    v_mfma_f32_32x32x16_bf16 v[128:143], v[192:195], a[32:35], v[128:143]
    s_add_u32 s43, s34, 917504
    s_add_u32 s43, s34, 917632
    s_add_u32 m0, s33, 155648
    s_nop 0
    buffer_load_dwordx4 v112, s[12:15], s43 offen offset:0 lds
    v_mfma_f32_32x32x16_bf16 v[144:159], v[196:199], a[32:35], v[144:159]
    v_mfma_f32_32x32x16_bf16 v[160:175], v[200:203], a[32:35], v[160:175]
    buffer_load_dwordx4 v113, s[12:15], s43 offen offset:1024 lds
    v_mfma_f32_32x32x16_bf16 v[176:191], v[204:207], a[32:35], v[176:191]
    v_mfma_f32_32x32x16_bf16 v[128:143], v[208:211], a[36:39], v[128:143]
    v_mfma_f32_32x32x16_bf16 v[144:159], v[212:215], a[36:39], v[144:159]
    v_mfma_f32_32x32x16_bf16 v[160:175], v[216:219], a[36:39], v[160:175]
    v_mfma_f32_32x32x16_bf16 v[176:191], v[220:223], a[36:39], v[176:191]
    v_mfma_f32_32x32x16_bf16 v[128:143], v[224:227], a[40:43], v[128:143]
    v_mfma_f32_32x32x16_bf16 v[144:159], v[228:231], a[40:43], v[144:159]
    v_mfma_f32_32x32x16_bf16 v[160:175], v[232:235], a[40:43], v[160:175]
    v_mfma_f32_32x32x16_bf16 v[176:191], v[236:239], a[40:43], v[176:191]
    ds_read_b64_tr_b16 v[40:41], v108 offset:32768
    ds_read_b64_tr_b16 v[42:43], v108 offset:33280
    v_mfma_f32_32x32x16_bf16 v[128:143], v[240:243], a[44:47], v[128:143]
    ds_read_b64_tr_b16 v[44:45], v109 offset:32768
    ds_read_b64_tr_b16 v[46:47], v109 offset:33280
    v_mfma_f32_32x32x16_bf16 v[144:159], v[244:247], a[44:47], v[144:159]
    ds_read_b64_tr_b16 v[48:49], v108 offset:40960
    ds_read_b64_tr_b16 v[50:51], v108 offset:41472
    v_mfma_f32_32x32x16_bf16 v[160:175], v[248:251], a[44:47], v[160:175]
    ds_read_b64_tr_b16 v[52:53], v109 offset:40960
    ds_read_b64_tr_b16 v[54:55], v109 offset:41472
    v_mfma_f32_32x32x16_bf16 v[176:191], v[252:255], a[44:47], v[176:191]
    ds_read_b64_tr_b16 v[56:57], v108 offset:34816
    ds_read_b64_tr_b16 v[58:59], v108 offset:35328
    s_waitcnt lgkmcnt(6)
    s_waitcnt vmcnt(33)
    s_waitcnt vmcnt(30)
Lhr_63:
    v_accvgpr_read_b32 v24, a48
    v_accvgpr_read_b32 v25, a52
    v_accvgpr_read_b32 v26, a56
    v_accvgpr_read_b32 v27, a60
    v_max3_u32 v24, v24, v25, v26
    v_max_u32 v24, v24, v27
    v_cmp_eq_u32 vcc, -1, v24
    s_nop 1
    s_cbranch_vccnz Lhs_64
Lhc_65:
    v_mfma_f32_32x32x16_bf16 v[128:143], v[40:43], a[48:51], v[128:143]
    ds_read_b64_tr_b16 v[60:61], v109 offset:34816
    ds_read_b64_tr_b16 v[62:63], v109 offset:35328
    v_mfma_f32_32x32x16_bf16 v[144:159], v[44:47], a[48:51], v[144:159]
    ds_read_b64_tr_b16 v[64:65], v108 offset:43008
    ds_read_b64_tr_b16 v[66:67], v108 offset:43520
    s_waitcnt lgkmcnt(6)
    v_mfma_f32_32x32x16_bf16 v[160:175], v[48:51], a[48:51], v[160:175]
    ds_read_b64_tr_b16 v[68:69], v109 offset:43008
    ds_read_b64_tr_b16 v[70:71], v109 offset:43520
    v_mfma_f32_32x32x16_bf16 v[176:191], v[52:55], a[48:51], v[176:191]
    ds_read_b64_tr_b16 v[40:41], v108 offset:36864
    ds_read_b64_tr_b16 v[42:43], v108 offset:37376
    s_waitcnt lgkmcnt(6)
    v_mfma_f32_32x32x16_bf16 v[128:143], v[56:59], a[52:55], v[128:143]
    ds_read_b64_tr_b16 v[44:45], v109 offset:36864
    ds_read_b64_tr_b16 v[46:47], v109 offset:37376
    v_mfma_f32_32x32x16_bf16 v[144:159], v[60:63], a[52:55], v[144:159]
    ds_read_b64_tr_b16 v[48:49], v108 offset:45056
    ds_read_b64_tr_b16 v[50:51], v108 offset:45568
    s_waitcnt lgkmcnt(6)
    v_mfma_f32_32x32x16_bf16 v[160:175], v[64:67], a[52:55], v[160:175]
    ds_read_b64_tr_b16 v[52:53], v109 offset:45056
    ds_read_b64_tr_b16 v[54:55], v109 offset:45568
    v_mfma_f32_32x32x16_bf16 v[176:191], v[68:71], a[52:55], v[176:191]
    ds_read_b64_tr_b16 v[56:57], v108 offset:38912
    ds_read_b64_tr_b16 v[58:59], v108 offset:39424
    s_waitcnt vmcnt(0)
    s_barrier
    s_waitcnt lgkmcnt(6)
    v_mfma_f32_32x32x16_bf16 v[128:143], v[40:43], a[56:59], v[128:143]
    ds_read_b64_tr_b16 v[60:61], v109 offset:38912
    ds_read_b64_tr_b16 v[62:63], v109 offset:39424
    v_mfma_f32_32x32x16_bf16 v[144:159], v[44:47], a[56:59], v[144:159]
    ds_read_b64_tr_b16 v[64:65], v108 offset:47104
    ds_read_b64_tr_b16 v[66:67], v108 offset:47616
    s_waitcnt lgkmcnt(6)
    v_mfma_f32_32x32x16_bf16 v[160:175], v[48:51], a[56:59], v[160:175]
    ds_read_b64_tr_b16 v[68:69], v109 offset:47104
    ds_read_b64_tr_b16 v[70:71], v109 offset:47616
    v_mfma_f32_32x32x16_bf16 v[176:191], v[52:55], a[56:59], v[176:191]
    ds_read_b64_tr_b16 v[40:41], v100 offset:0
    ds_read_b64_tr_b16 v[42:43], v100 offset:512
    s_waitcnt lgkmcnt(6)
    v_mfma_f32_32x32x16_bf16 v[128:143], v[56:59], a[60:63], v[128:143]
    ds_read_b64_tr_b16 v[44:45], v101 offset:0
    ds_read_b64_tr_b16 v[46:47], v101 offset:512
    v_mfma_f32_32x32x16_bf16 v[144:159], v[60:63], a[60:63], v[144:159]
    ds_read_b64_tr_b16 v[48:49], v100 offset:8192
    ds_read_b64_tr_b16 v[50:51], v100 offset:8704
    s_waitcnt lgkmcnt(6)
    v_mfma_f32_32x32x16_bf16 v[160:175], v[64:67], a[60:63], v[160:175]
    ds_read_b64_tr_b16 v[52:53], v101 offset:8192
    ds_read_b64_tr_b16 v[54:55], v101 offset:8704
    v_mfma_f32_32x32x16_bf16 v[176:191], v[68:71], a[60:63], v[176:191]
    ds_read_b64_tr_b16 v[56:57], v100 offset:2048
    ds_read_b64_tr_b16 v[58:59], v100 offset:2560
    s_barrier
    s_waitcnt lgkmcnt(6)
Lhr_66:
    v_accvgpr_read_b32 v24, a64
    v_accvgpr_read_b32 v25, a68
    v_accvgpr_read_b32 v26, a72
    v_accvgpr_read_b32 v27, a76
    v_max3_u32 v24, v24, v25, v26
    v_max_u32 v24, v24, v27
    v_cmp_eq_u32 vcc, -1, v24
    s_nop 1
    s_cbranch_vccnz Lhs_67
Lhc_68:
    v_mfma_f32_32x32x16_bf16 v[128:143], v[40:43], a[64:67], v[128:143]
    ds_read_b64_tr_b16 v[60:61], v101 offset:2048
    ds_read_b64_tr_b16 v[62:63], v101 offset:2560
    s_add_u32 s43, s34, 229632
    s_add_u32 m0, s33, 98304
    s_nop 0
    buffer_load_dwordx4 v112, s[8:11], s43 offen offset:0 lds
    v_mfma_f32_32x32x16_bf16 v[144:159], v[44:47], a[64:67], v[144:159]
    ds_read_b64_tr_b16 v[64:65], v100 offset:10240
    ds_read_b64_tr_b16 v[66:67], v100 offset:10752
    s_waitcnt lgkmcnt(6)
    v_mfma_f32_32x32x16_bf16 v[160:175], v[48:51], a[64:67], v[160:175]
    ds_read_b64_tr_b16 v[68:69], v101 offset:10240
    ds_read_b64_tr_b16 v[70:71], v101 offset:10752
    buffer_load_dwordx4 v113, s[8:11], s43 offen offset:1024 lds
    v_mfma_f32_32x32x16_bf16 v[176:191], v[52:55], a[64:67], v[176:191]
    ds_read_b64_tr_b16 v[40:41], v100 offset:4096
    ds_read_b64_tr_b16 v[42:43], v100 offset:4608
    s_waitcnt lgkmcnt(6)
    v_mfma_f32_32x32x16_bf16 v[128:143], v[56:59], a[68:71], v[128:143]
    ds_read_b64_tr_b16 v[44:45], v101 offset:4096
    ds_read_b64_tr_b16 v[46:47], v101 offset:4608
    s_add_u32 m0, s33, 106496
    s_nop 0
    buffer_load_dwordx4 v112, s[12:15], s43 offen offset:0 lds
    v_mfma_f32_32x32x16_bf16 v[144:159], v[60:63], a[68:71], v[144:159]
    ds_read_b64_tr_b16 v[48:49], v100 offset:12288
    ds_read_b64_tr_b16 v[50:51], v100 offset:12800
    s_waitcnt lgkmcnt(6)
    v_mfma_f32_32x32x16_bf16 v[160:175], v[64:67], a[68:71], v[160:175]
    ds_read_b64_tr_b16 v[52:53], v101 offset:12288
    ds_read_b64_tr_b16 v[54:55], v101 offset:12800
    buffer_load_dwordx4 v113, s[12:15], s43 offen offset:1024 lds
    v_mfma_f32_32x32x16_bf16 v[176:191], v[68:71], a[68:71], v[176:191]
    ds_read_b64_tr_b16 v[56:57], v100 offset:6144
    ds_read_b64_tr_b16 v[58:59], v100 offset:6656
    s_waitcnt lgkmcnt(6)
    v_mfma_f32_32x32x16_bf16 v[128:143], v[40:43], a[72:75], v[128:143]
    ds_read_b64_tr_b16 v[60:61], v101 offset:6144
    ds_read_b64_tr_b16 v[62:63], v101 offset:6656
    s_add_u32 s43, s77, 229376
    s_add_u32 m0, s33, 114688
    s_mov_b64 exec, s[72:73]
    buffer_load_dwordx4 v112, s[8:11], s43 offen offset:0 lds
    s_mov_b64 exec, -1
    v_mfma_f32_32x32x16_bf16 v[144:159], v[44:47], a[72:75], v[144:159]
    ds_read_b64_tr_b16 v[64:65], v100 offset:14336
    ds_read_b64_tr_b16 v[66:67], v100 offset:14848
    s_waitcnt lgkmcnt(6)
    v_mfma_f32_32x32x16_bf16 v[160:175], v[48:51], a[72:75], v[160:175]
    ds_read_b64_tr_b16 v[68:69], v101 offset:14336
    ds_read_b64_tr_b16 v[70:71], v101 offset:14848
    s_mov_b64 exec, s[72:73]
    buffer_load_dwordx4 v113, s[8:11], s43 offen offset:1024 lds
    s_mov_b64 exec, -1
    v_mfma_f32_32x32x16_bf16 v[176:191], v[52:55], a[72:75], v[176:191]
    ds_read_b64_tr_b16 v[40:41], v114 offset:0
    ds_read_b64_tr_b16 v[42:43], v114 offset:512
    s_waitcnt lgkmcnt(6)
    v_mfma_f32_32x32x16_bf16 v[128:143], v[56:59], a[76:79], v[128:143]
    ds_read_b64_tr_b16 v[44:45], v115 offset:0
    ds_read_b64_tr_b16 v[46:47], v115 offset:512
    s_add_u32 m0, s33, 122880
    s_mov_b64 exec, s[72:73]
    buffer_load_dwordx4 v112, s[12:15], s43 offen offset:0 lds
    s_mov_b64 exec, -1
    v_mfma_f32_32x32x16_bf16 v[144:159], v[60:63], a[76:79], v[144:159]
    ds_read_b64_tr_b16 v[48:49], v114 offset:8192
    ds_read_b64_tr_b16 v[50:51], v114 offset:8704
    s_waitcnt lgkmcnt(6)
    v_mfma_f32_32x32x16_bf16 v[160:175], v[64:67], a[76:79], v[160:175]
    ds_read_b64_tr_b16 v[52:53], v115 offset:8192
    ds_read_b64_tr_b16 v[54:55], v115 offset:8704
    s_mov_b64 exec, s[72:73]
    buffer_load_dwordx4 v113, s[12:15], s43 offen offset:1024 lds
    s_mov_b64 exec, -1
    v_mfma_f32_32x32x16_bf16 v[176:191], v[68:71], a[76:79], v[176:191]
    ds_read_b64_tr_b16 v[56:57], v114 offset:2048
    ds_read_b64_tr_b16 v[58:59], v114 offset:2560
    s_barrier
    s_waitcnt lgkmcnt(6)
Lhr_69:
    v_accvgpr_read_b32 v24, a80
    v_accvgpr_read_b32 v25, a84
    v_accvgpr_read_b32 v26, a88
    v_accvgpr_read_b32 v27, a92
    v_max3_u32 v24, v24, v25, v26
    v_max_u32 v24, v24, v27
    v_cmp_eq_u32 vcc, -1, v24
    s_nop 1
    s_cbranch_vccnz Lhs_70
Lhc_71:
    v_mfma_f32_32x32x16_bf16 v[128:143], v[40:43], a[80:83], v[128:143]
    ds_read_b64_tr_b16 v[60:61], v115 offset:2048
    ds_read_b64_tr_b16 v[62:63], v115 offset:2560
    v_mfma_f32_32x32x16_bf16 v[144:159], v[44:47], a[80:83], v[144:159]
    ds_read_b64_tr_b16 v[64:65], v114 offset:10240
    ds_read_b64_tr_b16 v[66:67], v114 offset:10752
    s_waitcnt lgkmcnt(6)
    v_mfma_f32_32x32x16_bf16 v[160:175], v[48:51], a[80:83], v[160:175]
    ds_read_b64_tr_b16 v[68:69], v115 offset:10240
    ds_read_b64_tr_b16 v[70:71], v115 offset:10752
    v_mfma_f32_32x32x16_bf16 v[176:191], v[52:55], a[80:83], v[176:191]
    ds_read_b64_tr_b16 v[40:41], v114 offset:4096
    ds_read_b64_tr_b16 v[42:43], v114 offset:4608
    s_waitcnt lgkmcnt(6)
    v_mfma_f32_32x32x16_bf16 v[128:143], v[56:59], a[84:87], v[128:143]
    ds_read_b64_tr_b16 v[44:45], v115 offset:4096
    ds_read_b64_tr_b16 v[46:47], v115 offset:4608
    v_mfma_f32_32x32x16_bf16 v[144:159], v[60:63], a[84:87], v[144:159]
    ds_read_b64_tr_b16 v[48:49], v114 offset:12288
    ds_read_b64_tr_b16 v[50:51], v114 offset:12800
    s_waitcnt lgkmcnt(6)
    v_mfma_f32_32x32x16_bf16 v[160:175], v[64:67], a[84:87], v[160:175]
    ds_read_b64_tr_b16 v[52:53], v115 offset:12288
    ds_read_b64_tr_b16 v[54:55], v115 offset:12800
    v_mfma_f32_32x32x16_bf16 v[176:191], v[68:71], a[84:87], v[176:191]
    ds_read_b64_tr_b16 v[56:57], v114 offset:6144
    ds_read_b64_tr_b16 v[58:59], v114 offset:6656
    s_waitcnt lgkmcnt(6)
    v_mfma_f32_32x32x16_bf16 v[128:143], v[40:43], a[88:91], v[128:143]
    ds_read_b64_tr_b16 v[60:61], v115 offset:6144
    ds_read_b64_tr_b16 v[62:63], v115 offset:6656
    v_mfma_f32_32x32x16_bf16 v[144:159], v[44:47], a[88:91], v[144:159]
    ds_read_b64_tr_b16 v[64:65], v114 offset:14336
    ds_read_b64_tr_b16 v[66:67], v114 offset:14848
    s_waitcnt lgkmcnt(6)
    v_mfma_f32_32x32x16_bf16 v[160:175], v[48:51], a[88:91], v[160:175]
    ds_read_b64_tr_b16 v[68:69], v115 offset:14336
    ds_read_b64_tr_b16 v[70:71], v115 offset:14848
    v_mfma_f32_32x32x16_bf16 v[176:191], v[52:55], a[88:91], v[176:191]
    ds_read_b64_tr_b16 v[40:41], v114 offset:32768
    ds_read_b64_tr_b16 v[42:43], v114 offset:33280
    s_waitcnt lgkmcnt(6)
    v_mfma_f32_32x32x16_bf16 v[128:143], v[56:59], a[92:95], v[128:143]
    ds_read_b64_tr_b16 v[44:45], v115 offset:32768
    ds_read_b64_tr_b16 v[46:47], v115 offset:33280
    v_mfma_f32_32x32x16_bf16 v[144:159], v[60:63], a[92:95], v[144:159]
    ds_read_b64_tr_b16 v[48:49], v114 offset:40960
    ds_read_b64_tr_b16 v[50:51], v114 offset:41472
    s_waitcnt lgkmcnt(6)
    v_mfma_f32_32x32x16_bf16 v[160:175], v[64:67], a[92:95], v[160:175]
    ds_read_b64_tr_b16 v[52:53], v115 offset:40960
    ds_read_b64_tr_b16 v[54:55], v115 offset:41472
    v_mfma_f32_32x32x16_bf16 v[176:191], v[68:71], a[92:95], v[176:191]
    ds_read_b64_tr_b16 v[56:57], v114 offset:34816
    ds_read_b64_tr_b16 v[58:59], v114 offset:35328
    s_barrier
    s_waitcnt lgkmcnt(6)
Lhr_72:
    v_accvgpr_read_b32 v24, a96
    v_accvgpr_read_b32 v25, a100
    v_accvgpr_read_b32 v26, a104
    v_accvgpr_read_b32 v27, a108
    v_max3_u32 v24, v24, v25, v26
    v_max_u32 v24, v24, v27
    v_cmp_eq_u32 vcc, -1, v24
    s_nop 1
    s_cbranch_vccnz Lhs_73
Lhc_74:
    v_mfma_f32_32x32x16_bf16 v[128:143], v[40:43], a[96:99], v[128:143]
    ds_read_b64_tr_b16 v[60:61], v115 offset:34816
    ds_read_b64_tr_b16 v[62:63], v115 offset:35328
    s_add_u32 s43, s34, 459008
    s_add_u32 m0, s33, 0
    s_nop 0
    buffer_load_dwordx4 v112, s[8:11], s43 offen offset:0 lds
    v_mfma_f32_32x32x16_bf16 v[144:159], v[44:47], a[96:99], v[144:159]
    ds_read_b64_tr_b16 v[64:65], v114 offset:43008
    ds_read_b64_tr_b16 v[66:67], v114 offset:43520
    s_waitcnt lgkmcnt(6)
    v_mfma_f32_32x32x16_bf16 v[160:175], v[48:51], a[96:99], v[160:175]
    ds_read_b64_tr_b16 v[68:69], v115 offset:43008
    ds_read_b64_tr_b16 v[70:71], v115 offset:43520
    buffer_load_dwordx4 v113, s[8:11], s43 offen offset:1024 lds
    v_mfma_f32_32x32x16_bf16 v[176:191], v[52:55], a[96:99], v[176:191]
    ds_read_b64_tr_b16 v[40:41], v114 offset:36864
    ds_read_b64_tr_b16 v[42:43], v114 offset:37376
    s_waitcnt lgkmcnt(6)
    v_mfma_f32_32x32x16_bf16 v[128:143], v[56:59], a[100:103], v[128:143]
    ds_read_b64_tr_b16 v[44:45], v115 offset:36864
    ds_read_b64_tr_b16 v[46:47], v115 offset:37376
    s_add_u32 m0, s33, 8192
    s_nop 0
    buffer_load_dwordx4 v112, s[12:15], s43 offen offset:0 lds
    v_mfma_f32_32x32x16_bf16 v[144:159], v[60:63], a[100:103], v[144:159]
    ds_read_b64_tr_b16 v[48:49], v114 offset:45056
    ds_read_b64_tr_b16 v[50:51], v114 offset:45568
    s_waitcnt lgkmcnt(6)
    v_mfma_f32_32x32x16_bf16 v[160:175], v[64:67], a[100:103], v[160:175]
    ds_read_b64_tr_b16 v[52:53], v115 offset:45056
    ds_read_b64_tr_b16 v[54:55], v115 offset:45568
    buffer_load_dwordx4 v113, s[12:15], s43 offen offset:1024 lds
    v_mfma_f32_32x32x16_bf16 v[176:191], v[68:71], a[100:103], v[176:191]
    ds_read_b64_tr_b16 v[56:57], v114 offset:38912
    ds_read_b64_tr_b16 v[58:59], v114 offset:39424
    s_waitcnt lgkmcnt(6)
    v_mfma_f32_32x32x16_bf16 v[128:143], v[40:43], a[104:107], v[128:143]
    ds_read_b64_tr_b16 v[60:61], v115 offset:38912
    ds_read_b64_tr_b16 v[62:63], v115 offset:39424
    s_add_u32 s43, s77, 458752
    s_add_u32 m0, s33, 16384
    s_mov_b64 exec, s[72:73]
    buffer_load_dwordx4 v112, s[8:11], s43 offen offset:0 lds
    s_mov_b64 exec, -1
    v_mfma_f32_32x32x16_bf16 v[144:159], v[44:47], a[104:107], v[144:159]
    ds_read_b64_tr_b16 v[64:65], v114 offset:47104
    ds_read_b64_tr_b16 v[66:67], v114 offset:47616
    s_waitcnt lgkmcnt(6)
    v_mfma_f32_32x32x16_bf16 v[160:175], v[48:51], a[104:107], v[160:175]
    ds_read_b64_tr_b16 v[68:69], v115 offset:47104
    ds_read_b64_tr_b16 v[70:71], v115 offset:47616
    s_mov_b64 exec, s[72:73]
    buffer_load_dwordx4 v113, s[8:11], s43 offen offset:1024 lds
    s_mov_b64 exec, -1
    v_mfma_f32_32x32x16_bf16 v[176:191], v[52:55], a[104:107], v[176:191]
    ds_read_b64_tr_b16 v[40:41], v108 offset:0
    ds_read_b64_tr_b16 v[42:43], v108 offset:512
    s_waitcnt lgkmcnt(6)
    v_mfma_f32_32x32x16_bf16 v[128:143], v[56:59], a[108:111], v[128:143]
    ds_read_b64_tr_b16 v[44:45], v109 offset:0
    ds_read_b64_tr_b16 v[46:47], v109 offset:512
    s_add_u32 m0, s33, 24576
    s_mov_b64 exec, s[72:73]
    buffer_load_dwordx4 v112, s[12:15], s43 offen offset:0 lds
    s_mov_b64 exec, -1
    v_mfma_f32_32x32x16_bf16 v[144:159], v[60:63], a[108:111], v[144:159]
    ds_read_b64_tr_b16 v[48:49], v108 offset:8192
    ds_read_b64_tr_b16 v[50:51], v108 offset:8704
    s_waitcnt lgkmcnt(6)
    v_mfma_f32_32x32x16_bf16 v[160:175], v[64:67], a[108:111], v[160:175]
    ds_read_b64_tr_b16 v[52:53], v109 offset:8192
    ds_read_b64_tr_b16 v[54:55], v109 offset:8704
    s_mov_b64 exec, s[72:73]
    buffer_load_dwordx4 v113, s[12:15], s43 offen offset:1024 lds
    s_mov_b64 exec, -1
    v_mfma_f32_32x32x16_bf16 v[176:191], v[68:71], a[108:111], v[176:191]
    ds_read_b64_tr_b16 v[56:57], v108 offset:2048
    ds_read_b64_tr_b16 v[58:59], v108 offset:2560
    s_waitcnt vmcnt(8)
    s_barrier
    s_waitcnt lgkmcnt(6)
    v_mfma_f32_32x32x16_bf16 v[192:207], v[40:43], a[0:3], 0
    ds_read_b64_tr_b16 v[60:61], v109 offset:2048
    ds_read_b64_tr_b16 v[62:63], v109 offset:2560
    s_add_u32 s43, s34, 688384
    s_add_u32 m0, s33, 32768
    s_nop 0
    buffer_load_dwordx4 v112, s[8:11], s43 offen offset:0 lds
    v_mfma_f32_32x32x16_bf16 v[208:223], v[44:47], a[0:3], 0
    ds_read_b64_tr_b16 v[64:65], v108 offset:10240
    ds_read_b64_tr_b16 v[66:67], v108 offset:10752
    s_waitcnt lgkmcnt(6)
    v_mfma_f32_32x32x16_bf16 v[224:239], v[48:51], a[0:3], 0
    ds_read_b64_tr_b16 v[68:69], v109 offset:10240
    ds_read_b64_tr_b16 v[70:71], v109 offset:10752
    buffer_load_dwordx4 v113, s[8:11], s43 offen offset:1024 lds
    v_cvt_pk_bf16_f32 v128, 0, v128
    v_cvt_pk_bf16_f32 v129, 0, v129
    v_cvt_pk_bf16_f32 v130, 0, v130
    v_mfma_f32_32x32x16_bf16 v[240:255], v[52:55], a[0:3], 0
    ds_read_b64_tr_b16 v[40:41], v108 offset:4096
    ds_read_b64_tr_b16 v[42:43], v108 offset:4608
    v_cvt_pk_bf16_f32 v131, 0, v131
    v_mul_f32 v18, s68, v128
    v_mul_f32 v19, s68, v129
    v_mul_f32 v20, s68, v130
    s_waitcnt lgkmcnt(6)
    v_mfma_f32_32x32x16_bf16 v[192:207], v[56:59], a[4:7], v[192:207]
    ds_read_b64_tr_b16 v[44:45], v109 offset:4096
    ds_read_b64_tr_b16 v[46:47], v109 offset:4608
    s_add_u32 m0, s33, 40960
    s_nop 0
    buffer_load_dwordx4 v112, s[12:15], s43 offen offset:0 lds
    v_mul_f32 v21, s68, v131
    v_mfma_f32_32x32x16_bf16 v[208:223], v[60:63], a[4:7], v[208:223]
    ds_read_b64_tr_b16 v[48:49], v108 offset:12288
    ds_read_b64_tr_b16 v[50:51], v108 offset:12800
    v_exp_f32 v18, v18
    v_exp_f32 v19, v19
    s_waitcnt lgkmcnt(6)
    v_mfma_f32_32x32x16_bf16 v[224:239], v[64:67], a[4:7], v[224:239]
    ds_read_b64_tr_b16 v[52:53], v109 offset:12288
    ds_read_b64_tr_b16 v[54:55], v109 offset:12800
    buffer_load_dwordx4 v113, s[12:15], s43 offen offset:1024 lds
    v_exp_f32 v20, v20
    v_mfma_f32_32x32x16_bf16 v[240:255], v[68:71], a[4:7], v[240:255]
    ds_read_b64_tr_b16 v[56:57], v108 offset:6144
    ds_read_b64_tr_b16 v[58:59], v108 offset:6656
    v_exp_f32 v21, v21
    v_cvt_pk_bf16_f32 v160, 0, v160
    v_cvt_pk_bf16_f32 v161, 0, v161
    s_waitcnt lgkmcnt(6)
    v_mfma_f32_32x32x16_bf16 v[192:207], v[40:43], a[8:11], v[192:207]
    ds_read_b64_tr_b16 v[60:61], v109 offset:6144
    ds_read_b64_tr_b16 v[62:63], v109 offset:6656
    s_add_u32 s43, s77, 688128
    s_add_u32 m0, s33, 49152
    s_mov_b64 exec, s[72:73]
    buffer_load_dwordx4 v112, s[8:11], s43 offen offset:0 lds
    s_mov_b64 exec, -1
    v_cvt_pk_bf16_f32 v162, 0, v162
    v_cvt_pk_bf16_f32 v163, 0, v163
    v_mfma_f32_32x32x16_bf16 v[208:223], v[44:47], a[8:11], v[208:223]
    ds_read_b64_tr_b16 v[64:65], v108 offset:14336
    ds_read_b64_tr_b16 v[66:67], v108 offset:14848
    v_add_f32 v18, 1.0, v18
    v_add_f32 v19, 1.0, v19
    v_add_f32 v20, 1.0, v20
    v_add_f32 v21, 1.0, v21
    s_waitcnt lgkmcnt(6)
    v_mfma_f32_32x32x16_bf16 v[224:239], v[48:51], a[8:11], v[224:239]
    ds_read_b64_tr_b16 v[68:69], v109 offset:14336
    ds_read_b64_tr_b16 v[70:71], v109 offset:14848
    s_mov_b64 exec, s[72:73]
    buffer_load_dwordx4 v113, s[8:11], s43 offen offset:1024 lds
    s_mov_b64 exec, -1
    v_rcp_f32 v18, v18
    v_rcp_f32 v19, v19
    v_mfma_f32_32x32x16_bf16 v[240:255], v[52:55], a[8:11], v[240:255]
    ds_read_b64_tr_b16 v[40:41], v108 offset:32768
    ds_read_b64_tr_b16 v[42:43], v108 offset:33280
    v_rcp_f32 v20, v20
    v_rcp_f32 v21, v21
    s_waitcnt lgkmcnt(6)
    v_mfma_f32_32x32x16_bf16 v[192:207], v[56:59], a[12:15], v[192:207]
    ds_read_b64_tr_b16 v[44:45], v109 offset:32768
    ds_read_b64_tr_b16 v[46:47], v109 offset:33280
    s_add_u32 m0, s33, 57344
    s_mov_b64 exec, s[72:73]
    buffer_load_dwordx4 v112, s[12:15], s43 offen offset:0 lds
    s_mov_b64 exec, -1
    s_nop 0
    v_mul_f32 v128, v128, v18
    v_mul_f32 v129, v129, v19
    v_mfma_f32_32x32x16_bf16 v[208:223], v[60:63], a[12:15], v[208:223]
    ds_read_b64_tr_b16 v[48:49], v108 offset:40960
    ds_read_b64_tr_b16 v[50:51], v108 offset:41472
    v_mul_f32 v130, v130, v20
    v_mul_f32 v131, v131, v21
    v_cvt_pk_bf16_f32 v128, 0, v128
    v_cvt_pk_bf16_f32 v129, 0, v129
    s_waitcnt lgkmcnt(6)
    v_mfma_f32_32x32x16_bf16 v[224:239], v[64:67], a[12:15], v[224:239]
    ds_read_b64_tr_b16 v[52:53], v109 offset:40960
    ds_read_b64_tr_b16 v[54:55], v109 offset:41472
    s_mov_b64 exec, s[72:73]
    buffer_load_dwordx4 v113, s[12:15], s43 offen offset:1024 lds
    s_mov_b64 exec, -1
    v_cvt_pk_bf16_f32 v130, 0, v130
    v_cvt_pk_bf16_f32 v131, 0, v131
    v_mul_f32 v128, v128, v160
    v_mul_f32 v129, v129, v161
    v_mfma_f32_32x32x16_bf16 v[240:255], v[68:71], a[12:15], v[240:255]
    ds_read_b64_tr_b16 v[56:57], v108 offset:34816
    ds_read_b64_tr_b16 v[58:59], v108 offset:35328
    v_mul_f32 v130, v130, v162
    v_mul_f32 v131, v131, v163
    v_cvt_pk_bf16_f32 v24, v128, v129
    v_cvt_pk_bf16_f32 v25, v130, v131
    s_waitcnt vmcnt(8)
    s_barrier
    s_waitcnt lgkmcnt(6)
    v_mfma_f32_32x32x16_bf16 v[192:207], v[40:43], a[16:19], v[192:207]
    ds_read_b64_tr_b16 v[60:61], v109 offset:34816
    ds_read_b64_tr_b16 v[62:63], v109 offset:35328
    s_add_u32 s43, s34, 917760
    s_add_u32 m0, s33, 65536
    s_nop 0
    buffer_load_dwordx4 v112, s[8:11], s43 offen offset:0 lds
    v_cvt_pk_bf16_f32 v132, 0, v132
    v_cvt_pk_bf16_f32 v133, 0, v133
    v_cvt_pk_bf16_f32 v134, 0, v134
    v_mfma_f32_32x32x16_bf16 v[208:223], v[44:47], a[16:19], v[208:223]
    ds_read_b64_tr_b16 v[64:65], v108 offset:43008
    ds_read_b64_tr_b16 v[66:67], v108 offset:43520
    v_cvt_pk_bf16_f32 v135, 0, v135
    v_mul_f32 v18, s68, v132
    v_mul_f32 v19, s68, v133
    v_mul_f32 v20, s68, v134
    s_waitcnt lgkmcnt(6)
    v_mfma_f32_32x32x16_bf16 v[224:239], v[48:51], a[16:19], v[224:239]
    ds_read_b64_tr_b16 v[68:69], v109 offset:43008
    ds_read_b64_tr_b16 v[70:71], v109 offset:43520
    buffer_load_dwordx4 v113, s[8:11], s43 offen offset:1024 lds
    v_mul_f32 v21, s68, v135
    v_exp_f32 v18, v18
    v_mfma_f32_32x32x16_bf16 v[240:255], v[52:55], a[16:19], v[240:255]
    ds_read_b64_tr_b16 v[40:41], v108 offset:36864
    ds_read_b64_tr_b16 v[42:43], v108 offset:37376
    v_exp_f32 v19, v19
    v_exp_f32 v20, v20
    s_waitcnt lgkmcnt(6)
    v_mfma_f32_32x32x16_bf16 v[192:207], v[56:59], a[20:23], v[192:207]
    ds_read_b64_tr_b16 v[44:45], v109 offset:36864
    ds_read_b64_tr_b16 v[46:47], v109 offset:37376
    s_add_u32 m0, s33, 73728
    s_nop 0
    buffer_load_dwordx4 v112, s[12:15], s43 offen offset:0 lds
    v_exp_f32 v21, v21
    v_cvt_pk_bf16_f32 v164, 0, v164
    v_cvt_pk_bf16_f32 v165, 0, v165
    v_mfma_f32_32x32x16_bf16 v[208:223], v[60:63], a[20:23], v[208:223]
    ds_read_b64_tr_b16 v[48:49], v108 offset:45056
    ds_read_b64_tr_b16 v[50:51], v108 offset:45568
    v_cvt_pk_bf16_f32 v166, 0, v166
    v_cvt_pk_bf16_f32 v167, 0, v167
    v_add_f32 v18, 1.0, v18
    v_add_f32 v19, 1.0, v19
    s_waitcnt lgkmcnt(6)
    v_mfma_f32_32x32x16_bf16 v[224:239], v[64:67], a[20:23], v[224:239]
    ds_read_b64_tr_b16 v[52:53], v109 offset:45056
    ds_read_b64_tr_b16 v[54:55], v109 offset:45568
    buffer_load_dwordx4 v113, s[12:15], s43 offen offset:1024 lds
    v_add_f32 v20, 1.0, v20
    v_add_f32 v21, 1.0, v21
    v_rcp_f32 v18, v18
    v_mfma_f32_32x32x16_bf16 v[240:255], v[68:71], a[20:23], v[240:255]
    ds_read_b64_tr_b16 v[56:57], v108 offset:38912
    ds_read_b64_tr_b16 v[58:59], v108 offset:39424
    v_rcp_f32 v19, v19
    v_rcp_f32 v20, v20
    s_waitcnt lgkmcnt(6)
    v_mfma_f32_32x32x16_bf16 v[192:207], v[40:43], a[24:27], v[192:207]
    ds_read_b64_tr_b16 v[60:61], v109 offset:38912
    ds_read_b64_tr_b16 v[62:63], v109 offset:39424
    s_add_u32 s43, s77, 917504
    s_add_u32 m0, s33, 81920
    s_mov_b64 exec, s[72:73]
    buffer_load_dwordx4 v112, s[8:11], s43 offen offset:0 lds
    s_mov_b64 exec, -1
    v_rcp_f32 v21, v21
    s_nop 0
    v_mfma_f32_32x32x16_bf16 v[208:223], v[44:47], a[24:27], v[208:223]
    ds_read_b64_tr_b16 v[64:65], v108 offset:47104
    ds_read_b64_tr_b16 v[66:67], v108 offset:47616
    v_mul_f32 v132, v132, v18
    v_mul_f32 v133, v133, v19
    v_mul_f32 v134, v134, v20
    v_mul_f32 v135, v135, v21
    s_waitcnt lgkmcnt(6)
    v_mfma_f32_32x32x16_bf16 v[224:239], v[48:51], a[24:27], v[224:239]
    ds_read_b64_tr_b16 v[68:69], v109 offset:47104
    ds_read_b64_tr_b16 v[70:71], v109 offset:47616
    s_mov_b64 exec, s[72:73]
    buffer_load_dwordx4 v113, s[8:11], s43 offen offset:1024 lds
    s_mov_b64 exec, -1
    v_cvt_pk_bf16_f32 v132, 0, v132
    v_cvt_pk_bf16_f32 v133, 0, v133
    v_cvt_pk_bf16_f32 v134, 0, v134
    v_mfma_f32_32x32x16_bf16 v[240:255], v[52:55], a[24:27], v[240:255]
    ds_read_b64_tr_b16 v[40:41], v114 offset:0
    ds_read_b64_tr_b16 v[42:43], v114 offset:512
    v_cvt_pk_bf16_f32 v135, 0, v135
    v_mul_f32 v132, v132, v164
    v_mul_f32 v133, v133, v165
    v_mul_f32 v134, v134, v166
    s_waitcnt lgkmcnt(6)
    v_mfma_f32_32x32x16_bf16 v[192:207], v[56:59], a[28:31], v[192:207]
    ds_read_b64_tr_b16 v[44:45], v115 offset:0
    ds_read_b64_tr_b16 v[46:47], v115 offset:512
    s_add_u32 m0, s33, 90112
    s_mov_b64 exec, s[72:73]
    buffer_load_dwordx4 v112, s[12:15], s43 offen offset:0 lds
    s_mov_b64 exec, -1
    v_mul_f32 v135, v135, v167
    v_cvt_pk_bf16_f32 v26, v132, v133
    v_cvt_pk_bf16_f32 v27, v134, v135
    v_mfma_f32_32x32x16_bf16 v[208:223], v[60:63], a[28:31], v[208:223]
    ds_read_b64_tr_b16 v[48:49], v114 offset:8192
    ds_read_b64_tr_b16 v[50:51], v114 offset:8704
    s_nop 1
    v_permlane32_swap_b32 v24, v26
    v_permlane32_swap_b32 v25, v27
    s_nop 0
    s_waitcnt lgkmcnt(6)
    v_mfma_f32_32x32x16_bf16 v[224:239], v[64:67], a[28:31], v[224:239]
    ds_read_b64_tr_b16 v[52:53], v115 offset:8192
    ds_read_b64_tr_b16 v[54:55], v115 offset:8704
    s_mov_b64 exec, s[72:73]
    buffer_load_dwordx4 v113, s[12:15], s43 offen offset:1024 lds
    s_mov_b64 exec, -1
    ds_write_b128 v106, v[24:27] offset:0
    v_cvt_pk_bf16_f32 v136, 0, v136
    v_cvt_pk_bf16_f32 v137, 0, v137
    v_cvt_pk_bf16_f32 v138, 0, v138
    v_mfma_f32_32x32x16_bf16 v[240:255], v[68:71], a[28:31], v[240:255]
    ds_read_b64_tr_b16 v[56:57], v114 offset:2048
    ds_read_b64_tr_b16 v[58:59], v114 offset:2560
    v_cvt_pk_bf16_f32 v139, 0, v139
    v_mul_f32 v18, s68, v136
    v_mul_f32 v19, s68, v137
    v_mul_f32 v20, s68, v138
    s_waitcnt vmcnt(8)
    s_barrier
    s_waitcnt lgkmcnt(7)
    v_mfma_f32_32x32x16_bf16 v[192:207], v[40:43], a[32:35], v[192:207]
    ds_read_b64_tr_b16 v[60:61], v115 offset:2048
    ds_read_b64_tr_b16 v[62:63], v115 offset:2560
    s_add_u32 s43, s34, 1147136
    s_add_u32 m0, s33, 98304
    s_nop 0
    buffer_load_dwordx4 v112, s[8:11], s43 offen offset:0 lds
    v_mul_f32 v21, s68, v139
    v_exp_f32 v18, v18
    v_mfma_f32_32x32x16_bf16 v[208:223], v[44:47], a[32:35], v[208:223]
    ds_read_b64_tr_b16 v[64:65], v114 offset:10240
    ds_read_b64_tr_b16 v[66:67], v114 offset:10752
    v_exp_f32 v19, v19
    v_exp_f32 v20, v20
    s_waitcnt lgkmcnt(7)
    v_mfma_f32_32x32x16_bf16 v[224:239], v[48:51], a[32:35], v[224:239]
    ds_read_b64_tr_b16 v[68:69], v115 offset:10240
    ds_read_b64_tr_b16 v[70:71], v115 offset:10752
    buffer_load_dwordx4 v113, s[8:11], s43 offen offset:1024 lds
    v_exp_f32 v21, v21
    v_cvt_pk_bf16_f32 v168, 0, v168
    v_cvt_pk_bf16_f32 v169, 0, v169
    v_mfma_f32_32x32x16_bf16 v[240:255], v[52:55], a[32:35], v[240:255]
    ds_read_b64_tr_b16 v[40:41], v114 offset:4096
    ds_read_b64_tr_b16 v[42:43], v114 offset:4608
    v_cvt_pk_bf16_f32 v170, 0, v170
    v_cvt_pk_bf16_f32 v171, 0, v171
    v_add_f32 v18, 1.0, v18
    v_add_f32 v19, 1.0, v19
    s_waitcnt lgkmcnt(6)
    v_mfma_f32_32x32x16_bf16 v[192:207], v[56:59], a[36:39], v[192:207]
    ds_read_b64_tr_b16 v[44:45], v115 offset:4096
    ds_read_b64_tr_b16 v[46:47], v115 offset:4608
    s_add_u32 m0, s33, 106496
    s_nop 0
    buffer_load_dwordx4 v112, s[12:15], s43 offen offset:0 lds
    v_add_f32 v20, 1.0, v20
    v_add_f32 v21, 1.0, v21
    v_rcp_f32 v18, v18
    v_mfma_f32_32x32x16_bf16 v[208:223], v[60:63], a[36:39], v[208:223]
    ds_read_b64_tr_b16 v[48:49], v114 offset:12288
    ds_read_b64_tr_b16 v[50:51], v114 offset:12800
    v_rcp_f32 v19, v19
    v_rcp_f32 v20, v20
    s_waitcnt lgkmcnt(6)
    v_mfma_f32_32x32x16_bf16 v[224:239], v[64:67], a[36:39], v[224:239]
    ds_read_b64_tr_b16 v[52:53], v115 offset:12288
    ds_read_b64_tr_b16 v[54:55], v115 offset:12800
    buffer_load_dwordx4 v113, s[12:15], s43 offen offset:1024 lds
    v_rcp_f32 v21, v21
    s_nop 0
    v_mfma_f32_32x32x16_bf16 v[240:255], v[68:71], a[36:39], v[240:255]
    ds_read_b64_tr_b16 v[56:57], v114 offset:6144
    ds_read_b64_tr_b16 v[58:59], v114 offset:6656
    v_mul_f32 v136, v136, v18
    v_mul_f32 v137, v137, v19
    v_mul_f32 v138, v138, v20
    v_mul_f32 v139, v139, v21
    s_waitcnt lgkmcnt(6)
    v_mfma_f32_32x32x16_bf16 v[192:207], v[40:43], a[40:43], v[192:207]
    ds_read_b64_tr_b16 v[60:61], v115 offset:6144
    ds_read_b64_tr_b16 v[62:63], v115 offset:6656
    s_add_u32 s43, s77, 1146880
    s_add_u32 m0, s33, 114688
    s_mov_b64 exec, s[72:73]
    buffer_load_dwordx4 v112, s[8:11], s43 offen offset:0 lds
    s_mov_b64 exec, -1
    v_cvt_pk_bf16_f32 v136, 0, v136
    v_cvt_pk_bf16_f32 v137, 0, v137
    v_cvt_pk_bf16_f32 v138, 0, v138
    v_mfma_f32_32x32x16_bf16 v[208:223], v[44:47], a[40:43], v[208:223]
    ds_read_b64_tr_b16 v[64:65], v114 offset:14336
    ds_read_b64_tr_b16 v[66:67], v114 offset:14848
    v_cvt_pk_bf16_f32 v139, 0, v139
    v_mul_f32 v136, v136, v168
    v_mul_f32 v137, v137, v169
    v_mul_f32 v138, v138, v170
    s_waitcnt lgkmcnt(6)
    v_mfma_f32_32x32x16_bf16 v[224:239], v[48:51], a[40:43], v[224:239]
    ds_read_b64_tr_b16 v[68:69], v115 offset:14336
    ds_read_b64_tr_b16 v[70:71], v115 offset:14848
    s_mov_b64 exec, s[72:73]
    buffer_load_dwordx4 v113, s[8:11], s43 offen offset:1024 lds
    s_mov_b64 exec, -1
    v_mul_f32 v139, v139, v171
    v_cvt_pk_bf16_f32 v28, v136, v137
    v_cvt_pk_bf16_f32 v29, v138, v139
    v_mfma_f32_32x32x16_bf16 v[240:255], v[52:55], a[40:43], v[240:255]
    ds_read_b64_tr_b16 v[40:41], v114 offset:32768
    ds_read_b64_tr_b16 v[42:43], v114 offset:33280
    v_cvt_pk_bf16_f32 v140, 0, v140
    v_cvt_pk_bf16_f32 v141, 0, v141
    v_cvt_pk_bf16_f32 v142, 0, v142
    v_cvt_pk_bf16_f32 v143, 0, v143
    s_waitcnt lgkmcnt(6)
    v_mfma_f32_32x32x16_bf16 v[192:207], v[56:59], a[44:47], v[192:207]
    ds_read_b64_tr_b16 v[44:45], v115 offset:32768
    ds_read_b64_tr_b16 v[46:47], v115 offset:33280
    s_add_u32 m0, s33, 122880
    s_mov_b64 exec, s[72:73]
    buffer_load_dwordx4 v112, s[12:15], s43 offen offset:0 lds
    s_mov_b64 exec, -1
    v_mul_f32 v18, s68, v140
    v_mul_f32 v19, s68, v141
    v_mul_f32 v20, s68, v142
    v_mul_f32 v21, s68, v143
    v_mfma_f32_32x32x16_bf16 v[208:223], v[60:63], a[44:47], v[208:223]
    ds_read_b64_tr_b16 v[48:49], v114 offset:40960
    ds_read_b64_tr_b16 v[50:51], v114 offset:41472
    v_exp_f32 v18, v18
    v_exp_f32 v19, v19
    s_waitcnt lgkmcnt(6)
    v_mfma_f32_32x32x16_bf16 v[224:239], v[64:67], a[44:47], v[224:239]
    ds_read_b64_tr_b16 v[52:53], v115 offset:40960
    ds_read_b64_tr_b16 v[54:55], v115 offset:41472
    s_mov_b64 exec, s[72:73]
    buffer_load_dwordx4 v113, s[12:15], s43 offen offset:1024 lds
    s_mov_b64 exec, -1
    v_exp_f32 v20, v20
    v_exp_f32 v21, v21
    v_mfma_f32_32x32x16_bf16 v[240:255], v[68:71], a[44:47], v[240:255]
    ds_read_b64_tr_b16 v[56:57], v114 offset:34816
    ds_read_b64_tr_b16 v[58:59], v114 offset:35328
    v_cvt_pk_bf16_f32 v172, 0, v172
    v_cvt_pk_bf16_f32 v173, 0, v173
    v_cvt_pk_bf16_f32 v174, 0, v174
    v_cvt_pk_bf16_f32 v175, 0, v175
    s_waitcnt vmcnt(8)
    s_barrier
    s_waitcnt lgkmcnt(6)
    v_mfma_f32_32x32x16_bf16 v[192:207], v[40:43], a[48:51], v[192:207]
    ds_read_b64_tr_b16 v[60:61], v115 offset:34816
    ds_read_b64_tr_b16 v[62:63], v115 offset:35328
    s_add_u32 s43, s34, 1376512
    s_add_u32 m0, s33, 0
    s_nop 0
    buffer_load_dwordx4 v112, s[8:11], s43 offen offset:0 lds
    v_add_f32 v18, 1.0, v18
    v_add_f32 v19, 1.0, v19
    v_mfma_f32_32x32x16_bf16 v[208:223], v[44:47], a[48:51], v[208:223]
    ds_read_b64_tr_b16 v[64:65], v114 offset:43008
    ds_read_b64_tr_b16 v[66:67], v114 offset:43520
    v_add_f32 v20, 1.0, v20
    v_add_f32 v21, 1.0, v21
    v_rcp_f32 v18, v18
    s_waitcnt lgkmcnt(6)
    v_mfma_f32_32x32x16_bf16 v[224:239], v[48:51], a[48:51], v[224:239]
    ds_read_b64_tr_b16 v[68:69], v115 offset:43008
    ds_read_b64_tr_b16 v[70:71], v115 offset:43520
    buffer_load_dwordx4 v113, s[8:11], s43 offen offset:1024 lds
    v_rcp_f32 v19, v19
    v_rcp_f32 v20, v20
    v_mfma_f32_32x32x16_bf16 v[240:255], v[52:55], a[48:51], v[240:255]
    ds_read_b64_tr_b16 v[40:41], v114 offset:36864
    ds_read_b64_tr_b16 v[42:43], v114 offset:37376
    v_rcp_f32 v21, v21
    s_nop 0
    v_mul_f32 v140, v140, v18
    s_waitcnt lgkmcnt(6)
    v_mfma_f32_32x32x16_bf16 v[192:207], v[56:59], a[52:55], v[192:207]
    ds_read_b64_tr_b16 v[44:45], v115 offset:36864
    ds_read_b64_tr_b16 v[46:47], v115 offset:37376
    s_add_u32 m0, s33, 8192
    s_nop 0
    buffer_load_dwordx4 v112, s[12:15], s43 offen offset:0 lds
    v_mul_f32 v141, v141, v19
    v_mul_f32 v142, v142, v20
    v_mul_f32 v143, v143, v21
    v_mfma_f32_32x32x16_bf16 v[208:223], v[60:63], a[52:55], v[208:223]
    ds_read_b64_tr_b16 v[48:49], v114 offset:45056
    ds_read_b64_tr_b16 v[50:51], v114 offset:45568
    v_cvt_pk_bf16_f32 v140, 0, v140
    v_cvt_pk_bf16_f32 v141, 0, v141
    v_cvt_pk_bf16_f32 v142, 0, v142
    v_cvt_pk_bf16_f32 v143, 0, v143
    s_waitcnt lgkmcnt(6)
    v_mfma_f32_32x32x16_bf16 v[224:239], v[64:67], a[52:55], v[224:239]
    ds_read_b64_tr_b16 v[52:53], v115 offset:45056
    ds_read_b64_tr_b16 v[54:55], v115 offset:45568
    buffer_load_dwordx4 v113, s[12:15], s43 offen offset:1024 lds
    v_mul_f32 v140, v140, v172
    v_mul_f32 v141, v141, v173
    v_mul_f32 v142, v142, v174
    v_mul_f32 v143, v143, v175
    v_mfma_f32_32x32x16_bf16 v[240:255], v[68:71], a[52:55], v[240:255]
    ds_read_b64_tr_b16 v[56:57], v114 offset:38912
    ds_read_b64_tr_b16 v[58:59], v114 offset:39424
    v_cvt_pk_bf16_f32 v30, v140, v141
    v_cvt_pk_bf16_f32 v31, v142, v143
    s_nop 1
    v_permlane32_swap_b32 v28, v30
    s_waitcnt lgkmcnt(6)
    v_mfma_f32_32x32x16_bf16 v[192:207], v[40:43], a[56:59], v[192:207]
    ds_read_b64_tr_b16 v[60:61], v115 offset:38912
    ds_read_b64_tr_b16 v[62:63], v115 offset:39424
    s_add_u32 s43, s77, 1376256
    s_add_u32 m0, s33, 16384
    s_mov_b64 exec, s[72:73]
    buffer_load_dwordx4 v112, s[8:11], s43 offen offset:0 lds
    s_mov_b64 exec, -1
    v_permlane32_swap_b32 v29, v31
    s_nop 0
    ds_write_b128 v106, v[28:31] offset:1024
    v_mfma_f32_32x32x16_bf16 v[208:223], v[44:47], a[56:59], v[208:223]
    ds_read_b64_tr_b16 v[64:65], v114 offset:47104
    ds_read_b64_tr_b16 v[66:67], v114 offset:47616
    v_cvt_pk_bf16_f32 v144, 0, v144
    v_cvt_pk_bf16_f32 v145, 0, v145
    v_cvt_pk_bf16_f32 v146, 0, v146
    v_cvt_pk_bf16_f32 v147, 0, v147
    s_waitcnt lgkmcnt(7)
    v_mfma_f32_32x32x16_bf16 v[224:239], v[48:51], a[56:59], v[224:239]
    ds_read_b64_tr_b16 v[68:69], v115 offset:47104
    ds_read_b64_tr_b16 v[70:71], v115 offset:47616
    s_mov_b64 exec, s[72:73]
    buffer_load_dwordx4 v113, s[8:11], s43 offen offset:1024 lds
    s_mov_b64 exec, -1
    v_mul_f32 v18, s68, v144
    v_mul_f32 v19, s68, v145
    v_mul_f32 v20, s68, v146
    v_mfma_f32_32x32x16_bf16 v[240:255], v[52:55], a[56:59], v[240:255]
    ds_read_b64_tr_b16 v[40:41], v108 offset:0
    ds_read_b64_tr_b16 v[42:43], v108 offset:512
    v_mul_f32 v21, s68, v147
    v_exp_f32 v18, v18
    v_exp_f32 v19, v19
    s_waitcnt lgkmcnt(7)
    v_mfma_f32_32x32x16_bf16 v[192:207], v[56:59], a[60:63], v[192:207]
    ds_read_b64_tr_b16 v[44:45], v109 offset:0
    ds_read_b64_tr_b16 v[46:47], v109 offset:512
    s_add_u32 m0, s33, 24576
    s_mov_b64 exec, s[72:73]
    buffer_load_dwordx4 v112, s[12:15], s43 offen offset:0 lds
    s_mov_b64 exec, -1
    v_exp_f32 v20, v20
    v_exp_f32 v21, v21
    v_mfma_f32_32x32x16_bf16 v[208:223], v[60:63], a[60:63], v[208:223]
    ds_read_b64_tr_b16 v[48:49], v108 offset:8192
    ds_read_b64_tr_b16 v[50:51], v108 offset:8704
    v_cvt_pk_bf16_f32 v176, 0, v176
    v_cvt_pk_bf16_f32 v177, 0, v177
    v_cvt_pk_bf16_f32 v178, 0, v178
    v_cvt_pk_bf16_f32 v179, 0, v179
    s_waitcnt lgkmcnt(6)
    v_mfma_f32_32x32x16_bf16 v[224:239], v[64:67], a[60:63], v[224:239]
    ds_read_b64_tr_b16 v[52:53], v109 offset:8192
    ds_read_b64_tr_b16 v[54:55], v109 offset:8704
    s_mov_b64 exec, s[72:73]
    buffer_load_dwordx4 v113, s[12:15], s43 offen offset:1024 lds
    s_mov_b64 exec, -1
    v_add_f32 v18, 1.0, v18
    v_add_f32 v19, 1.0, v19
    v_mfma_f32_32x32x16_bf16 v[240:255], v[68:71], a[60:63], v[240:255]
    ds_read_b64_tr_b16 v[56:57], v108 offset:2048
    ds_read_b64_tr_b16 v[58:59], v108 offset:2560
    v_add_f32 v20, 1.0, v20
    v_add_f32 v21, 1.0, v21
    v_rcp_f32 v18, v18
    s_waitcnt vmcnt(8)
    s_barrier
    s_waitcnt lgkmcnt(6)
    v_mfma_f32_32x32x16_bf16 v[192:207], v[40:43], a[64:67], v[192:207]
    ds_read_b64_tr_b16 v[60:61], v109 offset:2048
    ds_read_b64_tr_b16 v[62:63], v109 offset:2560
    s_add_u32 m0, s37, 32768
    s_add_u32 s43, s36, 0
    buffer_load_dwordx4 v116, s[16:19], s43 offen lds
    v_rcp_f32 v19, v19
    v_rcp_f32 v20, v20
    v_mfma_f32_32x32x16_bf16 v[208:223], v[44:47], a[64:67], v[208:223]
    ds_read_b64_tr_b16 v[64:65], v108 offset:10240
    ds_read_b64_tr_b16 v[66:67], v108 offset:10752
    v_rcp_f32 v21, v21
    s_nop 0
    v_mul_f32 v144, v144, v18
    s_waitcnt lgkmcnt(6)
    v_mfma_f32_32x32x16_bf16 v[224:239], v[48:51], a[64:67], v[224:239]
    ds_read_b64_tr_b16 v[68:69], v109 offset:10240
    ds_read_b64_tr_b16 v[70:71], v109 offset:10752
    s_add_u32 m0, s37, 36864
    s_add_u32 s43, s36, 128
    buffer_load_dwordx4 v116, s[16:19], s43 offen lds
    v_mul_f32 v145, v145, v19
    v_mul_f32 v146, v146, v20
    v_mul_f32 v147, v147, v21
    v_mfma_f32_32x32x16_bf16 v[240:255], v[52:55], a[64:67], v[240:255]
    ds_read_b64_tr_b16 v[40:41], v108 offset:4096
    ds_read_b64_tr_b16 v[42:43], v108 offset:4608
    v_cvt_pk_bf16_f32 v144, 0, v144
    v_cvt_pk_bf16_f32 v145, 0, v145
    v_cvt_pk_bf16_f32 v146, 0, v146
    v_cvt_pk_bf16_f32 v147, 0, v147
    s_waitcnt lgkmcnt(6)
    v_mfma_f32_32x32x16_bf16 v[192:207], v[56:59], a[68:71], v[192:207]
    ds_read_b64_tr_b16 v[44:45], v109 offset:4096
    ds_read_b64_tr_b16 v[46:47], v109 offset:4608
    s_add_u32 m0, s37, 40960
    s_add_u32 s43, s36, 256
    buffer_load_dwordx4 v116, s[16:19], s43 offen lds
    v_mul_f32 v144, v144, v176
    v_mul_f32 v145, v145, v177
    v_mul_f32 v146, v146, v178
    v_mfma_f32_32x32x16_bf16 v[208:223], v[60:63], a[68:71], v[208:223]
    ds_read_b64_tr_b16 v[48:49], v108 offset:12288
    ds_read_b64_tr_b16 v[50:51], v108 offset:12800
    v_mul_f32 v147, v147, v179
    v_cvt_pk_bf16_f32 v32, v144, v145
    v_cvt_pk_bf16_f32 v33, v146, v147
    v_cvt_pk_bf16_f32 v148, 0, v148
    s_waitcnt lgkmcnt(6)
    v_mfma_f32_32x32x16_bf16 v[224:239], v[64:67], a[68:71], v[224:239]
    ds_read_b64_tr_b16 v[52:53], v109 offset:12288
    ds_read_b64_tr_b16 v[54:55], v109 offset:12800
    s_add_u32 m0, s37, 45056
    s_add_u32 s43, s36, 384
    buffer_load_dwordx4 v116, s[16:19], s43 offen lds
    v_cvt_pk_bf16_f32 v149, 0, v149
    v_cvt_pk_bf16_f32 v150, 0, v150
    v_cvt_pk_bf16_f32 v151, 0, v151
    v_mul_f32 v18, s68, v148
    v_mfma_f32_32x32x16_bf16 v[240:255], v[68:71], a[68:71], v[240:255]
    ds_read_b64_tr_b16 v[56:57], v108 offset:6144
    ds_read_b64_tr_b16 v[58:59], v108 offset:6656
    v_mul_f32 v19, s68, v149
    v_mul_f32 v20, s68, v150
    v_mul_f32 v21, s68, v151
    v_exp_f32 v18, v18
    s_waitcnt lgkmcnt(6)
    v_mfma_f32_32x32x16_bf16 v[192:207], v[40:43], a[72:75], v[192:207]
    ds_read_b64_tr_b16 v[60:61], v109 offset:6144
    ds_read_b64_tr_b16 v[62:63], v109 offset:6656
    s_add_u32 m0, s37, 49152
    s_add_u32 s43, s36, 512
    buffer_load_dwordx4 v116, s[16:19], s43 offen lds
    v_exp_f32 v19, v19
    v_mfma_f32_32x32x16_bf16 v[208:223], v[44:47], a[72:75], v[208:223]
    ds_read_b64_tr_b16 v[64:65], v108 offset:14336
    ds_read_b64_tr_b16 v[66:67], v108 offset:14848
    v_exp_f32 v20, v20
    v_exp_f32 v21, v21
    s_waitcnt lgkmcnt(6)
    v_mfma_f32_32x32x16_bf16 v[224:239], v[48:51], a[72:75], v[224:239]
    ds_read_b64_tr_b16 v[68:69], v109 offset:14336
    ds_read_b64_tr_b16 v[70:71], v109 offset:14848
    s_add_u32 m0, s37, 53248
    s_add_u32 s43, s36, 640
    buffer_load_dwordx4 v116, s[16:19], s43 offen lds
    v_cvt_pk_bf16_f32 v180, 0, v180
    v_cvt_pk_bf16_f32 v181, 0, v181
    v_cvt_pk_bf16_f32 v182, 0, v182
    v_cvt_pk_bf16_f32 v183, 0, v183
    v_mfma_f32_32x32x16_bf16 v[240:255], v[52:55], a[72:75], v[240:255]
    ds_read_b64_tr_b16 v[40:41], v108 offset:32768
    ds_read_b64_tr_b16 v[42:43], v108 offset:33280
    v_add_f32 v18, 1.0, v18
    v_add_f32 v19, 1.0, v19
    v_add_f32 v20, 1.0, v20
    v_add_f32 v21, 1.0, v21
    s_waitcnt lgkmcnt(6)
    v_mfma_f32_32x32x16_bf16 v[192:207], v[56:59], a[76:79], v[192:207]
    ds_read_b64_tr_b16 v[44:45], v109 offset:32768
    ds_read_b64_tr_b16 v[46:47], v109 offset:33280
    s_add_u32 m0, s37, 57344
    s_add_u32 s43, s36, 768
    buffer_load_dwordx4 v116, s[16:19], s43 offen lds
    v_rcp_f32 v18, v18
    v_rcp_f32 v19, v19
    v_mfma_f32_32x32x16_bf16 v[208:223], v[60:63], a[76:79], v[208:223]
    ds_read_b64_tr_b16 v[48:49], v108 offset:40960
    ds_read_b64_tr_b16 v[50:51], v108 offset:41472
    v_rcp_f32 v20, v20
    v_rcp_f32 v21, v21
    s_waitcnt lgkmcnt(6)
    v_mfma_f32_32x32x16_bf16 v[224:239], v[64:67], a[76:79], v[224:239]
    ds_read_b64_tr_b16 v[52:53], v109 offset:40960
    ds_read_b64_tr_b16 v[54:55], v109 offset:41472
    s_nop 0
    v_mul_f32 v148, v148, v18
    v_mul_f32 v149, v149, v19
    v_mul_f32 v150, v150, v20
    v_mfma_f32_32x32x16_bf16 v[240:255], v[68:71], a[76:79], v[240:255]
    ds_read_b64_tr_b16 v[56:57], v108 offset:34816
    ds_read_b64_tr_b16 v[58:59], v108 offset:35328
    v_mul_f32 v151, v151, v21
    v_cvt_pk_bf16_f32 v148, 0, v148
    v_cvt_pk_bf16_f32 v149, 0, v149
    v_cvt_pk_bf16_f32 v150, 0, v150
    s_waitcnt vmcnt(7)
    s_barrier
    s_waitcnt lgkmcnt(6)
    v_mfma_f32_32x32x16_bf16 v[192:207], v[40:43], a[80:83], v[192:207]
    ds_read_b64_tr_b16 v[60:61], v109 offset:34816
    ds_read_b64_tr_b16 v[62:63], v109 offset:35328
    s_add_u32 m0, s37, 65536
    s_add_u32 s43, s36, 28672
    buffer_load_dwordx4 v116, s[16:19], s43 offen lds
    v_cvt_pk_bf16_f32 v151, 0, v151
    v_mul_f32 v148, v148, v180
    v_mfma_f32_32x32x16_bf16 v[208:223], v[44:47], a[80:83], v[208:223]
    ds_read_b64_tr_b16 v[64:65], v108 offset:43008
    ds_read_b64_tr_b16 v[66:67], v108 offset:43520
    v_mul_f32 v149, v149, v181
    v_mul_f32 v150, v150, v182
    v_mul_f32 v151, v151, v183
    v_cvt_pk_bf16_f32 v34, v148, v149
    s_waitcnt lgkmcnt(6)
    v_mfma_f32_32x32x16_bf16 v[224:239], v[48:51], a[80:83], v[224:239]
    ds_read_b64_tr_b16 v[68:69], v109 offset:43008
    ds_read_b64_tr_b16 v[70:71], v109 offset:43520
    s_add_u32 m0, s37, 69632
    s_add_u32 s43, s36, 28800
    buffer_load_dwordx4 v116, s[16:19], s43 offen lds
    v_cvt_pk_bf16_f32 v35, v150, v151
    s_nop 1
    v_permlane32_swap_b32 v32, v34
    v_mfma_f32_32x32x16_bf16 v[240:255], v[52:55], a[80:83], v[240:255]
    ds_read_b64_tr_b16 v[40:41], v108 offset:36864
    ds_read_b64_tr_b16 v[42:43], v108 offset:37376
    v_permlane32_swap_b32 v33, v35
    s_nop 0
    ds_write_b128 v106, v[32:35] offset:2048
    v_cvt_pk_bf16_f32 v152, 0, v152
    s_waitcnt lgkmcnt(7)
    v_mfma_f32_32x32x16_bf16 v[192:207], v[56:59], a[84:87], v[192:207]
    ds_read_b64_tr_b16 v[44:45], v109 offset:36864
    ds_read_b64_tr_b16 v[46:47], v109 offset:37376
    s_add_u32 m0, s37, 73728
    s_add_u32 s43, s36, 28928
    buffer_load_dwordx4 v116, s[16:19], s43 offen lds
    v_cvt_pk_bf16_f32 v153, 0, v153
    v_cvt_pk_bf16_f32 v154, 0, v154
    v_cvt_pk_bf16_f32 v155, 0, v155
    v_mul_f32 v18, s68, v152
    v_mfma_f32_32x32x16_bf16 v[208:223], v[60:63], a[84:87], v[208:223]
    ds_read_b64_tr_b16 v[48:49], v108 offset:45056
    ds_read_b64_tr_b16 v[50:51], v108 offset:45568
    v_mul_f32 v19, s68, v153
    v_mul_f32 v20, s68, v154
    v_mul_f32 v21, s68, v155
    s_waitcnt lgkmcnt(7)
    v_mfma_f32_32x32x16_bf16 v[224:239], v[64:67], a[84:87], v[224:239]
    ds_read_b64_tr_b16 v[52:53], v109 offset:45056
    ds_read_b64_tr_b16 v[54:55], v109 offset:45568
    s_add_u32 m0, s37, 77824
    s_add_u32 s43, s36, 29056
    buffer_load_dwordx4 v116, s[16:19], s43 offen lds
    v_exp_f32 v18, v18
    v_exp_f32 v19, v19
    v_mfma_f32_32x32x16_bf16 v[240:255], v[68:71], a[84:87], v[240:255]
    ds_read_b64_tr_b16 v[56:57], v108 offset:38912
    ds_read_b64_tr_b16 v[58:59], v108 offset:39424
    v_exp_f32 v20, v20
    v_exp_f32 v21, v21
    s_waitcnt lgkmcnt(6)
    v_mfma_f32_32x32x16_bf16 v[192:207], v[40:43], a[88:91], v[192:207]
    ds_read_b64_tr_b16 v[60:61], v109 offset:38912
    ds_read_b64_tr_b16 v[62:63], v109 offset:39424
    s_add_u32 m0, s37, 81920
    s_add_u32 s43, s36, 29184
    buffer_load_dwordx4 v116, s[16:19], s43 offen lds
    v_cvt_pk_bf16_f32 v184, 0, v184
    v_cvt_pk_bf16_f32 v185, 0, v185
    v_cvt_pk_bf16_f32 v186, 0, v186
    v_mfma_f32_32x32x16_bf16 v[208:223], v[44:47], a[88:91], v[208:223]
    ds_read_b64_tr_b16 v[64:65], v108 offset:47104
    ds_read_b64_tr_b16 v[66:67], v108 offset:47616
    v_cvt_pk_bf16_f32 v187, 0, v187
    v_add_f32 v18, 1.0, v18
    v_add_f32 v19, 1.0, v19
    v_add_f32 v20, 1.0, v20
    s_waitcnt lgkmcnt(6)
    v_mfma_f32_32x32x16_bf16 v[224:239], v[48:51], a[88:91], v[224:239]
    ds_read_b64_tr_b16 v[68:69], v109 offset:47104
    ds_read_b64_tr_b16 v[70:71], v109 offset:47616
    s_add_u32 m0, s37, 86016
    s_add_u32 s43, s36, 29312
    buffer_load_dwordx4 v116, s[16:19], s43 offen lds
    v_add_f32 v21, 1.0, v21
    v_rcp_f32 v18, v18
    v_rcp_f32 v19, v19
    v_mfma_f32_32x32x16_bf16 v[240:255], v[52:55], a[88:91], v[240:255]
    ds_read_b64_tr_b16 v[40:41], v114 offset:0
    ds_read_b64_tr_b16 v[42:43], v114 offset:512
    v_rcp_f32 v20, v20
    v_rcp_f32 v21, v21
    s_waitcnt lgkmcnt(6)
    v_mfma_f32_32x32x16_bf16 v[192:207], v[56:59], a[92:95], v[192:207]
    ds_read_b64_tr_b16 v[44:45], v115 offset:0
    ds_read_b64_tr_b16 v[46:47], v115 offset:512
    s_add_u32 m0, s37, 90112
    s_add_u32 s43, s36, 29440
    buffer_load_dwordx4 v116, s[16:19], s43 offen lds
    s_nop 0
    v_mul_f32 v152, v152, v18
    v_mfma_f32_32x32x16_bf16 v[208:223], v[60:63], a[92:95], v[208:223]
    ds_read_b64_tr_b16 v[48:49], v114 offset:8192
    ds_read_b64_tr_b16 v[50:51], v114 offset:8704
    v_mul_f32 v153, v153, v19
    v_mul_f32 v154, v154, v20
    v_mul_f32 v155, v155, v21
    v_cvt_pk_bf16_f32 v152, 0, v152
    s_waitcnt lgkmcnt(6)
    v_mfma_f32_32x32x16_bf16 v[224:239], v[64:67], a[92:95], v[224:239]
    ds_read_b64_tr_b16 v[52:53], v115 offset:8192
    ds_read_b64_tr_b16 v[54:55], v115 offset:8704
    v_cvt_pk_bf16_f32 v153, 0, v153
    v_cvt_pk_bf16_f32 v154, 0, v154
    v_cvt_pk_bf16_f32 v155, 0, v155
    v_mul_f32 v152, v152, v184
    v_mfma_f32_32x32x16_bf16 v[240:255], v[68:71], a[92:95], v[240:255]
    ds_read_b64_tr_b16 v[56:57], v114 offset:2048
    ds_read_b64_tr_b16 v[58:59], v114 offset:2560
    v_mul_f32 v153, v153, v185
    v_mul_f32 v154, v154, v186
    v_mul_f32 v155, v155, v187
    v_cvt_pk_bf16_f32 v36, v152, v153
    s_waitcnt vmcnt(7)
    s_barrier
    s_waitcnt lgkmcnt(6)
    v_mfma_f32_32x32x16_bf16 v[192:207], v[40:43], a[96:99], v[192:207]
    ds_read_b64_tr_b16 v[60:61], v115 offset:2048
    ds_read_b64_tr_b16 v[62:63], v115 offset:2560
    s_add_u32 m0, s37, 98304
    s_add_u32 s43, s36, 57344
    buffer_load_dwordx4 v116, s[16:19], s43 offen lds
    v_cvt_pk_bf16_f32 v37, v154, v155
    v_cvt_pk_bf16_f32 v156, 0, v156
    v_cvt_pk_bf16_f32 v157, 0, v157
    v_mfma_f32_32x32x16_bf16 v[208:223], v[44:47], a[96:99], v[208:223]
    ds_read_b64_tr_b16 v[64:65], v114 offset:10240
    ds_read_b64_tr_b16 v[66:67], v114 offset:10752
    v_cvt_pk_bf16_f32 v158, 0, v158
    v_cvt_pk_bf16_f32 v159, 0, v159
    v_mul_f32 v18, s68, v156
    v_mul_f32 v19, s68, v157
    s_waitcnt lgkmcnt(6)
    v_mfma_f32_32x32x16_bf16 v[224:239], v[48:51], a[96:99], v[224:239]
    ds_read_b64_tr_b16 v[68:69], v115 offset:10240
    ds_read_b64_tr_b16 v[70:71], v115 offset:10752
    s_add_u32 m0, s37, 102400
    s_add_u32 s43, s36, 57472
    buffer_load_dwordx4 v116, s[16:19], s43 offen lds
    v_mul_f32 v20, s68, v158
    v_mul_f32 v21, s68, v159
    v_exp_f32 v18, v18
    v_mfma_f32_32x32x16_bf16 v[240:255], v[52:55], a[96:99], v[240:255]
    ds_read_b64_tr_b16 v[40:41], v114 offset:4096
    ds_read_b64_tr_b16 v[42:43], v114 offset:4608
    v_exp_f32 v19, v19
    v_exp_f32 v20, v20
    s_waitcnt lgkmcnt(6)
    v_mfma_f32_32x32x16_bf16 v[192:207], v[56:59], a[100:103], v[192:207]
    ds_read_b64_tr_b16 v[44:45], v115 offset:4096
    ds_read_b64_tr_b16 v[46:47], v115 offset:4608
    s_add_u32 m0, s37, 106496
    s_add_u32 s43, s36, 57600
    buffer_load_dwordx4 v116, s[16:19], s43 offen lds
    v_exp_f32 v21, v21
    v_cvt_pk_bf16_f32 v188, 0, v188
    v_mfma_f32_32x32x16_bf16 v[208:223], v[60:63], a[100:103], v[208:223]
    ds_read_b64_tr_b16 v[48:49], v114 offset:12288
    ds_read_b64_tr_b16 v[50:51], v114 offset:12800
    v_cvt_pk_bf16_f32 v189, 0, v189
    v_cvt_pk_bf16_f32 v190, 0, v190
    v_cvt_pk_bf16_f32 v191, 0, v191
    v_add_f32 v18, 1.0, v18
    s_waitcnt lgkmcnt(6)
    v_mfma_f32_32x32x16_bf16 v[224:239], v[64:67], a[100:103], v[224:239]
    ds_read_b64_tr_b16 v[52:53], v115 offset:12288
    ds_read_b64_tr_b16 v[54:55], v115 offset:12800
    s_add_u32 m0, s37, 110592
    s_add_u32 s43, s36, 57728
    buffer_load_dwordx4 v116, s[16:19], s43 offen lds
    v_add_f32 v19, 1.0, v19
    v_add_f32 v20, 1.0, v20
    v_add_f32 v21, 1.0, v21
    v_mfma_f32_32x32x16_bf16 v[240:255], v[68:71], a[100:103], v[240:255]
    ds_read_b64_tr_b16 v[56:57], v114 offset:6144
    ds_read_b64_tr_b16 v[58:59], v114 offset:6656
    v_rcp_f32 v18, v18
    v_rcp_f32 v19, v19
    s_waitcnt lgkmcnt(6)
    v_mfma_f32_32x32x16_bf16 v[192:207], v[40:43], a[104:107], v[192:207]
    ds_read_b64_tr_b16 v[60:61], v115 offset:6144
    ds_read_b64_tr_b16 v[62:63], v115 offset:6656
    s_add_u32 m0, s37, 114688
    s_add_u32 s43, s36, 57856
    buffer_load_dwordx4 v116, s[16:19], s43 offen lds
    v_rcp_f32 v20, v20
    v_rcp_f32 v21, v21
    v_mfma_f32_32x32x16_bf16 v[208:223], v[44:47], a[104:107], v[208:223]
    ds_read_b64_tr_b16 v[64:65], v114 offset:14336
    ds_read_b64_tr_b16 v[66:67], v114 offset:14848
    s_nop 0
    v_mul_f32 v156, v156, v18
    v_mul_f32 v157, v157, v19
    v_mul_f32 v158, v158, v20
    s_waitcnt lgkmcnt(6)
    v_mfma_f32_32x32x16_bf16 v[224:239], v[48:51], a[104:107], v[224:239]
    ds_read_b64_tr_b16 v[68:69], v115 offset:14336
    ds_read_b64_tr_b16 v[70:71], v115 offset:14848
    s_add_u32 m0, s37, 118784
    s_add_u32 s43, s36, 57984
    buffer_load_dwordx4 v116, s[16:19], s43 offen lds
    v_mul_f32 v159, v159, v21
    v_cvt_pk_bf16_f32 v156, 0, v156
    v_cvt_pk_bf16_f32 v157, 0, v157
    v_mfma_f32_32x32x16_bf16 v[240:255], v[52:55], a[104:107], v[240:255]
    ds_read_b64_tr_b16 v[40:41], v104 offset:32768
    ds_read_b64_tr_b16 v[42:43], v104 offset:33280
    v_cvt_pk_bf16_f32 v158, 0, v158
    v_cvt_pk_bf16_f32 v159, 0, v159
    v_mul_f32 v156, v156, v188
    v_mul_f32 v157, v157, v189
    s_waitcnt lgkmcnt(6)
    v_mfma_f32_32x32x16_bf16 v[192:207], v[56:59], a[108:111], v[192:207]
    ds_read_b64_tr_b16 v[44:45], v105 offset:32768
    ds_read_b64_tr_b16 v[46:47], v105 offset:33280
    s_add_u32 m0, s37, 122880
    s_add_u32 s43, s36, 58112
    buffer_load_dwordx4 v116, s[16:19], s43 offen lds
    v_mul_f32 v158, v158, v190
    v_mul_f32 v159, v159, v191
    v_cvt_pk_bf16_f32 v38, v156, v157
    v_mfma_f32_32x32x16_bf16 v[208:223], v[60:63], a[108:111], v[208:223]
    ds_read_b64_tr_b16 v[48:49], v104 offset:36864
    ds_read_b64_tr_b16 v[50:51], v104 offset:37376
    v_cvt_pk_bf16_f32 v39, v158, v159
    s_nop 1
    v_permlane32_swap_b32 v36, v38
    v_permlane32_swap_b32 v37, v39
    s_waitcnt lgkmcnt(6)
    v_mfma_f32_32x32x16_bf16 v[224:239], v[64:67], a[108:111], v[224:239]
    ds_read_b64_tr_b16 v[52:53], v105 offset:36864
    ds_read_b64_tr_b16 v[54:55], v105 offset:37376
    s_nop 0
    ds_write_b128 v106, v[36:39] offset:3072
    v_mfma_f32_32x32x16_bf16 v[240:255], v[68:71], a[108:111], v[240:255]
    ds_read_b64_tr_b16 v[56:57], v104 offset:40960
    ds_read_b64_tr_b16 v[58:59], v104 offset:41472
    s_waitcnt vmcnt(7)
    s_waitcnt lgkmcnt(2)
    s_barrier
    ds_read_b128 a[0:3], v107 offset:0
    ds_read_b128 a[4:7], v107 offset:1024
    ds_read_b128 a[8:11], v107 offset:2048
    ds_read_b128 a[12:15], v107 offset:3072
    ds_read_b128 a[16:19], v107 offset:4096
    ds_read_b128 a[20:23], v107 offset:5120
    ds_read_b128 a[24:27], v107 offset:6144
    ds_read_b128 a[28:31], v107 offset:7168
    s_waitcnt lgkmcnt(7)
    v_mfma_f32_32x32x16_bf16 v[128:143], a[0:3], v[40:43], 0
    ds_read_b64_tr_b16 v[60:61], v105 offset:40960
    ds_read_b64_tr_b16 v[62:63], v105 offset:41472
    s_add_u32 m0, s37, 0
    s_add_u32 s43, s36, 114688
    buffer_load_dwordx4 v116, s[16:19], s43 offen lds
    v_mfma_f32_32x32x16_bf16 v[144:159], a[0:3], v[44:47], 0
    ds_read_b64_tr_b16 v[64:65], v104 offset:45056
    ds_read_b64_tr_b16 v[66:67], v104 offset:45568
    s_add_u32 m0, s37, 4096
    s_add_u32 s43, s36, 114816
    buffer_load_dwordx4 v116, s[16:19], s43 offen lds
    v_mfma_f32_32x32x16_bf16 v[160:175], a[0:3], v[48:51], 0
    ds_read_b64_tr_b16 v[68:69], v104 offset:34816
    ds_read_b64_tr_b16 v[70:71], v104 offset:35328
    s_add_u32 m0, s37, 8192
    s_add_u32 s43, s36, 114944
    buffer_load_dwordx4 v116, s[16:19], s43 offen lds
    v_cvt_pk_bf16_f32 v192, 0, v192
    v_mfma_f32_32x32x16_bf16 v[176:191], a[0:3], v[52:55], 0
    ds_read_b64_tr_b16 v[40:41], v105 offset:34816
    ds_read_b64_tr_b16 v[42:43], v105 offset:35328
    s_add_u32 m0, s37, 12288
    s_add_u32 s43, s36, 115072
    buffer_load_dwordx4 v116, s[16:19], s43 offen lds
    v_cvt_pk_bf16_f32 v193, 0, v193
    v_cvt_pk_bf16_f32 v194, 0, v194
    v_cvt_pk_bf16_f32 v195, 0, v195
    v_mul_f32 v18, s68, v192
    v_mfma_f32_32x32x16_bf16 v[72:87], a[0:3], v[56:59], 0
    ds_read_b64_tr_b16 v[44:45], v104 offset:38912
    ds_read_b64_tr_b16 v[46:47], v104 offset:39424
    s_add_u32 m0, s37, 16384
    s_add_u32 s43, s36, 115200
    buffer_load_dwordx4 v116, s[16:19], s43 offen lds
    v_mul_f32 v19, s68, v193
    v_mul_f32 v20, s68, v194
    v_mul_f32 v21, s68, v195
    v_exp_f32 v18, v18
    v_exp_f32 v19, v19
    s_waitcnt lgkmcnt(8)
    v_mfma_f32_32x32x16_bf16 v[88:103], a[0:3], v[60:63], 0
    ds_read_b64_tr_b16 v[48:49], v105 offset:38912
    ds_read_b64_tr_b16 v[50:51], v105 offset:39424
    s_add_u32 m0, s37, 20480
    s_add_u32 s43, s36, 115328
    buffer_load_dwordx4 v116, s[16:19], s43 offen lds
    v_exp_f32 v20, v20
    v_exp_f32 v21, v21
    s_waitcnt lgkmcnt(6)
    v_mfma_f32_32x32x16_bf16 v[2:17], a[0:3], v[64:67], 0
    ds_read_b64_tr_b16 v[52:53], v104 offset:43008
    ds_read_b64_tr_b16 v[54:55], v104 offset:43520
    s_add_u32 m0, s37, 24576
    s_add_u32 s43, s36, 115456
    buffer_load_dwordx4 v116, s[16:19], s43 offen lds
    v_cvt_pk_bf16_f32 v224, 0, v224
    v_cvt_pk_bf16_f32 v225, 0, v225
    v_cvt_pk_bf16_f32 v226, 0, v226
    v_cvt_pk_bf16_f32 v227, 0, v227
    v_add_f32 v18, 1.0, v18
    v_add_f32 v19, 1.0, v19
    v_mfma_f32_32x32x16_bf16 v[128:143], a[4:7], v[68:71], v[128:143]
    ds_read_b64_tr_b16 v[56:57], v105 offset:43008
    ds_read_b64_tr_b16 v[58:59], v105 offset:43520
    v_add_f32 v20, 1.0, v20
    v_add_f32 v21, 1.0, v21
    v_rcp_f32 v18, v18
    v_rcp_f32 v19, v19
    s_waitcnt lgkmcnt(6)
    v_mfma_f32_32x32x16_bf16 v[144:159], a[4:7], v[40:43], v[144:159]
    ds_read_b64_tr_b16 v[60:61], v104 offset:47104
    ds_read_b64_tr_b16 v[62:63], v104 offset:47616
    v_rcp_f32 v20, v20
    v_rcp_f32 v21, v21
    s_nop 0
    v_mfma_f32_32x32x16_bf16 v[160:175], a[4:7], v[44:47], v[160:175]
    ds_read_b64_tr_b16 v[64:65], v110 offset:0
    ds_read_b64_tr_b16 v[66:67], v110 offset:512
    v_mul_f32 v192, v192, v18
    v_mul_f32 v193, v193, v19
    v_mul_f32 v194, v194, v20
    v_mul_f32 v195, v195, v21
    v_cvt_pk_bf16_f32 v192, 0, v192
    s_waitcnt lgkmcnt(6)
    v_mfma_f32_32x32x16_bf16 v[176:191], a[4:7], v[48:51], v[176:191]
    ds_read_b64_tr_b16 v[68:69], v117 offset:0
    ds_read_b64_tr_b16 v[70:71], v117 offset:512
    v_cvt_pk_bf16_f32 v193, 0, v193
    v_cvt_pk_bf16_f32 v194, 0, v194
    v_cvt_pk_bf16_f32 v195, 0, v195
    v_mul_f32 v192, v192, v224
    v_mul_f32 v193, v193, v225
    v_mul_f32 v194, v194, v226
    v_mfma_f32_32x32x16_bf16 v[72:87], a[4:7], v[52:55], v[72:87]
    ds_read_b64_tr_b16 v[40:41], v110 offset:4096
    ds_read_b64_tr_b16 v[42:43], v110 offset:4608
    v_mul_f32 v195, v195, v227
    v_cvt_pk_bf16_f32 v24, v192, v193
    v_cvt_pk_bf16_f32 v25, v194, v195
    v_cvt_pk_bf16_f32 v196, 0, v196
    v_cvt_pk_bf16_f32 v197, 0, v197
    s_waitcnt lgkmcnt(6)
    v_mfma_f32_32x32x16_bf16 v[88:103], a[4:7], v[56:59], v[88:103]
    ds_read_b64_tr_b16 v[44:45], v117 offset:4096
    ds_read_b64_tr_b16 v[46:47], v117 offset:4608
    v_cvt_pk_bf16_f32 v198, 0, v198
    v_cvt_pk_bf16_f32 v199, 0, v199
    v_mul_f32 v18, s68, v196
    v_mul_f32 v19, s68, v197
    v_mul_f32 v20, s68, v198
    v_mul_f32 v21, s68, v199
    v_mfma_f32_32x32x16_bf16 v[2:17], a[4:7], v[60:63], v[2:17]
    ds_read_b64_tr_b16 v[48:49], v110 offset:8192
    ds_read_b64_tr_b16 v[50:51], v110 offset:8704
    v_exp_f32 v18, v18
    v_exp_f32 v19, v19
    v_exp_f32 v20, v20
    s_waitcnt vmcnt(7)
    s_barrier
    s_waitcnt lgkmcnt(6)
    v_mfma_f32_32x32x16_bf16 v[128:143], a[8:11], v[64:67], v[128:143]
    ds_read_b64_tr_b16 v[52:53], v117 offset:8192
    ds_read_b64_tr_b16 v[54:55], v117 offset:8704
    s_add_u32 m0, s37, 32768
    s_add_u32 s43, s78, 0
    buffer_load_dwordx4 v116, s[16:19], s43 offen lds
    v_exp_f32 v21, v21
    v_cvt_pk_bf16_f32 v228, 0, v228
    v_cvt_pk_bf16_f32 v229, 0, v229
    v_cvt_pk_bf16_f32 v230, 0, v230
    v_mfma_f32_32x32x16_bf16 v[144:159], a[8:11], v[68:71], v[144:159]
    ds_read_b64_tr_b16 v[56:57], v110 offset:12288
    ds_read_b64_tr_b16 v[58:59], v110 offset:12800
    s_add_u32 m0, s37, 36864
    s_add_u32 s43, s78, 128
    buffer_load_dwordx4 v116, s[16:19], s43 offen lds
    v_cvt_pk_bf16_f32 v231, 0, v231
    v_add_f32 v18, 1.0, v18
    v_add_f32 v19, 1.0, v19
    v_add_f32 v20, 1.0, v20
    v_add_f32 v21, 1.0, v21
    s_waitcnt lgkmcnt(6)
    v_mfma_f32_32x32x16_bf16 v[160:175], a[8:11], v[40:43], v[160:175]
    ds_read_b64_tr_b16 v[60:61], v110 offset:2048
    ds_read_b64_tr_b16 v[62:63], v110 offset:2560
    s_add_u32 m0, s37, 40960
    s_add_u32 s43, s78, 256
    buffer_load_dwordx4 v116, s[16:19], s43 offen lds
    v_rcp_f32 v18, v18
    v_rcp_f32 v19, v19
    v_rcp_f32 v20, v20
    v_mfma_f32_32x32x16_bf16 v[176:191], a[8:11], v[44:47], v[176:191]
    ds_read_b64_tr_b16 v[64:65], v117 offset:2048
    ds_read_b64_tr_b16 v[66:67], v117 offset:2560
    s_add_u32 m0, s37, 45056
    s_add_u32 s43, s78, 384
    buffer_load_dwordx4 v116, s[16:19], s43 offen lds
    v_rcp_f32 v21, v21
    s_nop 0
    v_mul_f32 v196, v196, v18
    v_mul_f32 v197, v197, v19
    s_waitcnt lgkmcnt(6)
    v_mfma_f32_32x32x16_bf16 v[72:87], a[8:11], v[48:51], v[72:87]
    ds_read_b64_tr_b16 v[68:69], v110 offset:6144
    ds_read_b64_tr_b16 v[70:71], v110 offset:6656
    s_add_u32 m0, s37, 49152
    s_add_u32 s43, s78, 512
    buffer_load_dwordx4 v116, s[16:19], s43 offen lds
    v_mul_f32 v198, v198, v20
    v_mul_f32 v199, v199, v21
    v_cvt_pk_bf16_f32 v196, 0, v196
    v_cvt_pk_bf16_f32 v197, 0, v197
    v_cvt_pk_bf16_f32 v198, 0, v198
    v_cvt_pk_bf16_f32 v199, 0, v199
    v_mfma_f32_32x32x16_bf16 v[88:103], a[8:11], v[52:55], v[88:103]
    ds_read_b64_tr_b16 v[40:41], v117 offset:6144
    ds_read_b64_tr_b16 v[42:43], v117 offset:6656
    s_add_u32 m0, s37, 53248
    s_add_u32 s43, s78, 640
    buffer_load_dwordx4 v116, s[16:19], s43 offen lds
    v_mul_f32 v196, v196, v228
    v_mul_f32 v197, v197, v229
    v_mul_f32 v198, v198, v230
    v_mul_f32 v199, v199, v231
    v_cvt_pk_bf16_f32 v26, v196, v197
    s_waitcnt lgkmcnt(6)
    v_mfma_f32_32x32x16_bf16 v[2:17], a[8:11], v[56:59], v[2:17]
    ds_read_b64_tr_b16 v[44:45], v110 offset:10240
    ds_read_b64_tr_b16 v[46:47], v110 offset:10752
    s_add_u32 m0, s37, 57344
    s_add_u32 s43, s78, 768
    buffer_load_dwordx4 v116, s[16:19], s43 offen lds
    v_cvt_pk_bf16_f32 v27, v198, v199
    s_nop 1
    v_permlane32_swap_b32 v24, v26
    v_permlane32_swap_b32 v25, v27
    s_nop 0
    ds_write_b128 v106, v[24:27] offset:8192
    v_mfma_f32_32x32x16_bf16 v[128:143], a[12:15], v[60:63], v[128:143]
    ds_read_b64_tr_b16 v[48:49], v117 offset:10240
    ds_read_b64_tr_b16 v[50:51], v117 offset:10752
    v_cvt_pk_bf16_f32 v200, 0, v200
    v_cvt_pk_bf16_f32 v201, 0, v201
    v_cvt_pk_bf16_f32 v202, 0, v202
    v_cvt_pk_bf16_f32 v203, 0, v203
    v_mul_f32 v18, s68, v200
    s_waitcnt lgkmcnt(7)
    v_mfma_f32_32x32x16_bf16 v[144:159], a[12:15], v[64:67], v[144:159]
    ds_read_b64_tr_b16 v[52:53], v110 offset:14336
    ds_read_b64_tr_b16 v[54:55], v110 offset:14848
    v_mul_f32 v19, s68, v201
    v_mul_f32 v20, s68, v202
    v_mul_f32 v21, s68, v203
    v_exp_f32 v18, v18
    v_exp_f32 v19, v19
    v_mfma_f32_32x32x16_bf16 v[160:175], a[12:15], v[68:71], v[160:175]
    ds_read_b64_tr_b16 v[56:57], v110 offset:32768
    ds_read_b64_tr_b16 v[58:59], v110 offset:33280
    v_exp_f32 v20, v20
    v_exp_f32 v21, v21
    s_waitcnt lgkmcnt(7)
    v_mfma_f32_32x32x16_bf16 v[176:191], a[12:15], v[40:43], v[176:191]
    ds_read_b64_tr_b16 v[60:61], v117 offset:32768
    ds_read_b64_tr_b16 v[62:63], v117 offset:33280
    v_cvt_pk_bf16_f32 v232, 0, v232
    v_cvt_pk_bf16_f32 v233, 0, v233
    v_cvt_pk_bf16_f32 v234, 0, v234
    v_cvt_pk_bf16_f32 v235, 0, v235
    v_add_f32 v18, 1.0, v18
    v_add_f32 v19, 1.0, v19
    v_mfma_f32_32x32x16_bf16 v[72:87], a[12:15], v[44:47], v[72:87]
    ds_read_b64_tr_b16 v[64:65], v110 offset:36864
    ds_read_b64_tr_b16 v[66:67], v110 offset:37376
    v_add_f32 v20, 1.0, v20
    v_add_f32 v21, 1.0, v21
    v_rcp_f32 v18, v18
    v_rcp_f32 v19, v19
    s_waitcnt lgkmcnt(6)
    v_mfma_f32_32x32x16_bf16 v[88:103], a[12:15], v[48:51], v[88:103]
    ds_read_b64_tr_b16 v[68:69], v117 offset:36864
    ds_read_b64_tr_b16 v[70:71], v117 offset:37376
    v_rcp_f32 v20, v20
    v_rcp_f32 v21, v21
    s_nop 0
    v_mfma_f32_32x32x16_bf16 v[2:17], a[12:15], v[52:55], v[2:17]
    ds_read_b64_tr_b16 v[40:41], v110 offset:40960
    ds_read_b64_tr_b16 v[42:43], v110 offset:41472
    v_mul_f32 v200, v200, v18
    v_mul_f32 v201, v201, v19
    v_mul_f32 v202, v202, v20
    v_mul_f32 v203, v203, v21
    v_cvt_pk_bf16_f32 v200, 0, v200
    s_waitcnt vmcnt(7)
    s_barrier
    s_waitcnt lgkmcnt(6)
    v_mfma_f32_32x32x16_bf16 v[128:143], a[16:19], v[56:59], v[128:143]
    ds_read_b64_tr_b16 v[44:45], v117 offset:40960
    ds_read_b64_tr_b16 v[46:47], v117 offset:41472
    s_add_u32 m0, s37, 65536
    s_add_u32 s43, s36, 86016
    buffer_load_dwordx4 v116, s[16:19], s43 offen lds
    v_cvt_pk_bf16_f32 v201, 0, v201
    v_cvt_pk_bf16_f32 v202, 0, v202
    v_cvt_pk_bf16_f32 v203, 0, v203
    v_mul_f32 v200, v200, v232
    v_mul_f32 v201, v201, v233
    v_mul_f32 v202, v202, v234
    v_mfma_f32_32x32x16_bf16 v[144:159], a[16:19], v[60:63], v[144:159]
    ds_read_b64_tr_b16 v[48:49], v110 offset:45056
    ds_read_b64_tr_b16 v[50:51], v110 offset:45568
    s_add_u32 m0, s37, 69632
    s_add_u32 s43, s36, 86144
    buffer_load_dwordx4 v116, s[16:19], s43 offen lds
    v_mul_f32 v203, v203, v235
    v_cvt_pk_bf16_f32 v28, v200, v201
    v_cvt_pk_bf16_f32 v29, v202, v203
    v_cvt_pk_bf16_f32 v204, 0, v204
    v_cvt_pk_bf16_f32 v205, 0, v205
    s_waitcnt lgkmcnt(6)
    v_mfma_f32_32x32x16_bf16 v[160:175], a[16:19], v[64:67], v[160:175]
    ds_read_b64_tr_b16 v[52:53], v110 offset:34816
    ds_read_b64_tr_b16 v[54:55], v110 offset:35328
    s_add_u32 m0, s37, 73728
    s_add_u32 s43, s36, 86272
    buffer_load_dwordx4 v116, s[16:19], s43 offen lds
    v_cvt_pk_bf16_f32 v206, 0, v206
    v_cvt_pk_bf16_f32 v207, 0, v207
    v_mul_f32 v18, s68, v204
    v_mul_f32 v19, s68, v205
    v_mul_f32 v20, s68, v206
    v_mul_f32 v21, s68, v207
    v_mfma_f32_32x32x16_bf16 v[176:191], a[16:19], v[68:71], v[176:191]
    ds_read_b64_tr_b16 v[56:57], v117 offset:34816
    ds_read_b64_tr_b16 v[58:59], v117 offset:35328
    s_add_u32 m0, s37, 77824
    s_add_u32 s43, s36, 86400
    buffer_load_dwordx4 v116, s[16:19], s43 offen lds
    v_exp_f32 v18, v18
    v_exp_f32 v19, v19
    v_exp_f32 v20, v20
    s_waitcnt lgkmcnt(6)
    v_mfma_f32_32x32x16_bf16 v[72:87], a[16:19], v[40:43], v[72:87]
    ds_read_b64_tr_b16 v[60:61], v110 offset:38912
    ds_read_b64_tr_b16 v[62:63], v110 offset:39424
    s_add_u32 m0, s37, 81920
    s_add_u32 s43, s36, 86528
    buffer_load_dwordx4 v116, s[16:19], s43 offen lds
    v_exp_f32 v21, v21
    v_cvt_pk_bf16_f32 v236, 0, v236
    v_cvt_pk_bf16_f32 v237, 0, v237
    v_cvt_pk_bf16_f32 v238, 0, v238
    v_mfma_f32_32x32x16_bf16 v[88:103], a[16:19], v[44:47], v[88:103]
    ds_read_b64_tr_b16 v[64:65], v117 offset:38912
    ds_read_b64_tr_b16 v[66:67], v117 offset:39424
    s_add_u32 m0, s37, 86016
    s_add_u32 s43, s36, 86656
    buffer_load_dwordx4 v116, s[16:19], s43 offen lds
    v_cvt_pk_bf16_f32 v239, 0, v239
    v_add_f32 v18, 1.0, v18
    v_add_f32 v19, 1.0, v19
    v_add_f32 v20, 1.0, v20
    v_add_f32 v21, 1.0, v21
    s_waitcnt lgkmcnt(6)
    v_mfma_f32_32x32x16_bf16 v[2:17], a[16:19], v[48:51], v[2:17]
    ds_read_b64_tr_b16 v[68:69], v110 offset:43008
    ds_read_b64_tr_b16 v[70:71], v110 offset:43520
    s_add_u32 m0, s37, 90112
    s_add_u32 s43, s36, 86784
    buffer_load_dwordx4 v116, s[16:19], s43 offen lds
    v_rcp_f32 v18, v18
    v_rcp_f32 v19, v19
    v_rcp_f32 v20, v20
    v_mfma_f32_32x32x16_bf16 v[128:143], a[20:23], v[52:55], v[128:143]
    ds_read_b64_tr_b16 v[40:41], v117 offset:43008
    ds_read_b64_tr_b16 v[42:43], v117 offset:43520
    v_rcp_f32 v21, v21
    s_nop 0
    v_mul_f32 v204, v204, v18
    v_mul_f32 v205, v205, v19
    s_waitcnt lgkmcnt(6)
    v_mfma_f32_32x32x16_bf16 v[144:159], a[20:23], v[56:59], v[144:159]
    ds_read_b64_tr_b16 v[44:45], v110 offset:47104
    ds_read_b64_tr_b16 v[46:47], v110 offset:47616
    v_mul_f32 v206, v206, v20
    v_mul_f32 v207, v207, v21
    v_cvt_pk_bf16_f32 v204, 0, v204
    v_cvt_pk_bf16_f32 v205, 0, v205
    v_cvt_pk_bf16_f32 v206, 0, v206
    v_cvt_pk_bf16_f32 v207, 0, v207
    v_mfma_f32_32x32x16_bf16 v[160:175], a[20:23], v[60:63], v[160:175]
    ds_read_b64_tr_b16 v[48:49], v104 offset:0
    ds_read_b64_tr_b16 v[50:51], v104 offset:512
    v_mul_f32 v204, v204, v236
    v_mul_f32 v205, v205, v237
    v_mul_f32 v206, v206, v238
    v_mul_f32 v207, v207, v239
    v_cvt_pk_bf16_f32 v30, v204, v205
    s_waitcnt lgkmcnt(6)
    v_mfma_f32_32x32x16_bf16 v[176:191], a[20:23], v[64:67], v[176:191]
    ds_read_b64_tr_b16 v[52:53], v105 offset:0
    ds_read_b64_tr_b16 v[54:55], v105 offset:512
    v_cvt_pk_bf16_f32 v31, v206, v207
    s_nop 1
    v_permlane32_swap_b32 v28, v30
    v_permlane32_swap_b32 v29, v31
    s_nop 0
    ds_write_b128 v106, v[28:31] offset:9216
    v_mfma_f32_32x32x16_bf16 v[72:87], a[20:23], v[68:71], v[72:87]
    ds_read_b64_tr_b16 v[56:57], v104 offset:4096
    ds_read_b64_tr_b16 v[58:59], v104 offset:4608
    s_waitcnt lgkmcnt(7)
    v_mfma_f32_32x32x16_bf16 v[88:103], a[20:23], v[40:43], v[88:103]
    ds_read_b64_tr_b16 v[60:61], v105 offset:4096
    ds_read_b64_tr_b16 v[62:63], v105 offset:4608
    v_mfma_f32_32x32x16_bf16 v[2:17], a[20:23], v[44:47], v[2:17]
    ds_read_b64_tr_b16 v[64:65], v104 offset:8192
    ds_read_b64_tr_b16 v[66:67], v104 offset:8704
    s_waitcnt vmcnt(7)
    s_waitcnt lgkmcnt(6)
    s_barrier
    ds_read_b128 a[32:35], v107 offset:8192
    ds_read_b128 a[36:39], v107 offset:9216
    ds_read_b128 a[48:51], v107 offset:12288
    ds_read_b128 a[52:55], v107 offset:13312
    s_waitcnt lgkmcnt(3)
    v_mfma_f32_32x32x16_bf16 v[128:143], a[32:35], v[48:51], v[128:143]
    ds_read_b64_tr_b16 v[68:69], v105 offset:8192
    ds_read_b64_tr_b16 v[70:71], v105 offset:8704
    s_add_u32 m0, s37, 98304
    s_add_u32 s43, s36, 143360
    buffer_load_dwordx4 v116, s[16:19], s43 offen lds
    v_cvt_pk_bf16_f32 v208, 0, v208
    v_mfma_f32_32x32x16_bf16 v[144:159], a[32:35], v[52:55], v[144:159]
    ds_read_b64_tr_b16 v[40:41], v104 offset:12288
    ds_read_b64_tr_b16 v[42:43], v104 offset:12800
    s_add_u32 m0, s37, 102400
    s_add_u32 s43, s36, 143488
    buffer_load_dwordx4 v116, s[16:19], s43 offen lds
    v_cvt_pk_bf16_f32 v209, 0, v209
    v_cvt_pk_bf16_f32 v210, 0, v210
    v_cvt_pk_bf16_f32 v211, 0, v211
    v_mul_f32 v18, s68, v208
    v_mfma_f32_32x32x16_bf16 v[160:175], a[32:35], v[56:59], v[160:175]
    ds_read_b64_tr_b16 v[44:45], v104 offset:2048
    ds_read_b64_tr_b16 v[46:47], v104 offset:2560
    s_add_u32 m0, s37, 106496
    s_add_u32 s43, s36, 143616
    buffer_load_dwordx4 v116, s[16:19], s43 offen lds
    v_mul_f32 v19, s68, v209
    v_mul_f32 v20, s68, v210
    v_mul_f32 v21, s68, v211
    v_exp_f32 v18, v18
    v_mfma_f32_32x32x16_bf16 v[176:191], a[32:35], v[60:63], v[176:191]
    ds_read_b64_tr_b16 v[48:49], v105 offset:2048
    ds_read_b64_tr_b16 v[50:51], v105 offset:2560
    s_add_u32 m0, s37, 110592
    s_add_u32 s43, s36, 143744
    buffer_load_dwordx4 v116, s[16:19], s43 offen lds
    v_exp_f32 v19, v19
    v_exp_f32 v20, v20
    v_exp_f32 v21, v21
    v_mfma_f32_32x32x16_bf16 v[72:87], a[32:35], v[64:67], v[72:87]
    ds_read_b64_tr_b16 v[52:53], v104 offset:6144
    ds_read_b64_tr_b16 v[54:55], v104 offset:6656
    s_add_u32 m0, s37, 114688
    s_add_u32 s43, s36, 143872
    buffer_load_dwordx4 v116, s[16:19], s43 offen lds
    v_cvt_pk_bf16_f32 v240, 0, v240
    v_cvt_pk_bf16_f32 v241, 0, v241
    v_cvt_pk_bf16_f32 v242, 0, v242
    v_cvt_pk_bf16_f32 v243, 0, v243
    v_add_f32 v18, 1.0, v18
    s_waitcnt lgkmcnt(8)
    v_mfma_f32_32x32x16_bf16 v[88:103], a[32:35], v[68:71], v[88:103]
    ds_read_b64_tr_b16 v[56:57], v105 offset:6144
    ds_read_b64_tr_b16 v[58:59], v105 offset:6656
    s_add_u32 m0, s37, 118784
    s_add_u32 s43, s36, 144000
    buffer_load_dwordx4 v116, s[16:19], s43 offen lds
    v_add_f32 v19, 1.0, v19
    v_add_f32 v20, 1.0, v20
    v_add_f32 v21, 1.0, v21
    v_rcp_f32 v18, v18
    s_waitcnt lgkmcnt(6)
    v_mfma_f32_32x32x16_bf16 v[2:17], a[32:35], v[40:43], v[2:17]
    ds_read_b64_tr_b16 v[60:61], v104 offset:10240
    ds_read_b64_tr_b16 v[62:63], v104 offset:10752
    s_add_u32 m0, s37, 122880
    s_add_u32 s43, s36, 144128
    buffer_load_dwordx4 v116, s[16:19], s43 offen lds
    v_rcp_f32 v19, v19
    v_rcp_f32 v20, v20
    v_rcp_f32 v21, v21
    v_mfma_f32_32x32x16_bf16 v[128:143], a[36:39], v[44:47], v[128:143]
    ds_read_b64_tr_b16 v[64:65], v105 offset:10240
    ds_read_b64_tr_b16 v[66:67], v105 offset:10752
    s_nop 0
    v_mul_f32 v208, v208, v18
    v_mul_f32 v209, v209, v19
    v_mul_f32 v210, v210, v20
    s_waitcnt lgkmcnt(6)
    v_mfma_f32_32x32x16_bf16 v[144:159], a[36:39], v[48:51], v[144:159]
    ds_read_b64_tr_b16 v[68:69], v104 offset:14336
    ds_read_b64_tr_b16 v[70:71], v104 offset:14848
    v_mul_f32 v211, v211, v21
    v_cvt_pk_bf16_f32 v208, 0, v208
    v_cvt_pk_bf16_f32 v209, 0, v209
    v_cvt_pk_bf16_f32 v210, 0, v210
    v_cvt_pk_bf16_f32 v211, 0, v211
    v_mfma_f32_32x32x16_bf16 v[160:175], a[36:39], v[52:55], v[160:175]
    ds_read_b64_tr_b16 v[40:41], v104 offset:32768
    ds_read_b64_tr_b16 v[42:43], v104 offset:33280
    v_mul_f32 v208, v208, v240
    v_mul_f32 v209, v209, v241
    v_mul_f32 v210, v210, v242
    v_mul_f32 v211, v211, v243
    v_cvt_pk_bf16_f32 v32, v208, v209
    v_cvt_pk_bf16_f32 v33, v210, v211
    s_waitcnt lgkmcnt(6)
    v_mfma_f32_32x32x16_bf16 v[176:191], a[36:39], v[56:59], v[176:191]
    ds_read_b64_tr_b16 v[44:45], v105 offset:32768
    ds_read_b64_tr_b16 v[46:47], v105 offset:33280
    v_cvt_pk_bf16_f32 v212, 0, v212
    v_cvt_pk_bf16_f32 v213, 0, v213
    v_cvt_pk_bf16_f32 v214, 0, v214
    v_cvt_pk_bf16_f32 v215, 0, v215
    v_mul_f32 v18, s68, v212
    v_mfma_f32_32x32x16_bf16 v[72:87], a[36:39], v[60:63], v[72:87]
    ds_read_b64_tr_b16 v[48:49], v104 offset:36864
    ds_read_b64_tr_b16 v[50:51], v104 offset:37376
    v_mul_f32 v19, s68, v213
    v_mul_f32 v20, s68, v214
    v_mul_f32 v21, s68, v215
    v_exp_f32 v18, v18
    s_waitcnt lgkmcnt(6)
    v_mfma_f32_32x32x16_bf16 v[88:103], a[36:39], v[64:67], v[88:103]
    ds_read_b64_tr_b16 v[52:53], v105 offset:36864
    ds_read_b64_tr_b16 v[54:55], v105 offset:37376
    v_exp_f32 v19, v19
    v_exp_f32 v20, v20
    v_exp_f32 v21, v21
    v_mfma_f32_32x32x16_bf16 v[2:17], a[36:39], v[68:71], v[2:17]
    ds_read_b64_tr_b16 v[56:57], v104 offset:40960
    ds_read_b64_tr_b16 v[58:59], v104 offset:41472
    v_cvt_pk_bf16_f32 v244, 0, v244
    v_cvt_pk_bf16_f32 v245, 0, v245
    v_cvt_pk_bf16_f32 v246, 0, v246
    v_cvt_pk_bf16_f32 v247, 0, v247
    s_waitcnt vmcnt(7)
    s_barrier
    s_waitcnt lgkmcnt(6)
    v_mfma_f32_32x32x16_bf16 v[128:143], a[48:51], v[40:43], v[128:143]
    ds_read_b64_tr_b16 v[60:61], v105 offset:40960
    ds_read_b64_tr_b16 v[62:63], v105 offset:41472
    v_add_f32 v18, 1.0, v18
    v_add_f32 v19, 1.0, v19
    v_add_f32 v20, 1.0, v20
    v_add_f32 v21, 1.0, v21
    v_rcp_f32 v18, v18
    v_mfma_f32_32x32x16_bf16 v[144:159], a[48:51], v[44:47], v[144:159]
    ds_read_b64_tr_b16 v[64:65], v104 offset:45056
    ds_read_b64_tr_b16 v[66:67], v104 offset:45568
    v_rcp_f32 v19, v19
    v_rcp_f32 v20, v20
    v_rcp_f32 v21, v21
    s_waitcnt lgkmcnt(6)
    v_mfma_f32_32x32x16_bf16 v[160:175], a[48:51], v[48:51], v[160:175]
    ds_read_b64_tr_b16 v[68:69], v104 offset:34816
    ds_read_b64_tr_b16 v[70:71], v104 offset:35328
    s_nop 0
    v_mul_f32 v212, v212, v18
    v_mul_f32 v213, v213, v19
    v_mul_f32 v214, v214, v20
    v_mfma_f32_32x32x16_bf16 v[176:191], a[48:51], v[52:55], v[176:191]
    ds_read_b64_tr_b16 v[40:41], v105 offset:34816
    ds_read_b64_tr_b16 v[42:43], v105 offset:35328
    v_mul_f32 v215, v215, v21
    v_cvt_pk_bf16_f32 v212, 0, v212
    v_cvt_pk_bf16_f32 v213, 0, v213
    v_cvt_pk_bf16_f32 v214, 0, v214
    v_cvt_pk_bf16_f32 v215, 0, v215
    s_waitcnt lgkmcnt(6)
    v_mfma_f32_32x32x16_bf16 v[72:87], a[48:51], v[56:59], v[72:87]
    ds_read_b64_tr_b16 v[44:45], v104 offset:38912
    ds_read_b64_tr_b16 v[46:47], v104 offset:39424
    v_mul_f32 v212, v212, v244
    v_mul_f32 v213, v213, v245
    v_mul_f32 v214, v214, v246
    v_mul_f32 v215, v215, v247
    v_cvt_pk_bf16_f32 v34, v212, v213
    v_mfma_f32_32x32x16_bf16 v[88:103], a[48:51], v[60:63], v[88:103]
    ds_read_b64_tr_b16 v[48:49], v105 offset:38912
    ds_read_b64_tr_b16 v[50:51], v105 offset:39424
    v_cvt_pk_bf16_f32 v35, v214, v215
    s_nop 1
    v_permlane32_swap_b32 v32, v34
    v_permlane32_swap_b32 v33, v35
    s_nop 0
    ds_write_b128 v106, v[32:35] offset:10240
    s_waitcnt lgkmcnt(7)
    v_mfma_f32_32x32x16_bf16 v[2:17], a[48:51], v[64:67], v[2:17]
    ds_read_b64_tr_b16 v[52:53], v104 offset:43008
    ds_read_b64_tr_b16 v[54:55], v104 offset:43520
    v_cvt_pk_bf16_f32 v216, 0, v216
    v_cvt_pk_bf16_f32 v217, 0, v217
    v_cvt_pk_bf16_f32 v218, 0, v218
    v_cvt_pk_bf16_f32 v219, 0, v219
    v_mul_f32 v18, s68, v216
    v_mfma_f32_32x32x16_bf16 v[128:143], a[52:55], v[68:71], v[128:143]
    ds_read_b64_tr_b16 v[56:57], v105 offset:43008
    ds_read_b64_tr_b16 v[58:59], v105 offset:43520
    v_mul_f32 v19, s68, v217
    v_mul_f32 v20, s68, v218
    v_mul_f32 v21, s68, v219
    v_exp_f32 v18, v18
    s_waitcnt lgkmcnt(7)
    v_mfma_f32_32x32x16_bf16 v[144:159], a[52:55], v[40:43], v[144:159]
    ds_read_b64_tr_b16 v[60:61], v104 offset:47104
    ds_read_b64_tr_b16 v[62:63], v104 offset:47616
    v_exp_f32 v19, v19
    v_exp_f32 v20, v20
    v_exp_f32 v21, v21
    v_mfma_f32_32x32x16_bf16 v[160:175], a[52:55], v[44:47], v[160:175]
    ds_read_b64_tr_b16 v[64:65], v110 offset:0
    ds_read_b64_tr_b16 v[66:67], v110 offset:512
    v_cvt_pk_bf16_f32 v248, 0, v248
    v_cvt_pk_bf16_f32 v249, 0, v249
    v_cvt_pk_bf16_f32 v250, 0, v250
    v_cvt_pk_bf16_f32 v251, 0, v251
    v_add_f32 v18, 1.0, v18
    s_waitcnt lgkmcnt(6)
    v_mfma_f32_32x32x16_bf16 v[176:191], a[52:55], v[48:51], v[176:191]
    ds_read_b64_tr_b16 v[68:69], v117 offset:0
    ds_read_b64_tr_b16 v[70:71], v117 offset:512
    v_add_f32 v19, 1.0, v19
    v_add_f32 v20, 1.0, v20
    v_add_f32 v21, 1.0, v21
    v_rcp_f32 v18, v18
    v_mfma_f32_32x32x16_bf16 v[72:87], a[52:55], v[52:55], v[72:87]
    ds_read_b64_tr_b16 v[40:41], v110 offset:4096
    ds_read_b64_tr_b16 v[42:43], v110 offset:4608
    v_rcp_f32 v19, v19
    v_rcp_f32 v20, v20
    v_rcp_f32 v21, v21
    s_waitcnt lgkmcnt(6)
    v_mfma_f32_32x32x16_bf16 v[88:103], a[52:55], v[56:59], v[88:103]
    ds_read_b64_tr_b16 v[44:45], v117 offset:4096
    ds_read_b64_tr_b16 v[46:47], v117 offset:4608
    s_nop 0
    v_mul_f32 v216, v216, v18
    v_mul_f32 v217, v217, v19
    v_mul_f32 v218, v218, v20
    v_mfma_f32_32x32x16_bf16 v[2:17], a[52:55], v[60:63], v[2:17]
    ds_read_b64_tr_b16 v[48:49], v110 offset:8192
    ds_read_b64_tr_b16 v[50:51], v110 offset:8704
    v_mul_f32 v219, v219, v21
    v_cvt_pk_bf16_f32 v216, 0, v216
    v_cvt_pk_bf16_f32 v217, 0, v217
    v_cvt_pk_bf16_f32 v218, 0, v218
    v_cvt_pk_bf16_f32 v219, 0, v219
    s_waitcnt vmcnt(0)
    s_barrier
    s_waitcnt lgkmcnt(6)
    v_mfma_f32_32x32x16_bf16 v[128:143], a[24:27], v[64:67], v[128:143]
    ds_read_b64_tr_b16 v[52:53], v117 offset:8192
    ds_read_b64_tr_b16 v[54:55], v117 offset:8704
    v_mul_f32 v216, v216, v248
    v_mul_f32 v217, v217, v249
    v_mul_f32 v218, v218, v250
    v_mul_f32 v219, v219, v251
    v_cvt_pk_bf16_f32 v36, v216, v217
    v_cvt_pk_bf16_f32 v37, v218, v219
    v_mfma_f32_32x32x16_bf16 v[144:159], a[24:27], v[68:71], v[144:159]
    ds_read_b64_tr_b16 v[56:57], v110 offset:12288
    ds_read_b64_tr_b16 v[58:59], v110 offset:12800
    v_cvt_pk_bf16_f32 v220, 0, v220
    v_cvt_pk_bf16_f32 v221, 0, v221
    v_cvt_pk_bf16_f32 v222, 0, v222
    v_cvt_pk_bf16_f32 v223, 0, v223
    v_mul_f32 v18, s68, v220
    s_waitcnt lgkmcnt(6)
    v_mfma_f32_32x32x16_bf16 v[160:175], a[24:27], v[40:43], v[160:175]
    ds_read_b64_tr_b16 v[60:61], v110 offset:2048
    ds_read_b64_tr_b16 v[62:63], v110 offset:2560
    v_mul_f32 v19, s68, v221
    v_mul_f32 v20, s68, v222
    v_mul_f32 v21, s68, v223
    v_exp_f32 v18, v18
    v_mfma_f32_32x32x16_bf16 v[176:191], a[24:27], v[44:47], v[176:191]
    ds_read_b64_tr_b16 v[64:65], v117 offset:2048
    ds_read_b64_tr_b16 v[66:67], v117 offset:2560
    v_exp_f32 v19, v19
    v_exp_f32 v20, v20
    v_exp_f32 v21, v21
    s_waitcnt lgkmcnt(6)
    v_mfma_f32_32x32x16_bf16 v[72:87], a[24:27], v[48:51], v[72:87]
    ds_read_b64_tr_b16 v[68:69], v110 offset:6144
    ds_read_b64_tr_b16 v[70:71], v110 offset:6656
    v_cvt_pk_bf16_f32 v252, 0, v252
    v_cvt_pk_bf16_f32 v253, 0, v253
    v_cvt_pk_bf16_f32 v254, 0, v254
    v_cvt_pk_bf16_f32 v255, 0, v255
    v_mfma_f32_32x32x16_bf16 v[88:103], a[24:27], v[52:55], v[88:103]
    ds_read_b64_tr_b16 v[40:41], v117 offset:6144
    ds_read_b64_tr_b16 v[42:43], v117 offset:6656
    v_add_f32 v18, 1.0, v18
    v_add_f32 v19, 1.0, v19
    v_add_f32 v20, 1.0, v20
    v_add_f32 v21, 1.0, v21
    v_rcp_f32 v18, v18
    s_waitcnt lgkmcnt(6)
    v_mfma_f32_32x32x16_bf16 v[2:17], a[24:27], v[56:59], v[2:17]
    ds_read_b64_tr_b16 v[44:45], v110 offset:10240
    ds_read_b64_tr_b16 v[46:47], v110 offset:10752
    v_rcp_f32 v19, v19
    v_rcp_f32 v20, v20
    v_rcp_f32 v21, v21
    v_mfma_f32_32x32x16_bf16 v[128:143], a[28:31], v[60:63], v[128:143]
    ds_read_b64_tr_b16 v[48:49], v117 offset:10240
    ds_read_b64_tr_b16 v[50:51], v117 offset:10752
    s_nop 0
    v_mul_f32 v220, v220, v18
    v_mul_f32 v221, v221, v19
    v_mul_f32 v222, v222, v20
    s_waitcnt lgkmcnt(6)
    v_mfma_f32_32x32x16_bf16 v[144:159], a[28:31], v[64:67], v[144:159]
    ds_read_b64_tr_b16 v[52:53], v110 offset:14336
    ds_read_b64_tr_b16 v[54:55], v110 offset:14848
    v_mul_f32 v223, v223, v21
    v_cvt_pk_bf16_f32 v220, 0, v220
    v_cvt_pk_bf16_f32 v221, 0, v221
    v_cvt_pk_bf16_f32 v222, 0, v222
    v_cvt_pk_bf16_f32 v223, 0, v223
    v_mfma_f32_32x32x16_bf16 v[160:175], a[28:31], v[68:71], v[160:175]
    ds_read_b64_tr_b16 v[56:57], v110 offset:32768
    ds_read_b64_tr_b16 v[58:59], v110 offset:33280
    v_mul_f32 v220, v220, v252
    v_mul_f32 v221, v221, v253
    v_mul_f32 v222, v222, v254
    v_mul_f32 v223, v223, v255
    v_cvt_pk_bf16_f32 v38, v220, v221
    s_waitcnt lgkmcnt(6)
    v_mfma_f32_32x32x16_bf16 v[176:191], a[28:31], v[40:43], v[176:191]
    ds_read_b64_tr_b16 v[60:61], v117 offset:32768
    ds_read_b64_tr_b16 v[62:63], v117 offset:33280
    v_cvt_pk_bf16_f32 v39, v222, v223
    s_nop 1
    v_permlane32_swap_b32 v36, v38
    v_permlane32_swap_b32 v37, v39
    s_nop 0
    ds_write_b128 v106, v[36:39] offset:11264
    v_mfma_f32_32x32x16_bf16 v[72:87], a[28:31], v[44:47], v[72:87]
    ds_read_b64_tr_b16 v[64:65], v110 offset:34816
    ds_read_b64_tr_b16 v[66:67], v110 offset:35328
    s_waitcnt lgkmcnt(7)
    v_mfma_f32_32x32x16_bf16 v[88:103], a[28:31], v[48:51], v[88:103]
    ds_read_b64_tr_b16 v[68:69], v117 offset:34816
    ds_read_b64_tr_b16 v[70:71], v117 offset:35328
    v_mfma_f32_32x32x16_bf16 v[2:17], a[28:31], v[52:55], v[2:17]
    ds_read_b64_tr_b16 v[40:41], v110 offset:36864
    ds_read_b64_tr_b16 v[42:43], v110 offset:37376
    s_waitcnt lgkmcnt(6)
    s_barrier
    ds_read_b128 a[40:43], v107 offset:10240
    ds_read_b128 a[44:47], v107 offset:11264
    v_mul_u32_u24 v126, 3584, v120
    v_lshl_add_u32 v126, v124, 2, v126
    v_add_u32 v120, 0, v126
    v_add_u32 v121, 7168, v126
    v_add_u32 v122, 14336, v126
    v_add_u32 v123, 21504, v126
    s_waitcnt lgkmcnt(1)
    v_mfma_f32_32x32x16_bf16 v[128:143], a[40:43], v[56:59], v[128:143]
    ds_read_b64_tr_b16 v[44:45], v117 offset:36864
    ds_read_b64_tr_b16 v[46:47], v117 offset:37376
    v_mfma_f32_32x32x16_bf16 v[144:159], a[40:43], v[60:63], v[144:159]
    ds_read_b64_tr_b16 v[48:49], v110 offset:38912
    ds_read_b64_tr_b16 v[50:51], v110 offset:39424
    s_waitcnt lgkmcnt(4)
    v_mfma_f32_32x32x16_bf16 v[128:143], a[44:47], v[64:67], v[128:143]
    ds_read_b64_tr_b16 v[52:53], v117 offset:38912
    ds_read_b64_tr_b16 v[54:55], v117 offset:39424
    v_mfma_f32_32x32x16_bf16 v[144:159], a[44:47], v[68:71], v[144:159]
    ds_read_b64_tr_b16 v[56:57], v110 offset:40960
    ds_read_b64_tr_b16 v[58:59], v110 offset:41472
    v_mfma_f32_32x32x16_bf16 v[160:175], a[40:43], v[40:43], v[160:175]
    ds_read_b64_tr_b16 v[60:61], v117 offset:40960
    ds_read_b64_tr_b16 v[62:63], v117 offset:41472
    v_cvt_pk_f16_f32 v24, v128, v129
    s_add_u32 s40, s39, 0
    buffer_store_dword v24, v120, s[24:27], s40 offen offset:0 sc1
    v_cvt_pk_f16_f32 v25, v130, v131
    buffer_store_dword v25, v120, s[24:27], s40 offen offset:1792 sc1
    v_cvt_pk_f16_f32 v26, v132, v133
    buffer_store_dword v26, v121, s[24:27], s40 offen offset:0 sc1
    v_cvt_pk_f16_f32 v27, v134, v135
    buffer_store_dword v27, v121, s[24:27], s40 offen offset:1792 sc1
    s_waitcnt lgkmcnt(8)
    v_mfma_f32_32x32x16_bf16 v[176:191], a[40:43], v[44:47], v[176:191]
    ds_read_b64_tr_b16 v[64:65], v110 offset:43008
    ds_read_b64_tr_b16 v[66:67], v110 offset:43520
    v_cvt_pk_f16_f32 v28, v136, v137
    buffer_store_dword v28, v122, s[24:27], s40 offen offset:0 sc1
    v_cvt_pk_f16_f32 v29, v138, v139
    buffer_store_dword v29, v122, s[24:27], s40 offen offset:1792 sc1
    v_cvt_pk_f16_f32 v30, v140, v141
    buffer_store_dword v30, v123, s[24:27], s40 offen offset:0 sc1
    v_cvt_pk_f16_f32 v31, v142, v143
    buffer_store_dword v31, v123, s[24:27], s40 offen offset:1792 sc1
    s_waitcnt lgkmcnt(6)
    v_mfma_f32_32x32x16_bf16 v[160:175], a[44:47], v[48:51], v[160:175]
    ds_read_b64_tr_b16 v[68:69], v117 offset:43008
    ds_read_b64_tr_b16 v[70:71], v117 offset:43520
    v_cvt_pk_f16_f32 v24, v144, v145
    s_add_u32 s40, s39, 128
    buffer_store_dword v24, v120, s[24:27], s40 offen offset:0 sc1
    v_cvt_pk_f16_f32 v25, v146, v147
    buffer_store_dword v25, v120, s[24:27], s40 offen offset:1792 sc1
    v_cvt_pk_f16_f32 v26, v148, v149
    buffer_store_dword v26, v121, s[24:27], s40 offen offset:0 sc1
    v_cvt_pk_f16_f32 v27, v150, v151
    buffer_store_dword v27, v121, s[24:27], s40 offen offset:1792 sc1
    v_mfma_f32_32x32x16_bf16 v[176:191], a[44:47], v[52:55], v[176:191]
    ds_read_b64_tr_b16 v[40:41], v110 offset:45056
    ds_read_b64_tr_b16 v[42:43], v110 offset:45568
    v_cvt_pk_f16_f32 v28, v152, v153
    buffer_store_dword v28, v122, s[24:27], s40 offen offset:0 sc1
    v_cvt_pk_f16_f32 v29, v154, v155
    buffer_store_dword v29, v122, s[24:27], s40 offen offset:1792 sc1
    v_cvt_pk_f16_f32 v30, v156, v157
    buffer_store_dword v30, v123, s[24:27], s40 offen offset:0 sc1
    v_cvt_pk_f16_f32 v31, v158, v159
    buffer_store_dword v31, v123, s[24:27], s40 offen offset:1792 sc1
    s_waitcnt lgkmcnt(6)
    v_mfma_f32_32x32x16_bf16 v[72:87], a[40:43], v[56:59], v[72:87]
    ds_read_b64_tr_b16 v[44:45], v110 offset:47104
    ds_read_b64_tr_b16 v[46:47], v110 offset:47616
    v_cvt_pk_f16_f32 v24, v160, v161
    s_add_u32 s40, s39, 256
    buffer_store_dword v24, v120, s[24:27], s40 offen offset:0 sc1
    v_cvt_pk_f16_f32 v25, v162, v163
    buffer_store_dword v25, v120, s[24:27], s40 offen offset:1792 sc1
    v_cvt_pk_f16_f32 v26, v164, v165
    buffer_store_dword v26, v121, s[24:27], s40 offen offset:0 sc1
    v_cvt_pk_f16_f32 v27, v166, v167
    buffer_store_dword v27, v121, s[24:27], s40 offen offset:1792 sc1
    v_mfma_f32_32x32x16_bf16 v[88:103], a[40:43], v[60:63], v[88:103]
    v_cvt_pk_f16_f32 v28, v168, v169
    buffer_store_dword v28, v122, s[24:27], s40 offen offset:0 sc1
    v_cvt_pk_f16_f32 v29, v170, v171
    buffer_store_dword v29, v122, s[24:27], s40 offen offset:1792 sc1
    v_cvt_pk_f16_f32 v30, v172, v173
    buffer_store_dword v30, v123, s[24:27], s40 offen offset:0 sc1
    v_cvt_pk_f16_f32 v31, v174, v175
    buffer_store_dword v31, v123, s[24:27], s40 offen offset:1792 sc1
    s_waitcnt lgkmcnt(4)
    v_mfma_f32_32x32x16_bf16 v[72:87], a[44:47], v[64:67], v[72:87]
    v_cvt_pk_f16_f32 v24, v176, v177
    s_add_u32 s40, s39, 384
    buffer_store_dword v24, v120, s[24:27], s40 offen offset:0 sc1
    v_cvt_pk_f16_f32 v25, v178, v179
    buffer_store_dword v25, v120, s[24:27], s40 offen offset:1792 sc1
    v_cvt_pk_f16_f32 v26, v180, v181
    buffer_store_dword v26, v121, s[24:27], s40 offen offset:0 sc1
    v_cvt_pk_f16_f32 v27, v182, v183
    buffer_store_dword v27, v121, s[24:27], s40 offen offset:1792 sc1
    v_mfma_f32_32x32x16_bf16 v[88:103], a[44:47], v[68:71], v[88:103]
    v_cvt_pk_f16_f32 v28, v184, v185
    buffer_store_dword v28, v122, s[24:27], s40 offen offset:0 sc1
    v_cvt_pk_f16_f32 v29, v186, v187
    buffer_store_dword v29, v122, s[24:27], s40 offen offset:1792 sc1
    v_cvt_pk_f16_f32 v30, v188, v189
    buffer_store_dword v30, v123, s[24:27], s40 offen offset:0 sc1
    v_cvt_pk_f16_f32 v31, v190, v191
    buffer_store_dword v31, v123, s[24:27], s40 offen offset:1792 sc1
    s_waitcnt lgkmcnt(0)
    v_mfma_f32_32x32x16_bf16 v[2:17], a[40:43], v[40:43], v[2:17]
    v_cvt_pk_f16_f32 v24, v72, v73
    s_add_u32 s40, s39, 512
    buffer_store_dword v24, v120, s[24:27], s40 offen offset:0 sc1
    v_cvt_pk_f16_f32 v25, v74, v75
    buffer_store_dword v25, v120, s[24:27], s40 offen offset:1792 sc1
    v_cvt_pk_f16_f32 v26, v76, v77
    buffer_store_dword v26, v121, s[24:27], s40 offen offset:0 sc1
    v_cvt_pk_f16_f32 v27, v78, v79
    buffer_store_dword v27, v121, s[24:27], s40 offen offset:1792 sc1
    v_mfma_f32_32x32x16_bf16 v[2:17], a[44:47], v[44:47], v[2:17]
    v_cvt_pk_f16_f32 v28, v80, v81
    buffer_store_dword v28, v122, s[24:27], s40 offen offset:0 sc1
    v_cvt_pk_f16_f32 v29, v82, v83
    buffer_store_dword v29, v122, s[24:27], s40 offen offset:1792 sc1
    v_cvt_pk_f16_f32 v30, v84, v85
    buffer_store_dword v30, v123, s[24:27], s40 offen offset:0 sc1
    v_cvt_pk_f16_f32 v31, v86, v87
    buffer_store_dword v31, v123, s[24:27], s40 offen offset:1792 sc1
    s_nop 7
    s_nop 7
    v_cvt_pk_f16_f32 v24, v88, v89
    s_add_u32 s40, s39, 640
    buffer_store_dword v24, v120, s[24:27], s40 offen offset:0 sc1
    v_cvt_pk_f16_f32 v25, v90, v91
    s_add_u32 s40, s39, 640
    buffer_store_dword v25, v120, s[24:27], s40 offen offset:1792 sc1
    v_cvt_pk_f16_f32 v26, v92, v93
    s_add_u32 s40, s39, 640
    buffer_store_dword v26, v121, s[24:27], s40 offen offset:0 sc1
    v_cvt_pk_f16_f32 v27, v94, v95
    s_add_u32 s40, s39, 640
    buffer_store_dword v27, v121, s[24:27], s40 offen offset:1792 sc1
    v_cvt_pk_f16_f32 v28, v96, v97
    s_add_u32 s40, s39, 640
    buffer_store_dword v28, v122, s[24:27], s40 offen offset:0 sc1
    v_cvt_pk_f16_f32 v29, v98, v99
    s_add_u32 s40, s39, 640
    buffer_store_dword v29, v122, s[24:27], s40 offen offset:1792 sc1
    v_cvt_pk_f16_f32 v30, v100, v101
    s_add_u32 s40, s39, 640
    buffer_store_dword v30, v123, s[24:27], s40 offen offset:0 sc1
    v_cvt_pk_f16_f32 v31, v102, v103
    s_add_u32 s40, s39, 640
    buffer_store_dword v31, v123, s[24:27], s40 offen offset:1792 sc1
    v_cvt_pk_f16_f32 v24, v2, v3
    s_add_u32 s40, s39, 768
    buffer_store_dword v24, v120, s[24:27], s40 offen offset:0 sc1
    v_cvt_pk_f16_f32 v25, v4, v5
    s_add_u32 s40, s39, 768
    buffer_store_dword v25, v120, s[24:27], s40 offen offset:1792 sc1
    v_cvt_pk_f16_f32 v26, v6, v7
    s_add_u32 s40, s39, 768
    buffer_store_dword v26, v121, s[24:27], s40 offen offset:0 sc1
    v_cvt_pk_f16_f32 v27, v8, v9
    s_add_u32 s40, s39, 768
    buffer_store_dword v27, v121, s[24:27], s40 offen offset:1792 sc1
    v_cvt_pk_f16_f32 v28, v10, v11
    s_add_u32 s40, s39, 768
    buffer_store_dword v28, v122, s[24:27], s40 offen offset:0 sc1
    v_cvt_pk_f16_f32 v29, v12, v13
    s_add_u32 s40, s39, 768
    buffer_store_dword v29, v122, s[24:27], s40 offen offset:1792 sc1
    v_cvt_pk_f16_f32 v30, v14, v15
    s_add_u32 s40, s39, 768
    buffer_store_dword v30, v123, s[24:27], s40 offen offset:0 sc1
    v_cvt_pk_f16_f32 v31, v16, v17
    s_add_u32 s40, s39, 768
    buffer_store_dword v31, v123, s[24:27], s40 offen offset:1792 sc1
    s_barrier
    s_cmp_lg_u32 s28, 0
    s_cbranch_scc1 Lhi_75
    v_mov_b32 v126, 3
    v_mov_b32 v127, 0
    s_lshl_b32 s40, s29, 7
    s_add_u32 s40, s40, s38
    s_mov_b64 exec, 1
    buffer_store_dword v126, v127, s[24:27], s40 offen offset:4 sc1
    s_mov_b64 exec, -1
Lhi_75:
    v_lshrrev_b32 v2, 6, v0
    v_add_u32 v2, s3, v2
    v_mul_u32_u24 v3, 1792, v2
    v_lshlrev_b32 v4, 4, v1
    v_lshl_add_u32 v5, v4, 1, v3
    v_add_u32 v3, v3, v4
    v_accvgpr_read_b32 v20, a248
    v_accvgpr_read_b32 v52, a252
    v_accvgpr_read_b32 v48, a244
    v_accvgpr_read_b32 v21, a249
    v_accvgpr_read_b32 v53, a253
    v_accvgpr_read_b32 v49, a245
    v_accvgpr_read_b32 v22, a250
    v_accvgpr_read_b32 v54, a254
    v_accvgpr_read_b32 v50, a246
    v_accvgpr_read_b32 v23, a251
    v_accvgpr_read_b32 v55, a255
    v_accvgpr_read_b32 v51, a247
    s_cmp_lg_u32 s28, 0
    s_cbranch_scc1 Lsy_76
    v_mov_b32 v126, 3
    v_and_b32 v127, 7, v1
    v_lshlrev_b32 v127, 7, v127
    v_bfe_u32 v125, v1, 3, 1
    v_xor_b32 v125, 1, v125
    v_lshl_add_u32 v127, v125, 2, v127
    s_mov_b64 exec, 0xff
    s_mov_b32 s40, 0
    buffer_load_dword v125, v127, s[24:27], s38 offen sc1
    s_sleep 4
Lsp_77:
    buffer_load_dword v118, v127, s[24:27], s38 offen sc1
    s_waitcnt vmcnt(1)
    v_cmp_gt_u32 vcc, v126, v125
    s_nop 1
    s_and_b64 vcc, vcc, exec
    s_cbranch_scc0 Lsy_76
    buffer_load_dword v125, v127, s[24:27], s38 offen sc1
    s_waitcnt vmcnt(1)
    v_cmp_gt_u32 vcc, v126, v118
    s_nop 1
    s_and_b64 vcc, vcc, exec
    s_cbranch_scc0 Lsy_76
    s_add_u32 s40, s40, 1
    s_cmp_lt_u32 s40, 65536
    s_cbranch_scc1 Lsp_77
Lsy_76:
    s_mov_b64 exec, -1
    s_barrier
    v_cmp_gt_u32 vcc, 56, v1
    s_and_saveexec_b64 s[58:59], vcc
    s_mov_b32 s40, 33554432
    buffer_load_dwordx4 v[160:163], v5, s[24:27], s40 offen
    buffer_load_dwordx4 v[164:167], v5, s[24:27], s40 offen offset:16
    s_mov_b32 s40, 35389440
    buffer_load_dwordx4 v[168:171], v5, s[24:27], s40 offen
    buffer_load_dwordx4 v[172:175], v5, s[24:27], s40 offen offset:16
    s_mov_b32 s40, 37224448
    buffer_load_dwordx4 v[176:179], v5, s[24:27], s40 offen
    buffer_load_dwordx4 v[180:183], v5, s[24:27], s40 offen offset:16
    s_mov_b32 s40, 39059456
    buffer_load_dwordx4 v[184:187], v5, s[24:27], s40 offen
    buffer_load_dwordx4 v[188:191], v5, s[24:27], s40 offen offset:16
    s_mov_b32 s40, 40894464
    buffer_load_dwordx4 v[192:195], v5, s[24:27], s40 offen
    buffer_load_dwordx4 v[196:199], v5, s[24:27], s40 offen offset:16
    s_mov_b32 s40, 42729472
    buffer_load_dwordx4 v[200:203], v5, s[24:27], s40 offen
    buffer_load_dwordx4 v[204:207], v5, s[24:27], s40 offen offset:16
    s_mov_b32 s40, 44564480
    buffer_load_dwordx4 v[208:211], v5, s[24:27], s40 offen
    buffer_load_dwordx4 v[212:215], v5, s[24:27], s40 offen offset:16
    s_mov_b32 s40, 46399488
    buffer_load_dwordx4 v[216:219], v5, s[24:27], s40 offen
    buffer_load_dwordx4 v[220:223], v5, s[24:27], s40 offen offset:16
    s_mov_b32 s57, 0
Lfr_79:
    s_waitcnt vmcnt(14)
    v_fma_mix_f32 v128, v160, 1.0, 0 op_sel:[0,0,0] op_sel_hi:[1,0,0]
    v_fma_mix_f32 v136, v160, 1.0, 0 op_sel:[1,0,0] op_sel_hi:[1,0,0]
    v_fma_mix_f32 v129, v161, 1.0, 0 op_sel:[0,0,0] op_sel_hi:[1,0,0]
    v_fma_mix_f32 v137, v161, 1.0, 0 op_sel:[1,0,0] op_sel_hi:[1,0,0]
    v_fma_mix_f32 v130, v162, 1.0, 0 op_sel:[0,0,0] op_sel_hi:[1,0,0]
    v_fma_mix_f32 v138, v162, 1.0, 0 op_sel:[1,0,0] op_sel_hi:[1,0,0]
    v_fma_mix_f32 v131, v163, 1.0, 0 op_sel:[0,0,0] op_sel_hi:[1,0,0]
    v_fma_mix_f32 v139, v163, 1.0, 0 op_sel:[1,0,0] op_sel_hi:[1,0,0]
    v_fma_mix_f32 v132, v164, 1.0, 0 op_sel:[0,0,0] op_sel_hi:[1,0,0]
    v_fma_mix_f32 v140, v164, 1.0, 0 op_sel:[1,0,0] op_sel_hi:[1,0,0]
    v_fma_mix_f32 v133, v165, 1.0, 0 op_sel:[0,0,0] op_sel_hi:[1,0,0]
    v_fma_mix_f32 v141, v165, 1.0, 0 op_sel:[1,0,0] op_sel_hi:[1,0,0]
    v_fma_mix_f32 v134, v166, 1.0, 0 op_sel:[0,0,0] op_sel_hi:[1,0,0]
    v_fma_mix_f32 v142, v166, 1.0, 0 op_sel:[1,0,0] op_sel_hi:[1,0,0]
    v_fma_mix_f32 v135, v167, 1.0, 0 op_sel:[0,0,0] op_sel_hi:[1,0,0]
    v_fma_mix_f32 v143, v167, 1.0, 0 op_sel:[1,0,0] op_sel_hi:[1,0,0]
    s_waitcnt vmcnt(12)
    v_fma_mix_f32 v128, v168, 1.0, v128 op_sel:[0,0,0] op_sel_hi:[1,0,0]
    v_fma_mix_f32 v136, v168, 1.0, v136 op_sel:[1,0,0] op_sel_hi:[1,0,0]
    v_fma_mix_f32 v129, v169, 1.0, v129 op_sel:[0,0,0] op_sel_hi:[1,0,0]
    v_fma_mix_f32 v137, v169, 1.0, v137 op_sel:[1,0,0] op_sel_hi:[1,0,0]
    v_fma_mix_f32 v130, v170, 1.0, v130 op_sel:[0,0,0] op_sel_hi:[1,0,0]
    v_fma_mix_f32 v138, v170, 1.0, v138 op_sel:[1,0,0] op_sel_hi:[1,0,0]
    v_fma_mix_f32 v131, v171, 1.0, v131 op_sel:[0,0,0] op_sel_hi:[1,0,0]
    v_fma_mix_f32 v139, v171, 1.0, v139 op_sel:[1,0,0] op_sel_hi:[1,0,0]
    v_fma_mix_f32 v132, v172, 1.0, v132 op_sel:[0,0,0] op_sel_hi:[1,0,0]
    v_fma_mix_f32 v140, v172, 1.0, v140 op_sel:[1,0,0] op_sel_hi:[1,0,0]
    v_fma_mix_f32 v133, v173, 1.0, v133 op_sel:[0,0,0] op_sel_hi:[1,0,0]
    v_fma_mix_f32 v141, v173, 1.0, v141 op_sel:[1,0,0] op_sel_hi:[1,0,0]
    v_fma_mix_f32 v134, v174, 1.0, v134 op_sel:[0,0,0] op_sel_hi:[1,0,0]
    v_fma_mix_f32 v142, v174, 1.0, v142 op_sel:[1,0,0] op_sel_hi:[1,0,0]
    v_fma_mix_f32 v135, v175, 1.0, v135 op_sel:[0,0,0] op_sel_hi:[1,0,0]
    v_fma_mix_f32 v143, v175, 1.0, v143 op_sel:[1,0,0] op_sel_hi:[1,0,0]
    s_waitcnt vmcnt(10)
    v_fma_mix_f32 v128, v176, 1.0, v128 op_sel:[0,0,0] op_sel_hi:[1,0,0]
    v_fma_mix_f32 v136, v176, 1.0, v136 op_sel:[1,0,0] op_sel_hi:[1,0,0]
    v_fma_mix_f32 v129, v177, 1.0, v129 op_sel:[0,0,0] op_sel_hi:[1,0,0]
    v_fma_mix_f32 v137, v177, 1.0, v137 op_sel:[1,0,0] op_sel_hi:[1,0,0]
    v_fma_mix_f32 v130, v178, 1.0, v130 op_sel:[0,0,0] op_sel_hi:[1,0,0]
    v_fma_mix_f32 v138, v178, 1.0, v138 op_sel:[1,0,0] op_sel_hi:[1,0,0]
    v_fma_mix_f32 v131, v179, 1.0, v131 op_sel:[0,0,0] op_sel_hi:[1,0,0]
    v_fma_mix_f32 v139, v179, 1.0, v139 op_sel:[1,0,0] op_sel_hi:[1,0,0]
    v_fma_mix_f32 v132, v180, 1.0, v132 op_sel:[0,0,0] op_sel_hi:[1,0,0]
    v_fma_mix_f32 v140, v180, 1.0, v140 op_sel:[1,0,0] op_sel_hi:[1,0,0]
    v_fma_mix_f32 v133, v181, 1.0, v133 op_sel:[0,0,0] op_sel_hi:[1,0,0]
    v_fma_mix_f32 v141, v181, 1.0, v141 op_sel:[1,0,0] op_sel_hi:[1,0,0]
    v_fma_mix_f32 v134, v182, 1.0, v134 op_sel:[0,0,0] op_sel_hi:[1,0,0]
    v_fma_mix_f32 v142, v182, 1.0, v142 op_sel:[1,0,0] op_sel_hi:[1,0,0]
    v_fma_mix_f32 v135, v183, 1.0, v135 op_sel:[0,0,0] op_sel_hi:[1,0,0]
    v_fma_mix_f32 v143, v183, 1.0, v143 op_sel:[1,0,0] op_sel_hi:[1,0,0]
    s_waitcnt vmcnt(8)
    v_fma_mix_f32 v128, v184, 1.0, v128 op_sel:[0,0,0] op_sel_hi:[1,0,0]
    v_fma_mix_f32 v136, v184, 1.0, v136 op_sel:[1,0,0] op_sel_hi:[1,0,0]
    v_fma_mix_f32 v129, v185, 1.0, v129 op_sel:[0,0,0] op_sel_hi:[1,0,0]
    v_fma_mix_f32 v137, v185, 1.0, v137 op_sel:[1,0,0] op_sel_hi:[1,0,0]
    v_fma_mix_f32 v130, v186, 1.0, v130 op_sel:[0,0,0] op_sel_hi:[1,0,0]
    v_fma_mix_f32 v138, v186, 1.0, v138 op_sel:[1,0,0] op_sel_hi:[1,0,0]
    v_fma_mix_f32 v131, v187, 1.0, v131 op_sel:[0,0,0] op_sel_hi:[1,0,0]
    v_fma_mix_f32 v139, v187, 1.0, v139 op_sel:[1,0,0] op_sel_hi:[1,0,0]
    v_fma_mix_f32 v132, v188, 1.0, v132 op_sel:[0,0,0] op_sel_hi:[1,0,0]
    v_fma_mix_f32 v140, v188, 1.0, v140 op_sel:[1,0,0] op_sel_hi:[1,0,0]
    v_fma_mix_f32 v133, v189, 1.0, v133 op_sel:[0,0,0] op_sel_hi:[1,0,0]
    v_fma_mix_f32 v141, v189, 1.0, v141 op_sel:[1,0,0] op_sel_hi:[1,0,0]
    v_fma_mix_f32 v134, v190, 1.0, v134 op_sel:[0,0,0] op_sel_hi:[1,0,0]
    v_fma_mix_f32 v142, v190, 1.0, v142 op_sel:[1,0,0] op_sel_hi:[1,0,0]
    v_fma_mix_f32 v135, v191, 1.0, v135 op_sel:[0,0,0] op_sel_hi:[1,0,0]
    v_fma_mix_f32 v143, v191, 1.0, v143 op_sel:[1,0,0] op_sel_hi:[1,0,0]
    s_waitcnt vmcnt(6)
    v_fma_mix_f32 v128, v192, 1.0, v128 op_sel:[0,0,0] op_sel_hi:[1,0,0]
    v_fma_mix_f32 v136, v192, 1.0, v136 op_sel:[1,0,0] op_sel_hi:[1,0,0]
    v_fma_mix_f32 v129, v193, 1.0, v129 op_sel:[0,0,0] op_sel_hi:[1,0,0]
    v_fma_mix_f32 v137, v193, 1.0, v137 op_sel:[1,0,0] op_sel_hi:[1,0,0]
    v_fma_mix_f32 v130, v194, 1.0, v130 op_sel:[0,0,0] op_sel_hi:[1,0,0]
    v_fma_mix_f32 v138, v194, 1.0, v138 op_sel:[1,0,0] op_sel_hi:[1,0,0]
    v_fma_mix_f32 v131, v195, 1.0, v131 op_sel:[0,0,0] op_sel_hi:[1,0,0]
    v_fma_mix_f32 v139, v195, 1.0, v139 op_sel:[1,0,0] op_sel_hi:[1,0,0]
    v_fma_mix_f32 v132, v196, 1.0, v132 op_sel:[0,0,0] op_sel_hi:[1,0,0]
    v_fma_mix_f32 v140, v196, 1.0, v140 op_sel:[1,0,0] op_sel_hi:[1,0,0]
    v_fma_mix_f32 v133, v197, 1.0, v133 op_sel:[0,0,0] op_sel_hi:[1,0,0]
    v_fma_mix_f32 v141, v197, 1.0, v141 op_sel:[1,0,0] op_sel_hi:[1,0,0]
    v_fma_mix_f32 v134, v198, 1.0, v134 op_sel:[0,0,0] op_sel_hi:[1,0,0]
    v_fma_mix_f32 v142, v198, 1.0, v142 op_sel:[1,0,0] op_sel_hi:[1,0,0]
    v_fma_mix_f32 v135, v199, 1.0, v135 op_sel:[0,0,0] op_sel_hi:[1,0,0]
    v_fma_mix_f32 v143, v199, 1.0, v143 op_sel:[1,0,0] op_sel_hi:[1,0,0]
    s_waitcnt vmcnt(4)
    v_fma_mix_f32 v128, v200, 1.0, v128 op_sel:[0,0,0] op_sel_hi:[1,0,0]
    v_fma_mix_f32 v136, v200, 1.0, v136 op_sel:[1,0,0] op_sel_hi:[1,0,0]
    v_fma_mix_f32 v129, v201, 1.0, v129 op_sel:[0,0,0] op_sel_hi:[1,0,0]
    v_fma_mix_f32 v137, v201, 1.0, v137 op_sel:[1,0,0] op_sel_hi:[1,0,0]
    v_fma_mix_f32 v130, v202, 1.0, v130 op_sel:[0,0,0] op_sel_hi:[1,0,0]
    v_fma_mix_f32 v138, v202, 1.0, v138 op_sel:[1,0,0] op_sel_hi:[1,0,0]
    v_fma_mix_f32 v131, v203, 1.0, v131 op_sel:[0,0,0] op_sel_hi:[1,0,0]
    v_fma_mix_f32 v139, v203, 1.0, v139 op_sel:[1,0,0] op_sel_hi:[1,0,0]
    v_fma_mix_f32 v132, v204, 1.0, v132 op_sel:[0,0,0] op_sel_hi:[1,0,0]
    v_fma_mix_f32 v140, v204, 1.0, v140 op_sel:[1,0,0] op_sel_hi:[1,0,0]
    v_fma_mix_f32 v133, v205, 1.0, v133 op_sel:[0,0,0] op_sel_hi:[1,0,0]
    v_fma_mix_f32 v141, v205, 1.0, v141 op_sel:[1,0,0] op_sel_hi:[1,0,0]
    v_fma_mix_f32 v134, v206, 1.0, v134 op_sel:[0,0,0] op_sel_hi:[1,0,0]
    v_fma_mix_f32 v142, v206, 1.0, v142 op_sel:[1,0,0] op_sel_hi:[1,0,0]
    v_fma_mix_f32 v135, v207, 1.0, v135 op_sel:[0,0,0] op_sel_hi:[1,0,0]
    v_fma_mix_f32 v143, v207, 1.0, v143 op_sel:[1,0,0] op_sel_hi:[1,0,0]
    s_waitcnt vmcnt(2)
    v_fma_mix_f32 v128, v208, 1.0, v128 op_sel:[0,0,0] op_sel_hi:[1,0,0]
    v_fma_mix_f32 v136, v208, 1.0, v136 op_sel:[1,0,0] op_sel_hi:[1,0,0]
    v_fma_mix_f32 v129, v209, 1.0, v129 op_sel:[0,0,0] op_sel_hi:[1,0,0]
    v_fma_mix_f32 v137, v209, 1.0, v137 op_sel:[1,0,0] op_sel_hi:[1,0,0]
    v_fma_mix_f32 v130, v210, 1.0, v130 op_sel:[0,0,0] op_sel_hi:[1,0,0]
    v_fma_mix_f32 v138, v210, 1.0, v138 op_sel:[1,0,0] op_sel_hi:[1,0,0]
    v_fma_mix_f32 v131, v211, 1.0, v131 op_sel:[0,0,0] op_sel_hi:[1,0,0]
    v_fma_mix_f32 v139, v211, 1.0, v139 op_sel:[1,0,0] op_sel_hi:[1,0,0]
    v_fma_mix_f32 v132, v212, 1.0, v132 op_sel:[0,0,0] op_sel_hi:[1,0,0]
    v_fma_mix_f32 v140, v212, 1.0, v140 op_sel:[1,0,0] op_sel_hi:[1,0,0]
    v_fma_mix_f32 v133, v213, 1.0, v133 op_sel:[0,0,0] op_sel_hi:[1,0,0]
    v_fma_mix_f32 v141, v213, 1.0, v141 op_sel:[1,0,0] op_sel_hi:[1,0,0]
    v_fma_mix_f32 v134, v214, 1.0, v134 op_sel:[0,0,0] op_sel_hi:[1,0,0]
    v_fma_mix_f32 v142, v214, 1.0, v142 op_sel:[1,0,0] op_sel_hi:[1,0,0]
    v_fma_mix_f32 v135, v215, 1.0, v135 op_sel:[0,0,0] op_sel_hi:[1,0,0]
    v_fma_mix_f32 v143, v215, 1.0, v143 op_sel:[1,0,0] op_sel_hi:[1,0,0]
    s_waitcnt vmcnt(0)
    v_fma_mix_f32 v128, v216, 1.0, v128 op_sel:[0,0,0] op_sel_hi:[1,0,0]
    v_fma_mix_f32 v136, v216, 1.0, v136 op_sel:[1,0,0] op_sel_hi:[1,0,0]
    v_fma_mix_f32 v129, v217, 1.0, v129 op_sel:[0,0,0] op_sel_hi:[1,0,0]
    v_fma_mix_f32 v137, v217, 1.0, v137 op_sel:[1,0,0] op_sel_hi:[1,0,0]
    v_fma_mix_f32 v130, v218, 1.0, v130 op_sel:[0,0,0] op_sel_hi:[1,0,0]
    v_fma_mix_f32 v138, v218, 1.0, v138 op_sel:[1,0,0] op_sel_hi:[1,0,0]
    v_fma_mix_f32 v131, v219, 1.0, v131 op_sel:[0,0,0] op_sel_hi:[1,0,0]
    v_fma_mix_f32 v139, v219, 1.0, v139 op_sel:[1,0,0] op_sel_hi:[1,0,0]
    v_fma_mix_f32 v132, v220, 1.0, v132 op_sel:[0,0,0] op_sel_hi:[1,0,0]
    v_fma_mix_f32 v140, v220, 1.0, v140 op_sel:[1,0,0] op_sel_hi:[1,0,0]
    v_fma_mix_f32 v133, v221, 1.0, v133 op_sel:[0,0,0] op_sel_hi:[1,0,0]
    v_fma_mix_f32 v141, v221, 1.0, v141 op_sel:[1,0,0] op_sel_hi:[1,0,0]
    v_fma_mix_f32 v134, v222, 1.0, v134 op_sel:[0,0,0] op_sel_hi:[1,0,0]
    v_fma_mix_f32 v142, v222, 1.0, v142 op_sel:[1,0,0] op_sel_hi:[1,0,0]
    v_fma_mix_f32 v135, v223, 1.0, v135 op_sel:[0,0,0] op_sel_hi:[1,0,0]
    v_fma_mix_f32 v143, v223, 1.0, v143 op_sel:[1,0,0] op_sel_hi:[1,0,0]
    v_add_f32 v24, v128, v129
    v_add_f32 v28, v136, v137
    v_add_f32 v25, v130, v131
    v_add_f32 v29, v138, v139
    v_add_f32 v26, v132, v133
    v_add_f32 v30, v140, v141
    v_add_f32 v27, v134, v135
    v_add_f32 v31, v142, v143
    v_add_f32 v24, v24, v28
    v_add_f32 v25, v25, v29
    v_add_f32 v26, v26, v30
    v_add_f32 v27, v27, v31
    v_add_f32 v24, v24, v25
    v_add_f32 v26, v26, v27
    v_cmp_u_f32 vcc, v24, v26
    s_nop 1
    s_cbranch_vccnz Lfs_80
Lfc_81:
    v_lshlrev_b32 v10, 16, v20
    v_and_b32 v11, 0xffff0000, v20
    v_lshlrev_b32 v12, 16, v21
    v_and_b32 v13, 0xffff0000, v21
    v_lshlrev_b32 v14, 16, v22
    v_and_b32 v15, 0xffff0000, v22
    v_lshlrev_b32 v16, 16, v23
    v_and_b32 v17, 0xffff0000, v23
    v_lshlrev_b32 v144, 16, v52
    v_and_b32 v145, 0xffff0000, v52
    v_lshlrev_b32 v146, 16, v53
    v_and_b32 v147, 0xffff0000, v53
    v_lshlrev_b32 v148, 16, v54
    v_and_b32 v149, 0xffff0000, v54
    v_lshlrev_b32 v150, 16, v55
    v_and_b32 v151, 0xffff0000, v55
    v_lshlrev_b32 v34, 16, v48
    v_and_b32 v35, 0xffff0000, v48
    v_cvt_pk_bf16_f32 v128, 0, v128
    v_cvt_pk_bf16_f32 v129, 0, v129
    v_mul_f32 v128, v128, v34
    v_mul_f32 v129, v129, v35
    v_cvt_pk_bf16_f32 v128, 0, v128
    v_cvt_pk_bf16_f32 v129, 0, v129
    v_add_f32 v10, v10, v128
    v_add_f32 v11, v11, v129
    v_cvt_pk_bf16_f32 v20, v10, v11
    v_lshlrev_b32 v10, 16, v20
    v_and_b32 v11, 0xffff0000, v20
    v_cvt_pk_bf16_f32 v136, 0, v136
    v_cvt_pk_bf16_f32 v137, 0, v137
    v_mul_f32 v136, v136, v34
    v_mul_f32 v137, v137, v35
    v_cvt_pk_bf16_f32 v136, 0, v136
    v_cvt_pk_bf16_f32 v137, 0, v137
    v_add_f32 v144, v144, v136
    v_add_f32 v145, v145, v137
    v_cvt_pk_bf16_f32 v52, v144, v145
    v_lshlrev_b32 v144, 16, v52
    v_and_b32 v145, 0xffff0000, v52
    v_lshlrev_b32 v34, 16, v49
    v_and_b32 v35, 0xffff0000, v49
    v_cvt_pk_bf16_f32 v130, 0, v130
    v_cvt_pk_bf16_f32 v131, 0, v131
    v_mul_f32 v130, v130, v34
    v_mul_f32 v131, v131, v35
    v_cvt_pk_bf16_f32 v130, 0, v130
    v_cvt_pk_bf16_f32 v131, 0, v131
    v_add_f32 v12, v12, v130
    v_add_f32 v13, v13, v131
    v_cvt_pk_bf16_f32 v21, v12, v13
    v_lshlrev_b32 v12, 16, v21
    v_and_b32 v13, 0xffff0000, v21
    v_cvt_pk_bf16_f32 v138, 0, v138
    v_cvt_pk_bf16_f32 v139, 0, v139
    v_mul_f32 v138, v138, v34
    v_mul_f32 v139, v139, v35
    v_cvt_pk_bf16_f32 v138, 0, v138
    v_cvt_pk_bf16_f32 v139, 0, v139
    v_add_f32 v146, v146, v138
    v_add_f32 v147, v147, v139
    v_cvt_pk_bf16_f32 v53, v146, v147
    v_lshlrev_b32 v146, 16, v53
    v_and_b32 v147, 0xffff0000, v53
    v_lshlrev_b32 v34, 16, v50
    v_and_b32 v35, 0xffff0000, v50
    v_cvt_pk_bf16_f32 v132, 0, v132
    v_cvt_pk_bf16_f32 v133, 0, v133
    v_mul_f32 v132, v132, v34
    v_mul_f32 v133, v133, v35
    v_cvt_pk_bf16_f32 v132, 0, v132
    v_cvt_pk_bf16_f32 v133, 0, v133
    v_add_f32 v14, v14, v132
    v_add_f32 v15, v15, v133
    v_cvt_pk_bf16_f32 v22, v14, v15
    v_lshlrev_b32 v14, 16, v22
    v_and_b32 v15, 0xffff0000, v22
    v_cvt_pk_bf16_f32 v140, 0, v140
    v_cvt_pk_bf16_f32 v141, 0, v141
    v_mul_f32 v140, v140, v34
    v_mul_f32 v141, v141, v35
    v_cvt_pk_bf16_f32 v140, 0, v140
    v_cvt_pk_bf16_f32 v141, 0, v141
    v_add_f32 v148, v148, v140
    v_add_f32 v149, v149, v141
    v_cvt_pk_bf16_f32 v54, v148, v149
    v_lshlrev_b32 v148, 16, v54
    v_and_b32 v149, 0xffff0000, v54
    v_lshlrev_b32 v34, 16, v51
    v_and_b32 v35, 0xffff0000, v51
    v_cvt_pk_bf16_f32 v134, 0, v134
    v_cvt_pk_bf16_f32 v135, 0, v135
    v_mul_f32 v134, v134, v34
    v_mul_f32 v135, v135, v35
    v_cvt_pk_bf16_f32 v134, 0, v134
    v_cvt_pk_bf16_f32 v135, 0, v135
    v_add_f32 v16, v16, v134
    v_add_f32 v17, v17, v135
    v_cvt_pk_bf16_f32 v23, v16, v17
    v_lshlrev_b32 v16, 16, v23
    v_and_b32 v17, 0xffff0000, v23
    v_cvt_pk_bf16_f32 v142, 0, v142
    v_cvt_pk_bf16_f32 v143, 0, v143
    v_mul_f32 v142, v142, v34
    v_mul_f32 v143, v143, v35
    v_cvt_pk_bf16_f32 v142, 0, v142
    v_cvt_pk_bf16_f32 v143, 0, v143
    v_add_f32 v150, v150, v142
    v_add_f32 v151, v151, v143
    v_cvt_pk_bf16_f32 v55, v150, v151
    v_lshlrev_b32 v150, 16, v55
    v_and_b32 v151, 0xffff0000, v55
    buffer_store_dwordx4 v[20:23], v3, s[64:67], 0 offen
    buffer_store_dwordx4 v[52:55], v3, s[64:67], 0 offen offset:896
    s_mov_b64 exec, -1
    s_waitcnt vmcnt(0)
    s_branch Lfin_82
Lfs_80:
    s_add_u32 s57, s57, 1
    s_cmp_ge_u32 s57, 4096
    s_cbranch_scc1 Lfc_81
    s_sleep 2
    s_mov_b32 s40, 33554432
    buffer_load_dwordx4 v[160:163], v5, s[24:27], s40 offen sc1
    buffer_load_dwordx4 v[164:167], v5, s[24:27], s40 offen offset:16 sc1
    s_mov_b32 s40, 35389440
    buffer_load_dwordx4 v[168:171], v5, s[24:27], s40 offen sc1
    buffer_load_dwordx4 v[172:175], v5, s[24:27], s40 offen offset:16 sc1
    s_mov_b32 s40, 37224448
    buffer_load_dwordx4 v[176:179], v5, s[24:27], s40 offen sc1
    buffer_load_dwordx4 v[180:183], v5, s[24:27], s40 offen offset:16 sc1
    s_mov_b32 s40, 39059456
    buffer_load_dwordx4 v[184:187], v5, s[24:27], s40 offen sc1
    buffer_load_dwordx4 v[188:191], v5, s[24:27], s40 offen offset:16 sc1
    s_mov_b32 s40, 40894464
    buffer_load_dwordx4 v[192:195], v5, s[24:27], s40 offen sc1
    buffer_load_dwordx4 v[196:199], v5, s[24:27], s40 offen offset:16 sc1
    s_mov_b32 s40, 42729472
    buffer_load_dwordx4 v[200:203], v5, s[24:27], s40 offen sc1
    buffer_load_dwordx4 v[204:207], v5, s[24:27], s40 offen offset:16 sc1
    s_mov_b32 s40, 44564480
    buffer_load_dwordx4 v[208:211], v5, s[24:27], s40 offen sc1
    buffer_load_dwordx4 v[212:215], v5, s[24:27], s40 offen offset:16 sc1
    s_mov_b32 s40, 46399488
    buffer_load_dwordx4 v[216:219], v5, s[24:27], s40 offen sc1
    buffer_load_dwordx4 v[220:223], v5, s[24:27], s40 offen offset:16 sc1
    s_waitcnt vmcnt(0)
    s_branch Lfr_79
Lls_45:
    s_add_u32 s57, s57, 1
    s_cmp_ge_u32 s57, 4096
    s_cbranch_scc1 Llc_46
    s_sleep 2
    s_mov_b32 s40, 16777216
    buffer_load_dwordx4 v[160:163], v5, s[24:27], s40 offen sc1
    buffer_load_dwordx4 v[164:167], v5, s[24:27], s40 offen offset:16 sc1
    s_mov_b32 s40, 18612224
    buffer_load_dwordx4 v[168:171], v5, s[24:27], s40 offen sc1
    buffer_load_dwordx4 v[172:175], v5, s[24:27], s40 offen offset:16 sc1
    s_mov_b32 s40, 20447232
    buffer_load_dwordx4 v[176:179], v5, s[24:27], s40 offen sc1
    buffer_load_dwordx4 v[180:183], v5, s[24:27], s40 offen offset:16 sc1
    s_mov_b32 s40, 22282240
    buffer_load_dwordx4 v[184:187], v5, s[24:27], s40 offen sc1
    buffer_load_dwordx4 v[188:191], v5, s[24:27], s40 offen offset:16 sc1
    s_mov_b32 s40, 24117248
    buffer_load_dwordx4 v[192:195], v5, s[24:27], s40 offen sc1
    buffer_load_dwordx4 v[196:199], v5, s[24:27], s40 offen offset:16 sc1
    s_mov_b32 s40, 25952256
    buffer_load_dwordx4 v[200:203], v5, s[24:27], s40 offen sc1
    buffer_load_dwordx4 v[204:207], v5, s[24:27], s40 offen offset:16 sc1
    s_mov_b32 s40, 27787264
    buffer_load_dwordx4 v[208:211], v5, s[24:27], s40 offen sc1
    buffer_load_dwordx4 v[212:215], v5, s[24:27], s40 offen offset:16 sc1
    s_mov_b32 s40, 29622272
    buffer_load_dwordx4 v[216:219], v5, s[24:27], s40 offen sc1
    buffer_load_dwordx4 v[220:223], v5, s[24:27], s40 offen offset:16 sc1
    s_waitcnt vmcnt(0)
    s_branch Llr_44
Lhs_55:
    s_add_u32 s57, s57, 1
    s_cmp_ge_u32 s57, 4096
    s_cbranch_scc1 Lhc_56
    s_sleep 2
    s_add_u32 s75, s74, 0
    buffer_load_dwordx4 a[0:3], v111, s[24:27], s75 offen offset:0 sc1
    buffer_load_dwordx4 a[4:7], v111, s[24:27], s75 offen offset:1024 sc1
    buffer_load_dwordx4 a[8:11], v111, s[24:27], s75 offen offset:2048 sc1
    buffer_load_dwordx4 a[12:15], v111, s[24:27], s75 offen offset:3072 sc1
    s_waitcnt vmcnt(0)
    s_branch Lhr_54
Lhs_58:
    s_add_u32 s57, s57, 1
    s_cmp_ge_u32 s57, 4096
    s_cbranch_scc1 Lhc_59
    s_sleep 2
    s_add_u32 s75, s74, 4096
    buffer_load_dwordx4 a[16:19], v111, s[24:27], s75 offen offset:0 sc1
    buffer_load_dwordx4 a[20:23], v111, s[24:27], s75 offen offset:1024 sc1
    buffer_load_dwordx4 a[24:27], v111, s[24:27], s75 offen offset:2048 sc1
    buffer_load_dwordx4 a[28:31], v111, s[24:27], s75 offen offset:3072 sc1
    s_waitcnt vmcnt(0)
    s_branch Lhr_57
Lhs_61:
    s_add_u32 s57, s57, 1
    s_cmp_ge_u32 s57, 4096
    s_cbranch_scc1 Lhc_62
    s_sleep 2
    s_add_u32 s75, s74, 8192
    buffer_load_dwordx4 a[32:35], v111, s[24:27], s75 offen offset:0 sc1
    buffer_load_dwordx4 a[36:39], v111, s[24:27], s75 offen offset:1024 sc1
    buffer_load_dwordx4 a[40:43], v111, s[24:27], s75 offen offset:2048 sc1
    buffer_load_dwordx4 a[44:47], v111, s[24:27], s75 offen offset:3072 sc1
    s_waitcnt vmcnt(0)
    s_branch Lhr_60
Lhs_64:
    s_add_u32 s57, s57, 1
    s_cmp_ge_u32 s57, 4096
    s_cbranch_scc1 Lhc_65
    s_sleep 2
    s_add_u32 s75, s74, 12288
    buffer_load_dwordx4 a[48:51], v111, s[24:27], s75 offen offset:0 sc1
    buffer_load_dwordx4 a[52:55], v111, s[24:27], s75 offen offset:1024 sc1
    buffer_load_dwordx4 a[56:59], v111, s[24:27], s75 offen offset:2048 sc1
    buffer_load_dwordx4 a[60:63], v111, s[24:27], s75 offen offset:3072 sc1
    s_waitcnt vmcnt(0)
    s_branch Lhr_63
Lhs_67:
    s_add_u32 s57, s57, 1
    s_cmp_ge_u32 s57, 4096
    s_cbranch_scc1 Lhc_68
    s_sleep 2
    s_add_u32 s75, s74, 16384
    buffer_load_dwordx4 a[64:67], v111, s[24:27], s75 offen offset:0 sc1
    buffer_load_dwordx4 a[68:71], v111, s[24:27], s75 offen offset:1024 sc1
    buffer_load_dwordx4 a[72:75], v111, s[24:27], s75 offen offset:2048 sc1
    buffer_load_dwordx4 a[76:79], v111, s[24:27], s75 offen offset:3072 sc1
    s_waitcnt vmcnt(0)
    s_branch Lhr_66
Lhs_70:
    s_add_u32 s57, s57, 1
    s_cmp_ge_u32 s57, 4096
    s_cbranch_scc1 Lhc_71
    s_sleep 2
    s_add_u32 s75, s74, 20480
    buffer_load_dwordx4 a[80:83], v111, s[24:27], s75 offen offset:0 sc1
    buffer_load_dwordx4 a[84:87], v111, s[24:27], s75 offen offset:1024 sc1
    buffer_load_dwordx4 a[88:91], v111, s[24:27], s75 offen offset:2048 sc1
    buffer_load_dwordx4 a[92:95], v111, s[24:27], s75 offen offset:3072 sc1
    s_waitcnt vmcnt(0)
    s_branch Lhr_69
Lhs_73:
    s_add_u32 s57, s57, 1
    s_cmp_ge_u32 s57, 4096
    s_cbranch_scc1 Lhc_74
    s_sleep 2
    s_add_u32 s75, s74, 24576
    buffer_load_dwordx4 a[96:99], v111, s[24:27], s75 offen offset:0 sc1
    buffer_load_dwordx4 a[100:103], v111, s[24:27], s75 offen offset:1024 sc1
    buffer_load_dwordx4 a[104:107], v111, s[24:27], s75 offen offset:2048 sc1
    buffer_load_dwordx4 a[108:111], v111, s[24:27], s75 offen offset:3072 sc1
    s_waitcnt vmcnt(0)
    s_branch Lhr_72
Lfin_82:
Lat_end_1:
    s_endpgm
LswV_5:
    s_mov_b32 s80, s12
    v_mov_b32 v112, v18
    s_mov_b32 s81, s13
    v_mov_b32 v113, v19
    s_mov_b32 s82, s14
    v_mov_b32 v114, v18
    s_mov_b32 s83, s15
    v_mov_b32 v115, v19
    s_lshl_b32 s42, s29, 20
    s_mov_b32 s84, 16384
    s_branch Lback_7
LswK_6:
    s_mov_b32 s80, s8
    v_mov_b32 v112, v14
    s_mov_b32 s81, s9
    v_mov_b32 v113, v15
    s_mov_b32 s82, s10
    v_mov_b32 v114, v16
    s_mov_b32 s83, s11
    v_mov_b32 v115, v17
    s_lshl_b32 s42, s29, 20
    s_branch Lback_7
Lslow_14:
    s_mov_b32 s88, 0
    s_branch Lsub_83
Lslow_22:
    s_mov_b32 s88, 1
Lsub_83:
    v_max3_f32 v26, v56, v57, v58
    v_max3_f32 v26, v26, v59, v60
    v_max3_f32 v26, v26, v61, v62
    v_max3_f32 v26, v26, v63, v64
    v_max3_f32 v26, v26, v65, v66
    v_max3_f32 v26, v26, v67, v68
    v_max3_f32 v26, v26, v69, v70
    v_max_f32 v26, v26, v71
    v_mov_b32 v27, v26
    s_nop 1
    v_permlane32_swap_b32 v26, v27
    s_nop 1
    v_max_f32 v26, v26, v27
    v_cvt_pk_bf16_f32 v26, 0, v26
    v_mov_b32 v28, 0x42400000
    v_fma_f32 v26, v26, s36, v28
    v_max_f32 v26, v26, v21
    v_sub_f32 v27, v21, v26
    v_exp_f32 v27, v27
    v_mov_b32 v21, v26
    s_nop 7
    s_nop 7
    v_mul_f32 v23, v23, v27
    v_accvgpr_read_b32 v32, a128
    v_accvgpr_read_b32 v33, a129
    v_accvgpr_read_b32 v34, a130
    v_accvgpr_read_b32 v35, a131
    v_mul_f32 v32, v32, v27
    v_mul_f32 v33, v33, v27
    v_mul_f32 v34, v34, v27
    v_mul_f32 v35, v35, v27
    v_accvgpr_write_b32 a128, v32
    v_accvgpr_write_b32 a129, v33
    v_accvgpr_write_b32 a130, v34
    v_accvgpr_write_b32 a131, v35
    v_accvgpr_read_b32 v32, a132
    v_accvgpr_read_b32 v33, a133
    v_accvgpr_read_b32 v34, a134
    v_accvgpr_read_b32 v35, a135
    v_mul_f32 v32, v32, v27
    v_mul_f32 v33, v33, v27
    v_mul_f32 v34, v34, v27
    v_mul_f32 v35, v35, v27
    v_accvgpr_write_b32 a132, v32
    v_accvgpr_write_b32 a133, v33
    v_accvgpr_write_b32 a134, v34
    v_accvgpr_write_b32 a135, v35
    v_accvgpr_read_b32 v32, a136
    v_accvgpr_read_b32 v33, a137
    v_accvgpr_read_b32 v34, a138
    v_accvgpr_read_b32 v35, a139
    v_mul_f32 v32, v32, v27
    v_mul_f32 v33, v33, v27
    v_mul_f32 v34, v34, v27
    v_mul_f32 v35, v35, v27
    v_accvgpr_write_b32 a136, v32
    v_accvgpr_write_b32 a137, v33
    v_accvgpr_write_b32 a138, v34
    v_accvgpr_write_b32 a139, v35
    v_accvgpr_read_b32 v32, a140
    v_accvgpr_read_b32 v33, a141
    v_accvgpr_read_b32 v34, a142
    v_accvgpr_read_b32 v35, a143
    v_mul_f32 v32, v32, v27
    v_mul_f32 v33, v33, v27
    v_mul_f32 v34, v34, v27
    v_mul_f32 v35, v35, v27
    v_accvgpr_write_b32 a140, v32
    v_accvgpr_write_b32 a141, v33
    v_accvgpr_write_b32 a142, v34
    v_accvgpr_write_b32 a143, v35
    v_accvgpr_read_b32 v32, a144
    v_accvgpr_read_b32 v33, a145
    v_accvgpr_read_b32 v34, a146
    v_accvgpr_read_b32 v35, a147
    v_mul_f32 v32, v32, v27
    v_mul_f32 v33, v33, v27
    v_mul_f32 v34, v34, v27
    v_mul_f32 v35, v35, v27
    v_accvgpr_write_b32 a144, v32
    v_accvgpr_write_b32 a145, v33
    v_accvgpr_write_b32 a146, v34
    v_accvgpr_write_b32 a147, v35
    v_accvgpr_read_b32 v32, a148
    v_accvgpr_read_b32 v33, a149
    v_accvgpr_read_b32 v34, a150
    v_accvgpr_read_b32 v35, a151
    v_mul_f32 v32, v32, v27
    v_mul_f32 v33, v33, v27
    v_mul_f32 v34, v34, v27
    v_mul_f32 v35, v35, v27
    v_accvgpr_write_b32 a148, v32
    v_accvgpr_write_b32 a149, v33
    v_accvgpr_write_b32 a150, v34
    v_accvgpr_write_b32 a151, v35
    v_accvgpr_read_b32 v32, a152
    v_accvgpr_read_b32 v33, a153
    v_accvgpr_read_b32 v34, a154
    v_accvgpr_read_b32 v35, a155
    v_mul_f32 v32, v32, v27
    v_mul_f32 v33, v33, v27
    v_mul_f32 v34, v34, v27
    v_mul_f32 v35, v35, v27
    v_accvgpr_write_b32 a152, v32
    v_accvgpr_write_b32 a153, v33
    v_accvgpr_write_b32 a154, v34
    v_accvgpr_write_b32 a155, v35
    v_accvgpr_read_b32 v32, a156
    v_accvgpr_read_b32 v33, a157
    v_accvgpr_read_b32 v34, a158
    v_accvgpr_read_b32 v35, a159
    v_mul_f32 v32, v32, v27
    v_mul_f32 v33, v33, v27
    v_mul_f32 v34, v34, v27
    v_mul_f32 v35, v35, v27
    v_accvgpr_write_b32 a156, v32
    v_accvgpr_write_b32 a157, v33
    v_accvgpr_write_b32 a158, v34
    v_accvgpr_write_b32 a159, v35
    v_accvgpr_read_b32 v32, a160
    v_accvgpr_read_b32 v33, a161
    v_accvgpr_read_b32 v34, a162
    v_accvgpr_read_b32 v35, a163
    v_mul_f32 v32, v32, v27
    v_mul_f32 v33, v33, v27
    v_mul_f32 v34, v34, v27
    v_mul_f32 v35, v35, v27
    v_accvgpr_write_b32 a160, v32
    v_accvgpr_write_b32 a161, v33
    v_accvgpr_write_b32 a162, v34
    v_accvgpr_write_b32 a163, v35
    v_accvgpr_read_b32 v32, a164
    v_accvgpr_read_b32 v33, a165
    v_accvgpr_read_b32 v34, a166
    v_accvgpr_read_b32 v35, a167
    v_mul_f32 v32, v32, v27
    v_mul_f32 v33, v33, v27
    v_mul_f32 v34, v34, v27
    v_mul_f32 v35, v35, v27
    v_accvgpr_write_b32 a164, v32
    v_accvgpr_write_b32 a165, v33
    v_accvgpr_write_b32 a166, v34
    v_accvgpr_write_b32 a167, v35
    v_accvgpr_read_b32 v32, a168
    v_accvgpr_read_b32 v33, a169
    v_accvgpr_read_b32 v34, a170
    v_accvgpr_read_b32 v35, a171
    v_mul_f32 v32, v32, v27
    v_mul_f32 v33, v33, v27
    v_mul_f32 v34, v34, v27
    v_mul_f32 v35, v35, v27
    v_accvgpr_write_b32 a168, v32
    v_accvgpr_write_b32 a169, v33
    v_accvgpr_write_b32 a170, v34
    v_accvgpr_write_b32 a171, v35
    v_accvgpr_read_b32 v32, a172
    v_accvgpr_read_b32 v33, a173
    v_accvgpr_read_b32 v34, a174
    v_accvgpr_read_b32 v35, a175
    v_mul_f32 v32, v32, v27
    v_mul_f32 v33, v33, v27
    v_mul_f32 v34, v34, v27
    v_mul_f32 v35, v35, v27
    v_accvgpr_write_b32 a172, v32
    v_accvgpr_write_b32 a173, v33
    v_accvgpr_write_b32 a174, v34
    v_accvgpr_write_b32 a175, v35
    v_accvgpr_read_b32 v32, a176
    v_accvgpr_read_b32 v33, a177
    v_accvgpr_read_b32 v34, a178
    v_accvgpr_read_b32 v35, a179
    v_mul_f32 v32, v32, v27
    v_mul_f32 v33, v33, v27
    v_mul_f32 v34, v34, v27
    v_mul_f32 v35, v35, v27
    v_accvgpr_write_b32 a176, v32
    v_accvgpr_write_b32 a177, v33
    v_accvgpr_write_b32 a178, v34
    v_accvgpr_write_b32 a179, v35
    v_accvgpr_read_b32 v32, a180
    v_accvgpr_read_b32 v33, a181
    v_accvgpr_read_b32 v34, a182
    v_accvgpr_read_b32 v35, a183
    v_mul_f32 v32, v32, v27
    v_mul_f32 v33, v33, v27
    v_mul_f32 v34, v34, v27
    v_mul_f32 v35, v35, v27
    v_accvgpr_write_b32 a180, v32
    v_accvgpr_write_b32 a181, v33
    v_accvgpr_write_b32 a182, v34
    v_accvgpr_write_b32 a183, v35
    v_accvgpr_read_b32 v32, a184
    v_accvgpr_read_b32 v33, a185
    v_accvgpr_read_b32 v34, a186
    v_accvgpr_read_b32 v35, a187
    v_mul_f32 v32, v32, v27
    v_mul_f32 v33, v33, v27
    v_mul_f32 v34, v34, v27
    v_mul_f32 v35, v35, v27
    v_accvgpr_write_b32 a184, v32
    v_accvgpr_write_b32 a185, v33
    v_accvgpr_write_b32 a186, v34
    v_accvgpr_write_b32 a187, v35
    v_accvgpr_read_b32 v32, a188
    v_accvgpr_read_b32 v33, a189
    v_accvgpr_read_b32 v34, a190
    v_accvgpr_read_b32 v35, a191
    v_mul_f32 v32, v32, v27
    v_mul_f32 v33, v33, v27
    v_mul_f32 v34, v34, v27
    v_mul_f32 v35, v35, v27
    v_accvgpr_write_b32 a188, v32
    v_accvgpr_write_b32 a189, v33
    v_accvgpr_write_b32 a190, v34
    v_accvgpr_write_b32 a191, v35
    v_accvgpr_read_b32 v32, a192
    v_accvgpr_read_b32 v33, a193
    v_accvgpr_read_b32 v34, a194
    v_accvgpr_read_b32 v35, a195
    v_mul_f32 v32, v32, v27
    v_mul_f32 v33, v33, v27
    v_mul_f32 v34, v34, v27
    v_mul_f32 v35, v35, v27
    v_accvgpr_write_b32 a192, v32
    v_accvgpr_write_b32 a193, v33
    v_accvgpr_write_b32 a194, v34
    v_accvgpr_write_b32 a195, v35
    v_accvgpr_read_b32 v32, a196
    v_accvgpr_read_b32 v33, a197
    v_accvgpr_read_b32 v34, a198
    v_accvgpr_read_b32 v35, a199
    v_mul_f32 v32, v32, v27
    v_mul_f32 v33, v33, v27
    v_mul_f32 v34, v34, v27
    v_mul_f32 v35, v35, v27
    v_accvgpr_write_b32 a196, v32
    v_accvgpr_write_b32 a197, v33
    v_accvgpr_write_b32 a198, v34
    v_accvgpr_write_b32 a199, v35
    v_accvgpr_read_b32 v32, a200
    v_accvgpr_read_b32 v33, a201
    v_accvgpr_read_b32 v34, a202
    v_accvgpr_read_b32 v35, a203
    v_mul_f32 v32, v32, v27
    v_mul_f32 v33, v33, v27
    v_mul_f32 v34, v34, v27
    v_mul_f32 v35, v35, v27
    v_accvgpr_write_b32 a200, v32
    v_accvgpr_write_b32 a201, v33
    v_accvgpr_write_b32 a202, v34
    v_accvgpr_write_b32 a203, v35
    v_accvgpr_read_b32 v32, a204
    v_accvgpr_read_b32 v33, a205
    v_accvgpr_read_b32 v34, a206
    v_accvgpr_read_b32 v35, a207
    v_mul_f32 v32, v32, v27
    v_mul_f32 v33, v33, v27
    v_mul_f32 v34, v34, v27
    v_mul_f32 v35, v35, v27
    v_accvgpr_write_b32 a204, v32
    v_accvgpr_write_b32 a205, v33
    v_accvgpr_write_b32 a206, v34
    v_accvgpr_write_b32 a207, v35
    v_accvgpr_read_b32 v32, a208
    v_accvgpr_read_b32 v33, a209
    v_accvgpr_read_b32 v34, a210
    v_accvgpr_read_b32 v35, a211
    v_mul_f32 v32, v32, v27
    v_mul_f32 v33, v33, v27
    v_mul_f32 v34, v34, v27
    v_mul_f32 v35, v35, v27
    v_accvgpr_write_b32 a208, v32
    v_accvgpr_write_b32 a209, v33
    v_accvgpr_write_b32 a210, v34
    v_accvgpr_write_b32 a211, v35
    v_accvgpr_read_b32 v32, a212
    v_accvgpr_read_b32 v33, a213
    v_accvgpr_read_b32 v34, a214
    v_accvgpr_read_b32 v35, a215
    v_mul_f32 v32, v32, v27
    v_mul_f32 v33, v33, v27
    v_mul_f32 v34, v34, v27
    v_mul_f32 v35, v35, v27
    v_accvgpr_write_b32 a212, v32
    v_accvgpr_write_b32 a213, v33
    v_accvgpr_write_b32 a214, v34
    v_accvgpr_write_b32 a215, v35
    v_accvgpr_read_b32 v32, a216
    v_accvgpr_read_b32 v33, a217
    v_accvgpr_read_b32 v34, a218
    v_accvgpr_read_b32 v35, a219
    v_mul_f32 v32, v32, v27
    v_mul_f32 v33, v33, v27
    v_mul_f32 v34, v34, v27
    v_mul_f32 v35, v35, v27
    v_accvgpr_write_b32 a216, v32
    v_accvgpr_write_b32 a217, v33
    v_accvgpr_write_b32 a218, v34
    v_accvgpr_write_b32 a219, v35
    v_accvgpr_read_b32 v32, a220
    v_accvgpr_read_b32 v33, a221
    v_accvgpr_read_b32 v34, a222
    v_accvgpr_read_b32 v35, a223
    v_mul_f32 v32, v32, v27
    v_mul_f32 v33, v33, v27
    v_mul_f32 v34, v34, v27
    v_mul_f32 v35, v35, v27
    v_accvgpr_write_b32 a220, v32
    v_accvgpr_write_b32 a221, v33
    v_accvgpr_write_b32 a222, v34
    v_accvgpr_write_b32 a223, v35
    v_accvgpr_read_b32 v32, a224
    v_accvgpr_read_b32 v33, a225
    v_accvgpr_read_b32 v34, a226
    v_accvgpr_read_b32 v35, a227
    v_mul_f32 v32, v32, v27
    v_mul_f32 v33, v33, v27
    v_mul_f32 v34, v34, v27
    v_mul_f32 v35, v35, v27
    v_accvgpr_write_b32 a224, v32
    v_accvgpr_write_b32 a225, v33
    v_accvgpr_write_b32 a226, v34
    v_accvgpr_write_b32 a227, v35
    v_accvgpr_read_b32 v32, a228
    v_accvgpr_read_b32 v33, a229
    v_accvgpr_read_b32 v34, a230
    v_accvgpr_read_b32 v35, a231
    v_mul_f32 v32, v32, v27
    v_mul_f32 v33, v33, v27
    v_mul_f32 v34, v34, v27
    v_mul_f32 v35, v35, v27
    v_accvgpr_write_b32 a228, v32
    v_accvgpr_write_b32 a229, v33
    v_accvgpr_write_b32 a230, v34
    v_accvgpr_write_b32 a231, v35
    v_accvgpr_read_b32 v32, a232
    v_accvgpr_read_b32 v33, a233
    v_accvgpr_read_b32 v34, a234
    v_accvgpr_read_b32 v35, a235
    v_mul_f32 v32, v32, v27
    v_mul_f32 v33, v33, v27
    v_mul_f32 v34, v34, v27
    v_mul_f32 v35, v35, v27
    v_accvgpr_write_b32 a232, v32
    v_accvgpr_write_b32 a233, v33
    v_accvgpr_write_b32 a234, v34
    v_accvgpr_write_b32 a235, v35
    v_accvgpr_read_b32 v32, a236
    v_accvgpr_read_b32 v33, a237
    v_accvgpr_read_b32 v34, a238
    v_accvgpr_read_b32 v35, a239
    v_mul_f32 v32, v32, v27
    v_mul_f32 v33, v33, v27
    v_mul_f32 v34, v34, v27
    v_mul_f32 v35, v35, v27
    v_accvgpr_write_b32 a236, v32
    v_accvgpr_write_b32 a237, v33
    v_accvgpr_write_b32 a238, v34
    v_accvgpr_write_b32 a239, v35
    v_accvgpr_read_b32 v32, a240
    v_accvgpr_read_b32 v33, a241
    v_accvgpr_read_b32 v34, a242
    v_accvgpr_read_b32 v35, a243
    v_mul_f32 v32, v32, v27
    v_mul_f32 v33, v33, v27
    v_mul_f32 v34, v34, v27
    v_mul_f32 v35, v35, v27
    v_accvgpr_write_b32 a240, v32
    v_accvgpr_write_b32 a241, v33
    v_accvgpr_write_b32 a242, v34
    v_accvgpr_write_b32 a243, v35
    v_accvgpr_read_b32 v32, a244
    v_accvgpr_read_b32 v33, a245
    v_accvgpr_read_b32 v34, a246
    v_accvgpr_read_b32 v35, a247
    v_mul_f32 v32, v32, v27
    v_mul_f32 v33, v33, v27
    v_mul_f32 v34, v34, v27
    v_mul_f32 v35, v35, v27
    v_accvgpr_write_b32 a244, v32
    v_accvgpr_write_b32 a245, v33
    v_accvgpr_write_b32 a246, v34
    v_accvgpr_write_b32 a247, v35
    v_accvgpr_read_b32 v32, a248
    v_accvgpr_read_b32 v33, a249
    v_accvgpr_read_b32 v34, a250
    v_accvgpr_read_b32 v35, a251
    v_mul_f32 v32, v32, v27
    v_mul_f32 v33, v33, v27
    v_mul_f32 v34, v34, v27
    v_mul_f32 v35, v35, v27
    v_accvgpr_write_b32 a248, v32
    v_accvgpr_write_b32 a249, v33
    v_accvgpr_write_b32 a250, v34
    v_accvgpr_write_b32 a251, v35
    v_accvgpr_read_b32 v32, a252
    v_accvgpr_read_b32 v33, a253
    v_accvgpr_read_b32 v34, a254
    v_accvgpr_read_b32 v35, a255
    v_mul_f32 v32, v32, v27
    v_mul_f32 v33, v33, v27
    v_mul_f32 v34, v34, v27
    v_mul_f32 v35, v35, v27
    v_accvgpr_write_b32 a252, v32
    v_accvgpr_write_b32 a253, v33
    v_accvgpr_write_b32 a254, v34
    v_accvgpr_write_b32 a255, v35
    v_cvt_pk_bf16_f32 v26, 0, v56
    v_cvt_pk_bf16_f32 v27, 0, v57
    v_fma_f32 v26, v26, s36, -v21
    v_fma_f32 v27, v27, s36, -v21
    v_exp_f32 v26, v26
    v_exp_f32 v27, v27
    v_cvt_pk_bf16_f32 v28, 0, v58
    v_add_f32 v24, v26, v27
    v_cvt_pk_bf16_f32 v104, v26, v27
    v_cvt_pk_bf16_f32 v29, 0, v59
    v_fma_f32 v28, v28, s36, -v21
    v_fma_f32 v29, v29, s36, -v21
    v_exp_f32 v28, v28
    v_exp_f32 v29, v29
    v_cvt_pk_bf16_f32 v30, 0, v60
    v_add_f32 v25, v28, v29
    v_cvt_pk_bf16_f32 v105, v28, v29
    v_cvt_pk_bf16_f32 v31, 0, v61
    v_fma_f32 v30, v30, s36, -v21
    v_fma_f32 v31, v31, s36, -v21
    v_exp_f32 v30, v30
    v_exp_f32 v31, v31
    v_cvt_pk_bf16_f32 v26, 0, v62
    v_add_f32 v24, v24, v30
    v_add_f32 v25, v25, v31
    v_cvt_pk_bf16_f32 v106, v30, v31
    v_cvt_pk_bf16_f32 v27, 0, v63
    v_fma_f32 v26, v26, s36, -v21
    v_fma_f32 v27, v27, s36, -v21
    v_exp_f32 v26, v26
    v_exp_f32 v27, v27
    v_cvt_pk_bf16_f32 v28, 0, v64
    v_add_f32 v24, v24, v26
    v_add_f32 v25, v25, v27
    v_cvt_pk_bf16_f32 v107, v26, v27
    v_cvt_pk_bf16_f32 v29, 0, v65
    v_fma_f32 v28, v28, s36, -v21
    v_fma_f32 v29, v29, s36, -v21
    v_exp_f32 v28, v28
    v_exp_f32 v29, v29
    v_cvt_pk_bf16_f32 v30, 0, v66
    v_add_f32 v24, v24, v28
    v_add_f32 v25, v25, v29
    v_cvt_pk_bf16_f32 v108, v28, v29
    v_cvt_pk_bf16_f32 v31, 0, v67
    v_fma_f32 v30, v30, s36, -v21
    v_fma_f32 v31, v31, s36, -v21
    v_exp_f32 v30, v30
    v_exp_f32 v31, v31
    v_cvt_pk_bf16_f32 v26, 0, v68
    v_add_f32 v24, v24, v30
    v_add_f32 v25, v25, v31
    v_cvt_pk_bf16_f32 v109, v30, v31
    v_cvt_pk_bf16_f32 v27, 0, v69
    v_fma_f32 v26, v26, s36, -v21
    v_fma_f32 v27, v27, s36, -v21
    v_exp_f32 v26, v26
    v_exp_f32 v27, v27
    v_cvt_pk_bf16_f32 v28, 0, v70
    v_add_f32 v24, v24, v26
    v_add_f32 v25, v25, v27
    v_cvt_pk_bf16_f32 v110, v26, v27
    v_cvt_pk_bf16_f32 v29, 0, v71
    v_fma_f32 v28, v28, s36, -v21
    v_fma_f32 v29, v29, s36, -v21
    v_exp_f32 v28, v28
    v_exp_f32 v29, v29
    s_nop 0
    v_add_f32 v24, v24, v28
    v_add_f32 v25, v25, v29
    v_cvt_pk_bf16_f32 v111, v28, v29
    v_add_f32 v24, v24, v25
    s_nop 1
    s_cmp_eq_u32 s88, 0
    s_cbranch_scc1 Lret_15
    s_branch Lret_23
Lslow_16:
    s_mov_b32 s88, 0
    s_branch Lsub_84
Lslow_24:
    s_mov_b32 s88, 1
Lsub_84:
    v_max3_f32 v26, v40, v41, v42
    v_max3_f32 v26, v26, v43, v44
    v_max3_f32 v26, v26, v45, v46
    v_max3_f32 v26, v26, v47, v48
    v_max3_f32 v26, v26, v49, v50
    v_max3_f32 v26, v26, v51, v52
    v_max3_f32 v26, v26, v53, v54
    v_max_f32 v26, v26, v55
    v_mov_b32 v27, v26
    s_nop 1
    v_permlane32_swap_b32 v26, v27
    s_nop 1
    v_max_f32 v26, v26, v27
    v_cvt_pk_bf16_f32 v26, 0, v26
    v_mov_b32 v28, 0x42400000
    v_fma_f32 v26, v26, s36, v28
    v_max_f32 v26, v26, v20
    v_sub_f32 v27, v20, v26
    v_exp_f32 v27, v27
    v_mov_b32 v20, v26
    s_nop 7
    s_nop 7
    v_mul_f32 v22, v22, v27
    v_mul_f32 v128, v128, v27
    v_mul_f32 v129, v129, v27
    v_mul_f32 v130, v130, v27
    v_mul_f32 v131, v131, v27
    v_mul_f32 v132, v132, v27
    v_mul_f32 v133, v133, v27
    v_mul_f32 v134, v134, v27
    v_mul_f32 v135, v135, v27
    v_mul_f32 v136, v136, v27
    v_mul_f32 v137, v137, v27
    v_mul_f32 v138, v138, v27
    v_mul_f32 v139, v139, v27
    v_mul_f32 v140, v140, v27
    v_mul_f32 v141, v141, v27
    v_mul_f32 v142, v142, v27
    v_mul_f32 v143, v143, v27
    v_mul_f32 v144, v144, v27
    v_mul_f32 v145, v145, v27
    v_mul_f32 v146, v146, v27
    v_mul_f32 v147, v147, v27
    v_mul_f32 v148, v148, v27
    v_mul_f32 v149, v149, v27
    v_mul_f32 v150, v150, v27
    v_mul_f32 v151, v151, v27
    v_mul_f32 v152, v152, v27
    v_mul_f32 v153, v153, v27
    v_mul_f32 v154, v154, v27
    v_mul_f32 v155, v155, v27
    v_mul_f32 v156, v156, v27
    v_mul_f32 v157, v157, v27
    v_mul_f32 v158, v158, v27
    v_mul_f32 v159, v159, v27
    v_mul_f32 v160, v160, v27
    v_mul_f32 v161, v161, v27
    v_mul_f32 v162, v162, v27
    v_mul_f32 v163, v163, v27
    v_mul_f32 v164, v164, v27
    v_mul_f32 v165, v165, v27
    v_mul_f32 v166, v166, v27
    v_mul_f32 v167, v167, v27
    v_mul_f32 v168, v168, v27
    v_mul_f32 v169, v169, v27
    v_mul_f32 v170, v170, v27
    v_mul_f32 v171, v171, v27
    v_mul_f32 v172, v172, v27
    v_mul_f32 v173, v173, v27
    v_mul_f32 v174, v174, v27
    v_mul_f32 v175, v175, v27
    v_mul_f32 v176, v176, v27
    v_mul_f32 v177, v177, v27
    v_mul_f32 v178, v178, v27
    v_mul_f32 v179, v179, v27
    v_mul_f32 v180, v180, v27
    v_mul_f32 v181, v181, v27
    v_mul_f32 v182, v182, v27
    v_mul_f32 v183, v183, v27
    v_mul_f32 v184, v184, v27
    v_mul_f32 v185, v185, v27
    v_mul_f32 v186, v186, v27
    v_mul_f32 v187, v187, v27
    v_mul_f32 v188, v188, v27
    v_mul_f32 v189, v189, v27
    v_mul_f32 v190, v190, v27
    v_mul_f32 v191, v191, v27
    v_mul_f32 v192, v192, v27
    v_mul_f32 v193, v193, v27
    v_mul_f32 v194, v194, v27
    v_mul_f32 v195, v195, v27
    v_mul_f32 v196, v196, v27
    v_mul_f32 v197, v197, v27
    v_mul_f32 v198, v198, v27
    v_mul_f32 v199, v199, v27
    v_mul_f32 v200, v200, v27
    v_mul_f32 v201, v201, v27
    v_mul_f32 v202, v202, v27
    v_mul_f32 v203, v203, v27
    v_mul_f32 v204, v204, v27
    v_mul_f32 v205, v205, v27
    v_mul_f32 v206, v206, v27
    v_mul_f32 v207, v207, v27
    v_mul_f32 v208, v208, v27
    v_mul_f32 v209, v209, v27
    v_mul_f32 v210, v210, v27
    v_mul_f32 v211, v211, v27
    v_mul_f32 v212, v212, v27
    v_mul_f32 v213, v213, v27
    v_mul_f32 v214, v214, v27
    v_mul_f32 v215, v215, v27
    v_mul_f32 v216, v216, v27
    v_mul_f32 v217, v217, v27
    v_mul_f32 v218, v218, v27
    v_mul_f32 v219, v219, v27
    v_mul_f32 v220, v220, v27
    v_mul_f32 v221, v221, v27
    v_mul_f32 v222, v222, v27
    v_mul_f32 v223, v223, v27
    v_mul_f32 v224, v224, v27
    v_mul_f32 v225, v225, v27
    v_mul_f32 v226, v226, v27
    v_mul_f32 v227, v227, v27
    v_mul_f32 v228, v228, v27
    v_mul_f32 v229, v229, v27
    v_mul_f32 v230, v230, v27
    v_mul_f32 v231, v231, v27
    v_mul_f32 v232, v232, v27
    v_mul_f32 v233, v233, v27
    v_mul_f32 v234, v234, v27
    v_mul_f32 v235, v235, v27
    v_mul_f32 v236, v236, v27
    v_mul_f32 v237, v237, v27
    v_mul_f32 v238, v238, v27
    v_mul_f32 v239, v239, v27
    v_mul_f32 v240, v240, v27
    v_mul_f32 v241, v241, v27
    v_mul_f32 v242, v242, v27
    v_mul_f32 v243, v243, v27
    v_mul_f32 v244, v244, v27
    v_mul_f32 v245, v245, v27
    v_mul_f32 v246, v246, v27
    v_mul_f32 v247, v247, v27
    v_mul_f32 v248, v248, v27
    v_mul_f32 v249, v249, v27
    v_mul_f32 v250, v250, v27
    v_mul_f32 v251, v251, v27
    v_mul_f32 v252, v252, v27
    v_mul_f32 v253, v253, v27
    v_mul_f32 v254, v254, v27
    v_mul_f32 v255, v255, v27
    v_cvt_pk_bf16_f32 v26, 0, v40
    v_cvt_pk_bf16_f32 v27, 0, v41
    v_fma_f32 v26, v26, s36, -v20
    v_fma_f32 v27, v27, s36, -v20
    v_exp_f32 v26, v26
    v_exp_f32 v27, v27
    v_cvt_pk_bf16_f32 v28, 0, v42
    v_add_f32 v24, v26, v27
    v_cvt_pk_bf16_f32 v96, v26, v27
    v_cvt_pk_bf16_f32 v29, 0, v43
    v_fma_f32 v28, v28, s36, -v20
    v_fma_f32 v29, v29, s36, -v20
    v_exp_f32 v28, v28
    v_exp_f32 v29, v29
    v_cvt_pk_bf16_f32 v30, 0, v44
    v_add_f32 v25, v28, v29
    v_cvt_pk_bf16_f32 v97, v28, v29
    v_cvt_pk_bf16_f32 v31, 0, v45
    v_fma_f32 v30, v30, s36, -v20
    v_fma_f32 v31, v31, s36, -v20
    v_exp_f32 v30, v30
    v_exp_f32 v31, v31
    v_cvt_pk_bf16_f32 v26, 0, v46
    v_add_f32 v24, v24, v30
    v_add_f32 v25, v25, v31
    v_cvt_pk_bf16_f32 v98, v30, v31
    v_cvt_pk_bf16_f32 v27, 0, v47
    v_fma_f32 v26, v26, s36, -v20
    v_fma_f32 v27, v27, s36, -v20
    v_exp_f32 v26, v26
    v_exp_f32 v27, v27
    v_cvt_pk_bf16_f32 v28, 0, v48
    v_add_f32 v24, v24, v26
    v_add_f32 v25, v25, v27
    v_cvt_pk_bf16_f32 v99, v26, v27
    v_cvt_pk_bf16_f32 v29, 0, v49
    v_fma_f32 v28, v28, s36, -v20
    v_fma_f32 v29, v29, s36, -v20
    v_exp_f32 v28, v28
    v_exp_f32 v29, v29
    v_cvt_pk_bf16_f32 v30, 0, v50
    v_add_f32 v24, v24, v28
    v_add_f32 v25, v25, v29
    v_cvt_pk_bf16_f32 v100, v28, v29
    v_cvt_pk_bf16_f32 v31, 0, v51
    v_fma_f32 v30, v30, s36, -v20
    v_fma_f32 v31, v31, s36, -v20
    v_exp_f32 v30, v30
    v_exp_f32 v31, v31
    v_cvt_pk_bf16_f32 v26, 0, v52
    v_add_f32 v24, v24, v30
    v_add_f32 v25, v25, v31
    v_cvt_pk_bf16_f32 v101, v30, v31
    v_cvt_pk_bf16_f32 v27, 0, v53
    v_fma_f32 v26, v26, s36, -v20
    v_fma_f32 v27, v27, s36, -v20
    v_exp_f32 v26, v26
    v_exp_f32 v27, v27
    v_cvt_pk_bf16_f32 v28, 0, v54
    v_add_f32 v24, v24, v26
    v_add_f32 v25, v25, v27
    v_cvt_pk_bf16_f32 v102, v26, v27
    v_cvt_pk_bf16_f32 v29, 0, v55
    v_fma_f32 v28, v28, s36, -v20
    v_fma_f32 v29, v29, s36, -v20
    v_exp_f32 v28, v28
    v_exp_f32 v29, v29
    s_nop 0
    v_add_f32 v24, v24, v28
    v_add_f32 v25, v25, v29
    v_cvt_pk_bf16_f32 v103, v28, v29
    v_add_f32 v24, v24, v25
    s_nop 1
    s_cmp_eq_u32 s88, 0
    s_cbranch_scc1 Lret_17
    s_branch Lret_25
Lslow_18:
    s_mov_b32 s88, 0
    s_branch Lsub_85
Lslow_26:
    s_mov_b32 s88, 1
Lsub_85:
    v_max3_f32 v26, v72, v73, v74
    v_max3_f32 v26, v26, v75, v76
    v_max3_f32 v26, v26, v77, v78
    v_max3_f32 v26, v26, v79, v80
    v_max3_f32 v26, v26, v81, v82
    v_max3_f32 v26, v26, v83, v84
    v_max3_f32 v26, v26, v85, v86
    v_max_f32 v26, v26, v87
    v_mov_b32 v27, v26
    s_nop 1
    v_permlane32_swap_b32 v26, v27
    s_nop 1
    v_max_f32 v26, v26, v27
    v_cvt_pk_bf16_f32 v26, 0, v26
    v_mov_b32 v28, 0x42400000
    v_fma_f32 v26, v26, s36, v28
    v_max_f32 v26, v26, v21
    v_sub_f32 v27, v21, v26
    v_exp_f32 v27, v27
    v_mov_b32 v21, v26
    s_nop 7
    s_nop 7
    v_mul_f32 v23, v23, v27
    v_accvgpr_read_b32 v32, a128
    v_accvgpr_read_b32 v33, a129
    v_accvgpr_read_b32 v34, a130
    v_accvgpr_read_b32 v35, a131
    v_mul_f32 v32, v32, v27
    v_mul_f32 v33, v33, v27
    v_mul_f32 v34, v34, v27
    v_mul_f32 v35, v35, v27
    v_accvgpr_write_b32 a128, v32
    v_accvgpr_write_b32 a129, v33
    v_accvgpr_write_b32 a130, v34
    v_accvgpr_write_b32 a131, v35
    v_accvgpr_read_b32 v32, a132
    v_accvgpr_read_b32 v33, a133
    v_accvgpr_read_b32 v34, a134
    v_accvgpr_read_b32 v35, a135
    v_mul_f32 v32, v32, v27
    v_mul_f32 v33, v33, v27
    v_mul_f32 v34, v34, v27
    v_mul_f32 v35, v35, v27
    v_accvgpr_write_b32 a132, v32
    v_accvgpr_write_b32 a133, v33
    v_accvgpr_write_b32 a134, v34
    v_accvgpr_write_b32 a135, v35
    v_accvgpr_read_b32 v32, a136
    v_accvgpr_read_b32 v33, a137
    v_accvgpr_read_b32 v34, a138
    v_accvgpr_read_b32 v35, a139
    v_mul_f32 v32, v32, v27
    v_mul_f32 v33, v33, v27
    v_mul_f32 v34, v34, v27
    v_mul_f32 v35, v35, v27
    v_accvgpr_write_b32 a136, v32
    v_accvgpr_write_b32 a137, v33
    v_accvgpr_write_b32 a138, v34
    v_accvgpr_write_b32 a139, v35
    v_accvgpr_read_b32 v32, a140
    v_accvgpr_read_b32 v33, a141
    v_accvgpr_read_b32 v34, a142
    v_accvgpr_read_b32 v35, a143
    v_mul_f32 v32, v32, v27
    v_mul_f32 v33, v33, v27
    v_mul_f32 v34, v34, v27
    v_mul_f32 v35, v35, v27
    v_accvgpr_write_b32 a140, v32
    v_accvgpr_write_b32 a141, v33
    v_accvgpr_write_b32 a142, v34
    v_accvgpr_write_b32 a143, v35
    v_accvgpr_read_b32 v32, a144
    v_accvgpr_read_b32 v33, a145
    v_accvgpr_read_b32 v34, a146
    v_accvgpr_read_b32 v35, a147
    v_mul_f32 v32, v32, v27
    v_mul_f32 v33, v33, v27
    v_mul_f32 v34, v34, v27
    v_mul_f32 v35, v35, v27
    v_accvgpr_write_b32 a144, v32
    v_accvgpr_write_b32 a145, v33
    v_accvgpr_write_b32 a146, v34
    v_accvgpr_write_b32 a147, v35
    v_accvgpr_read_b32 v32, a148
    v_accvgpr_read_b32 v33, a149
    v_accvgpr_read_b32 v34, a150
    v_accvgpr_read_b32 v35, a151
    v_mul_f32 v32, v32, v27
    v_mul_f32 v33, v33, v27
    v_mul_f32 v34, v34, v27
    v_mul_f32 v35, v35, v27
    v_accvgpr_write_b32 a148, v32
    v_accvgpr_write_b32 a149, v33
    v_accvgpr_write_b32 a150, v34
    v_accvgpr_write_b32 a151, v35
    v_accvgpr_read_b32 v32, a152
    v_accvgpr_read_b32 v33, a153
    v_accvgpr_read_b32 v34, a154
    v_accvgpr_read_b32 v35, a155
    v_mul_f32 v32, v32, v27
    v_mul_f32 v33, v33, v27
    v_mul_f32 v34, v34, v27
    v_mul_f32 v35, v35, v27
    v_accvgpr_write_b32 a152, v32
    v_accvgpr_write_b32 a153, v33
    v_accvgpr_write_b32 a154, v34
    v_accvgpr_write_b32 a155, v35
    v_accvgpr_read_b32 v32, a156
    v_accvgpr_read_b32 v33, a157
    v_accvgpr_read_b32 v34, a158
    v_accvgpr_read_b32 v35, a159
    v_mul_f32 v32, v32, v27
    v_mul_f32 v33, v33, v27
    v_mul_f32 v34, v34, v27
    v_mul_f32 v35, v35, v27
    v_accvgpr_write_b32 a156, v32
    v_accvgpr_write_b32 a157, v33
    v_accvgpr_write_b32 a158, v34
    v_accvgpr_write_b32 a159, v35
    v_accvgpr_read_b32 v32, a160
    v_accvgpr_read_b32 v33, a161
    v_accvgpr_read_b32 v34, a162
    v_accvgpr_read_b32 v35, a163
    v_mul_f32 v32, v32, v27
    v_mul_f32 v33, v33, v27
    v_mul_f32 v34, v34, v27
    v_mul_f32 v35, v35, v27
    v_accvgpr_write_b32 a160, v32
    v_accvgpr_write_b32 a161, v33
    v_accvgpr_write_b32 a162, v34
    v_accvgpr_write_b32 a163, v35
    v_accvgpr_read_b32 v32, a164
    v_accvgpr_read_b32 v33, a165
    v_accvgpr_read_b32 v34, a166
    v_accvgpr_read_b32 v35, a167
    v_mul_f32 v32, v32, v27
    v_mul_f32 v33, v33, v27
    v_mul_f32 v34, v34, v27
    v_mul_f32 v35, v35, v27
    v_accvgpr_write_b32 a164, v32
    v_accvgpr_write_b32 a165, v33
    v_accvgpr_write_b32 a166, v34
    v_accvgpr_write_b32 a167, v35
    v_accvgpr_read_b32 v32, a168
    v_accvgpr_read_b32 v33, a169
    v_accvgpr_read_b32 v34, a170
    v_accvgpr_read_b32 v35, a171
    v_mul_f32 v32, v32, v27
    v_mul_f32 v33, v33, v27
    v_mul_f32 v34, v34, v27
    v_mul_f32 v35, v35, v27
    v_accvgpr_write_b32 a168, v32
    v_accvgpr_write_b32 a169, v33
    v_accvgpr_write_b32 a170, v34
    v_accvgpr_write_b32 a171, v35
    v_accvgpr_read_b32 v32, a172
    v_accvgpr_read_b32 v33, a173
    v_accvgpr_read_b32 v34, a174
    v_accvgpr_read_b32 v35, a175
    v_mul_f32 v32, v32, v27
    v_mul_f32 v33, v33, v27
    v_mul_f32 v34, v34, v27
    v_mul_f32 v35, v35, v27
    v_accvgpr_write_b32 a172, v32
    v_accvgpr_write_b32 a173, v33
    v_accvgpr_write_b32 a174, v34
    v_accvgpr_write_b32 a175, v35
    v_accvgpr_read_b32 v32, a176
    v_accvgpr_read_b32 v33, a177
    v_accvgpr_read_b32 v34, a178
    v_accvgpr_read_b32 v35, a179
    v_mul_f32 v32, v32, v27
    v_mul_f32 v33, v33, v27
    v_mul_f32 v34, v34, v27
    v_mul_f32 v35, v35, v27
    v_accvgpr_write_b32 a176, v32
    v_accvgpr_write_b32 a177, v33
    v_accvgpr_write_b32 a178, v34
    v_accvgpr_write_b32 a179, v35
    v_accvgpr_read_b32 v32, a180
    v_accvgpr_read_b32 v33, a181
    v_accvgpr_read_b32 v34, a182
    v_accvgpr_read_b32 v35, a183
    v_mul_f32 v32, v32, v27
    v_mul_f32 v33, v33, v27
    v_mul_f32 v34, v34, v27
    v_mul_f32 v35, v35, v27
    v_accvgpr_write_b32 a180, v32
    v_accvgpr_write_b32 a181, v33
    v_accvgpr_write_b32 a182, v34
    v_accvgpr_write_b32 a183, v35
    v_accvgpr_read_b32 v32, a184
    v_accvgpr_read_b32 v33, a185
    v_accvgpr_read_b32 v34, a186
    v_accvgpr_read_b32 v35, a187
    v_mul_f32 v32, v32, v27
    v_mul_f32 v33, v33, v27
    v_mul_f32 v34, v34, v27
    v_mul_f32 v35, v35, v27
    v_accvgpr_write_b32 a184, v32
    v_accvgpr_write_b32 a185, v33
    v_accvgpr_write_b32 a186, v34
    v_accvgpr_write_b32 a187, v35
    v_accvgpr_read_b32 v32, a188
    v_accvgpr_read_b32 v33, a189
    v_accvgpr_read_b32 v34, a190
    v_accvgpr_read_b32 v35, a191
    v_mul_f32 v32, v32, v27
    v_mul_f32 v33, v33, v27
    v_mul_f32 v34, v34, v27
    v_mul_f32 v35, v35, v27
    v_accvgpr_write_b32 a188, v32
    v_accvgpr_write_b32 a189, v33
    v_accvgpr_write_b32 a190, v34
    v_accvgpr_write_b32 a191, v35
    v_accvgpr_read_b32 v32, a192
    v_accvgpr_read_b32 v33, a193
    v_accvgpr_read_b32 v34, a194
    v_accvgpr_read_b32 v35, a195
    v_mul_f32 v32, v32, v27
    v_mul_f32 v33, v33, v27
    v_mul_f32 v34, v34, v27
    v_mul_f32 v35, v35, v27
    v_accvgpr_write_b32 a192, v32
    v_accvgpr_write_b32 a193, v33
    v_accvgpr_write_b32 a194, v34
    v_accvgpr_write_b32 a195, v35
    v_accvgpr_read_b32 v32, a196
    v_accvgpr_read_b32 v33, a197
    v_accvgpr_read_b32 v34, a198
    v_accvgpr_read_b32 v35, a199
    v_mul_f32 v32, v32, v27
    v_mul_f32 v33, v33, v27
    v_mul_f32 v34, v34, v27
    v_mul_f32 v35, v35, v27
    v_accvgpr_write_b32 a196, v32
    v_accvgpr_write_b32 a197, v33
    v_accvgpr_write_b32 a198, v34
    v_accvgpr_write_b32 a199, v35
    v_accvgpr_read_b32 v32, a200
    v_accvgpr_read_b32 v33, a201
    v_accvgpr_read_b32 v34, a202
    v_accvgpr_read_b32 v35, a203
    v_mul_f32 v32, v32, v27
    v_mul_f32 v33, v33, v27
    v_mul_f32 v34, v34, v27
    v_mul_f32 v35, v35, v27
    v_accvgpr_write_b32 a200, v32
    v_accvgpr_write_b32 a201, v33
    v_accvgpr_write_b32 a202, v34
    v_accvgpr_write_b32 a203, v35
    v_accvgpr_read_b32 v32, a204
    v_accvgpr_read_b32 v33, a205
    v_accvgpr_read_b32 v34, a206
    v_accvgpr_read_b32 v35, a207
    v_mul_f32 v32, v32, v27
    v_mul_f32 v33, v33, v27
    v_mul_f32 v34, v34, v27
    v_mul_f32 v35, v35, v27
    v_accvgpr_write_b32 a204, v32
    v_accvgpr_write_b32 a205, v33
    v_accvgpr_write_b32 a206, v34
    v_accvgpr_write_b32 a207, v35
    v_accvgpr_read_b32 v32, a208
    v_accvgpr_read_b32 v33, a209
    v_accvgpr_read_b32 v34, a210
    v_accvgpr_read_b32 v35, a211
    v_mul_f32 v32, v32, v27
    v_mul_f32 v33, v33, v27
    v_mul_f32 v34, v34, v27
    v_mul_f32 v35, v35, v27
    v_accvgpr_write_b32 a208, v32
    v_accvgpr_write_b32 a209, v33
    v_accvgpr_write_b32 a210, v34
    v_accvgpr_write_b32 a211, v35
    v_accvgpr_read_b32 v32, a212
    v_accvgpr_read_b32 v33, a213
    v_accvgpr_read_b32 v34, a214
    v_accvgpr_read_b32 v35, a215
    v_mul_f32 v32, v32, v27
    v_mul_f32 v33, v33, v27
    v_mul_f32 v34, v34, v27
    v_mul_f32 v35, v35, v27
    v_accvgpr_write_b32 a212, v32
    v_accvgpr_write_b32 a213, v33
    v_accvgpr_write_b32 a214, v34
    v_accvgpr_write_b32 a215, v35
    v_accvgpr_read_b32 v32, a216
    v_accvgpr_read_b32 v33, a217
    v_accvgpr_read_b32 v34, a218
    v_accvgpr_read_b32 v35, a219
    v_mul_f32 v32, v32, v27
    v_mul_f32 v33, v33, v27
    v_mul_f32 v34, v34, v27
    v_mul_f32 v35, v35, v27
    v_accvgpr_write_b32 a216, v32
    v_accvgpr_write_b32 a217, v33
    v_accvgpr_write_b32 a218, v34
    v_accvgpr_write_b32 a219, v35
    v_accvgpr_read_b32 v32, a220
    v_accvgpr_read_b32 v33, a221
    v_accvgpr_read_b32 v34, a222
    v_accvgpr_read_b32 v35, a223
    v_mul_f32 v32, v32, v27
    v_mul_f32 v33, v33, v27
    v_mul_f32 v34, v34, v27
    v_mul_f32 v35, v35, v27
    v_accvgpr_write_b32 a220, v32
    v_accvgpr_write_b32 a221, v33
    v_accvgpr_write_b32 a222, v34
    v_accvgpr_write_b32 a223, v35
    v_accvgpr_read_b32 v32, a224
    v_accvgpr_read_b32 v33, a225
    v_accvgpr_read_b32 v34, a226
    v_accvgpr_read_b32 v35, a227
    v_mul_f32 v32, v32, v27
    v_mul_f32 v33, v33, v27
    v_mul_f32 v34, v34, v27
    v_mul_f32 v35, v35, v27
    v_accvgpr_write_b32 a224, v32
    v_accvgpr_write_b32 a225, v33
    v_accvgpr_write_b32 a226, v34
    v_accvgpr_write_b32 a227, v35
    v_accvgpr_read_b32 v32, a228
    v_accvgpr_read_b32 v33, a229
    v_accvgpr_read_b32 v34, a230
    v_accvgpr_read_b32 v35, a231
    v_mul_f32 v32, v32, v27
    v_mul_f32 v33, v33, v27
    v_mul_f32 v34, v34, v27
    v_mul_f32 v35, v35, v27
    v_accvgpr_write_b32 a228, v32
    v_accvgpr_write_b32 a229, v33
    v_accvgpr_write_b32 a230, v34
    v_accvgpr_write_b32 a231, v35
    v_accvgpr_read_b32 v32, a232
    v_accvgpr_read_b32 v33, a233
    v_accvgpr_read_b32 v34, a234
    v_accvgpr_read_b32 v35, a235
    v_mul_f32 v32, v32, v27
    v_mul_f32 v33, v33, v27
    v_mul_f32 v34, v34, v27
    v_mul_f32 v35, v35, v27
    v_accvgpr_write_b32 a232, v32
    v_accvgpr_write_b32 a233, v33
    v_accvgpr_write_b32 a234, v34
    v_accvgpr_write_b32 a235, v35
    v_accvgpr_read_b32 v32, a236
    v_accvgpr_read_b32 v33, a237
    v_accvgpr_read_b32 v34, a238
    v_accvgpr_read_b32 v35, a239
    v_mul_f32 v32, v32, v27
    v_mul_f32 v33, v33, v27
    v_mul_f32 v34, v34, v27
    v_mul_f32 v35, v35, v27
    v_accvgpr_write_b32 a236, v32
    v_accvgpr_write_b32 a237, v33
    v_accvgpr_write_b32 a238, v34
    v_accvgpr_write_b32 a239, v35
    v_accvgpr_read_b32 v32, a240
    v_accvgpr_read_b32 v33, a241
    v_accvgpr_read_b32 v34, a242
    v_accvgpr_read_b32 v35, a243
    v_mul_f32 v32, v32, v27
    v_mul_f32 v33, v33, v27
    v_mul_f32 v34, v34, v27
    v_mul_f32 v35, v35, v27
    v_accvgpr_write_b32 a240, v32
    v_accvgpr_write_b32 a241, v33
    v_accvgpr_write_b32 a242, v34
    v_accvgpr_write_b32 a243, v35
    v_accvgpr_read_b32 v32, a244
    v_accvgpr_read_b32 v33, a245
    v_accvgpr_read_b32 v34, a246
    v_accvgpr_read_b32 v35, a247
    v_mul_f32 v32, v32, v27
    v_mul_f32 v33, v33, v27
    v_mul_f32 v34, v34, v27
    v_mul_f32 v35, v35, v27
    v_accvgpr_write_b32 a244, v32
    v_accvgpr_write_b32 a245, v33
    v_accvgpr_write_b32 a246, v34
    v_accvgpr_write_b32 a247, v35
    v_accvgpr_read_b32 v32, a248
    v_accvgpr_read_b32 v33, a249
    v_accvgpr_read_b32 v34, a250
    v_accvgpr_read_b32 v35, a251
    v_mul_f32 v32, v32, v27
    v_mul_f32 v33, v33, v27
    v_mul_f32 v34, v34, v27
    v_mul_f32 v35, v35, v27
    v_accvgpr_write_b32 a248, v32
    v_accvgpr_write_b32 a249, v33
    v_accvgpr_write_b32 a250, v34
    v_accvgpr_write_b32 a251, v35
    v_accvgpr_read_b32 v32, a252
    v_accvgpr_read_b32 v33, a253
    v_accvgpr_read_b32 v34, a254
    v_accvgpr_read_b32 v35, a255
    v_mul_f32 v32, v32, v27
    v_mul_f32 v33, v33, v27
    v_mul_f32 v34, v34, v27
    v_mul_f32 v35, v35, v27
    v_accvgpr_write_b32 a252, v32
    v_accvgpr_write_b32 a253, v33
    v_accvgpr_write_b32 a254, v34
    v_accvgpr_write_b32 a255, v35
    v_cvt_pk_bf16_f32 v26, 0, v72
    v_cvt_pk_bf16_f32 v27, 0, v73
    v_fma_f32 v26, v26, s36, -v21
    v_fma_f32 v27, v27, s36, -v21
    v_exp_f32 v26, v26
    v_exp_f32 v27, v27
    v_cvt_pk_bf16_f32 v28, 0, v74
    v_add_f32 v24, v26, v27
    v_cvt_pk_bf16_f32 v104, v26, v27
    v_cvt_pk_bf16_f32 v29, 0, v75
    v_fma_f32 v28, v28, s36, -v21
    v_fma_f32 v29, v29, s36, -v21
    v_exp_f32 v28, v28
    v_exp_f32 v29, v29
    v_cvt_pk_bf16_f32 v30, 0, v76
    v_add_f32 v25, v28, v29
    v_cvt_pk_bf16_f32 v105, v28, v29
    v_cvt_pk_bf16_f32 v31, 0, v77
    v_fma_f32 v30, v30, s36, -v21
    v_fma_f32 v31, v31, s36, -v21
    v_exp_f32 v30, v30
    v_exp_f32 v31, v31
    v_cvt_pk_bf16_f32 v26, 0, v78
    v_add_f32 v24, v24, v30
    v_add_f32 v25, v25, v31
    v_cvt_pk_bf16_f32 v106, v30, v31
    v_cvt_pk_bf16_f32 v27, 0, v79
    v_fma_f32 v26, v26, s36, -v21
    v_fma_f32 v27, v27, s36, -v21
    v_exp_f32 v26, v26
    v_exp_f32 v27, v27
    v_cvt_pk_bf16_f32 v28, 0, v80
    v_add_f32 v24, v24, v26
    v_add_f32 v25, v25, v27
    v_cvt_pk_bf16_f32 v107, v26, v27
    v_cvt_pk_bf16_f32 v29, 0, v81
    v_fma_f32 v28, v28, s36, -v21
    v_fma_f32 v29, v29, s36, -v21
    v_exp_f32 v28, v28
    v_exp_f32 v29, v29
    v_cvt_pk_bf16_f32 v30, 0, v82
    v_add_f32 v24, v24, v28
    v_add_f32 v25, v25, v29
    v_cvt_pk_bf16_f32 v108, v28, v29
    v_cvt_pk_bf16_f32 v31, 0, v83
    v_fma_f32 v30, v30, s36, -v21
    v_fma_f32 v31, v31, s36, -v21
    v_exp_f32 v30, v30
    v_exp_f32 v31, v31
    v_cvt_pk_bf16_f32 v26, 0, v84
    v_add_f32 v24, v24, v30
    v_add_f32 v25, v25, v31
    v_cvt_pk_bf16_f32 v109, v30, v31
    v_cvt_pk_bf16_f32 v27, 0, v85
    v_fma_f32 v26, v26, s36, -v21
    v_fma_f32 v27, v27, s36, -v21
    v_exp_f32 v26, v26
    v_exp_f32 v27, v27
    v_cvt_pk_bf16_f32 v28, 0, v86
    v_add_f32 v24, v24, v26
    v_add_f32 v25, v25, v27
    v_cvt_pk_bf16_f32 v110, v26, v27
    v_cvt_pk_bf16_f32 v29, 0, v87
    v_fma_f32 v28, v28, s36, -v21
    v_fma_f32 v29, v29, s36, -v21
    v_exp_f32 v28, v28
    v_exp_f32 v29, v29
    s_nop 0
    v_add_f32 v24, v24, v28
    v_add_f32 v25, v25, v29
    v_cvt_pk_bf16_f32 v111, v28, v29
    v_add_f32 v24, v24, v25
    s_nop 1
    s_cmp_eq_u32 s88, 0
    s_cbranch_scc1 Lret_19
    s_branch Lret_27
Lslow_20:
    s_mov_b32 s88, 0
Lsub_86:
    v_max3_f32 v26, v40, v41, v42
    v_max3_f32 v26, v26, v43, v44
    v_max3_f32 v26, v26, v45, v46
    v_max3_f32 v26, v26, v47, v48
    v_max3_f32 v26, v26, v49, v50
    v_max3_f32 v26, v26, v51, v52
    v_max3_f32 v26, v26, v53, v54
    v_max_f32 v26, v26, v55
    v_mov_b32 v27, v26
    s_nop 1
    v_permlane32_swap_b32 v26, v27
    s_nop 1
    v_max_f32 v26, v26, v27
    v_cvt_pk_bf16_f32 v26, 0, v26
    v_mov_b32 v28, 0x42400000
    v_fma_f32 v26, v26, s36, v28
    v_max_f32 v26, v26, v20
    v_sub_f32 v27, v20, v26
    v_exp_f32 v27, v27
    v_mov_b32 v20, v26
    s_nop 7
    s_nop 7
    v_mul_f32 v22, v22, v27
    v_mul_f32 v128, v128, v27
    v_mul_f32 v129, v129, v27
    v_mul_f32 v130, v130, v27
    v_mul_f32 v131, v131, v27
    v_mul_f32 v132, v132, v27
    v_mul_f32 v133, v133, v27
    v_mul_f32 v134, v134, v27
    v_mul_f32 v135, v135, v27
    v_mul_f32 v136, v136, v27
    v_mul_f32 v137, v137, v27
    v_mul_f32 v138, v138, v27
    v_mul_f32 v139, v139, v27
    v_mul_f32 v140, v140, v27
    v_mul_f32 v141, v141, v27
    v_mul_f32 v142, v142, v27
    v_mul_f32 v143, v143, v27
    v_mul_f32 v144, v144, v27
    v_mul_f32 v145, v145, v27
    v_mul_f32 v146, v146, v27
    v_mul_f32 v147, v147, v27
    v_mul_f32 v148, v148, v27
    v_mul_f32 v149, v149, v27
    v_mul_f32 v150, v150, v27
    v_mul_f32 v151, v151, v27
    v_mul_f32 v152, v152, v27
    v_mul_f32 v153, v153, v27
    v_mul_f32 v154, v154, v27
    v_mul_f32 v155, v155, v27
    v_mul_f32 v156, v156, v27
    v_mul_f32 v157, v157, v27
    v_mul_f32 v158, v158, v27
    v_mul_f32 v159, v159, v27
    v_mul_f32 v160, v160, v27
    v_mul_f32 v161, v161, v27
    v_mul_f32 v162, v162, v27
    v_mul_f32 v163, v163, v27
    v_mul_f32 v164, v164, v27
    v_mul_f32 v165, v165, v27
    v_mul_f32 v166, v166, v27
    v_mul_f32 v167, v167, v27
    v_mul_f32 v168, v168, v27
    v_mul_f32 v169, v169, v27
    v_mul_f32 v170, v170, v27
    v_mul_f32 v171, v171, v27
    v_mul_f32 v172, v172, v27
    v_mul_f32 v173, v173, v27
    v_mul_f32 v174, v174, v27
    v_mul_f32 v175, v175, v27
    v_mul_f32 v176, v176, v27
    v_mul_f32 v177, v177, v27
    v_mul_f32 v178, v178, v27
    v_mul_f32 v179, v179, v27
    v_mul_f32 v180, v180, v27
    v_mul_f32 v181, v181, v27
    v_mul_f32 v182, v182, v27
    v_mul_f32 v183, v183, v27
    v_mul_f32 v184, v184, v27
    v_mul_f32 v185, v185, v27
    v_mul_f32 v186, v186, v27
    v_mul_f32 v187, v187, v27
    v_mul_f32 v188, v188, v27
    v_mul_f32 v189, v189, v27
    v_mul_f32 v190, v190, v27
    v_mul_f32 v191, v191, v27
    v_mul_f32 v192, v192, v27
    v_mul_f32 v193, v193, v27
    v_mul_f32 v194, v194, v27
    v_mul_f32 v195, v195, v27
    v_mul_f32 v196, v196, v27
    v_mul_f32 v197, v197, v27
    v_mul_f32 v198, v198, v27
    v_mul_f32 v199, v199, v27
    v_mul_f32 v200, v200, v27
    v_mul_f32 v201, v201, v27
    v_mul_f32 v202, v202, v27
    v_mul_f32 v203, v203, v27
    v_mul_f32 v204, v204, v27
    v_mul_f32 v205, v205, v27
    v_mul_f32 v206, v206, v27
    v_mul_f32 v207, v207, v27
    v_mul_f32 v208, v208, v27
    v_mul_f32 v209, v209, v27
    v_mul_f32 v210, v210, v27
    v_mul_f32 v211, v211, v27
    v_mul_f32 v212, v212, v27
    v_mul_f32 v213, v213, v27
    v_mul_f32 v214, v214, v27
    v_mul_f32 v215, v215, v27
    v_mul_f32 v216, v216, v27
    v_mul_f32 v217, v217, v27
    v_mul_f32 v218, v218, v27
    v_mul_f32 v219, v219, v27
    v_mul_f32 v220, v220, v27
    v_mul_f32 v221, v221, v27
    v_mul_f32 v222, v222, v27
    v_mul_f32 v223, v223, v27
    v_mul_f32 v224, v224, v27
    v_mul_f32 v225, v225, v27
    v_mul_f32 v226, v226, v27
    v_mul_f32 v227, v227, v27
    v_mul_f32 v228, v228, v27
    v_mul_f32 v229, v229, v27
    v_mul_f32 v230, v230, v27
    v_mul_f32 v231, v231, v27
    v_mul_f32 v232, v232, v27
    v_mul_f32 v233, v233, v27
    v_mul_f32 v234, v234, v27
    v_mul_f32 v235, v235, v27
    v_mul_f32 v236, v236, v27
    v_mul_f32 v237, v237, v27
    v_mul_f32 v238, v238, v27
    v_mul_f32 v239, v239, v27
    v_mul_f32 v240, v240, v27
    v_mul_f32 v241, v241, v27
    v_mul_f32 v242, v242, v27
    v_mul_f32 v243, v243, v27
    v_mul_f32 v244, v244, v27
    v_mul_f32 v245, v245, v27
    v_mul_f32 v246, v246, v27
    v_mul_f32 v247, v247, v27
    v_mul_f32 v248, v248, v27
    v_mul_f32 v249, v249, v27
    v_mul_f32 v250, v250, v27
    v_mul_f32 v251, v251, v27
    v_mul_f32 v252, v252, v27
    v_mul_f32 v253, v253, v27
    v_mul_f32 v254, v254, v27
    v_mul_f32 v255, v255, v27
    v_cvt_pk_bf16_f32 v26, 0, v40
    v_cvt_pk_bf16_f32 v27, 0, v41
    v_fma_f32 v26, v26, s36, -v20
    v_fma_f32 v27, v27, s36, -v20
    v_exp_f32 v26, v26
    v_exp_f32 v27, v27
    v_cvt_pk_bf16_f32 v28, 0, v42
    v_add_f32 v24, v26, v27
    v_cvt_pk_bf16_f32 v88, v26, v27
    v_cvt_pk_bf16_f32 v29, 0, v43
    v_fma_f32 v28, v28, s36, -v20
    v_fma_f32 v29, v29, s36, -v20
    v_exp_f32 v28, v28
    v_exp_f32 v29, v29
    v_cvt_pk_bf16_f32 v30, 0, v44
    v_add_f32 v25, v28, v29
    v_cvt_pk_bf16_f32 v89, v28, v29
    v_cvt_pk_bf16_f32 v31, 0, v45
    v_fma_f32 v30, v30, s36, -v20
    v_fma_f32 v31, v31, s36, -v20
    v_exp_f32 v30, v30
    v_exp_f32 v31, v31
    v_cvt_pk_bf16_f32 v26, 0, v46
    v_add_f32 v24, v24, v30
    v_add_f32 v25, v25, v31
    v_cvt_pk_bf16_f32 v90, v30, v31
    v_cvt_pk_bf16_f32 v27, 0, v47
    v_fma_f32 v26, v26, s36, -v20
    v_fma_f32 v27, v27, s36, -v20
    v_exp_f32 v26, v26
    v_exp_f32 v27, v27
    v_cvt_pk_bf16_f32 v28, 0, v48
    v_add_f32 v24, v24, v26
    v_add_f32 v25, v25, v27
    v_cvt_pk_bf16_f32 v91, v26, v27
    v_cvt_pk_bf16_f32 v29, 0, v49
    v_fma_f32 v28, v28, s36, -v20
    v_fma_f32 v29, v29, s36, -v20
    v_exp_f32 v28, v28
    v_exp_f32 v29, v29
    v_cvt_pk_bf16_f32 v30, 0, v50
    v_add_f32 v24, v24, v28
    v_add_f32 v25, v25, v29
    v_cvt_pk_bf16_f32 v92, v28, v29
    v_cvt_pk_bf16_f32 v31, 0, v51
    v_fma_f32 v30, v30, s36, -v20
    v_fma_f32 v31, v31, s36, -v20
    v_exp_f32 v30, v30
    v_exp_f32 v31, v31
    v_cvt_pk_bf16_f32 v26, 0, v52
    v_add_f32 v24, v24, v30
    v_add_f32 v25, v25, v31
    v_cvt_pk_bf16_f32 v93, v30, v31
    v_cvt_pk_bf16_f32 v27, 0, v53
    v_fma_f32 v26, v26, s36, -v20
    v_fma_f32 v27, v27, s36, -v20
    v_exp_f32 v26, v26
    v_exp_f32 v27, v27
    v_cvt_pk_bf16_f32 v28, 0, v54
    v_add_f32 v24, v24, v26
    v_add_f32 v25, v25, v27
    v_cvt_pk_bf16_f32 v94, v26, v27
    v_cvt_pk_bf16_f32 v29, 0, v55
    v_fma_f32 v28, v28, s36, -v20
    v_fma_f32 v29, v29, s36, -v20
    v_exp_f32 v28, v28
    v_exp_f32 v29, v29
    s_nop 0
    v_add_f32 v24, v24, v28
    v_add_f32 v25, v25, v29
    v_cvt_pk_bf16_f32 v95, v28, v29
    v_add_f32 v24, v24, v25
    s_nop 1
    s_branch Lret_21
.section .rodata,"a"
.p2align 6
.amdhsa_kernel attn_kernel
  .amdhsa_next_free_vgpr 512
  .amdhsa_next_free_sgpr 102
  .amdhsa_accum_offset 256
  .amdhsa_group_segment_fixed_size 0
  .amdhsa_kernarg_size 112
  .amdhsa_user_sgpr_count 2
  .amdhsa_user_sgpr_kernarg_segment_ptr 1
  .amdhsa_system_sgpr_workgroup_id_x 1
.end_amdhsa_kernel
```
